```python
import torch

def _softmax(x, axis=-1):
    return torch.softmax(x, dim=axis)
def _gelu(x):
    return torch.nn.functional.gelu(x, approximate="tanh")
def _silu(x):
    return torch.nn.functional.silu(x)
def _sigmoid(x):
    return torch.sigmoid(x)
def _layernorm(x, axis=-1, eps=1e-5):
    m = x.mean(dim=axis, keepdim=True)
    v = x.var(dim=axis, keepdim=True, unbiased=False)
    return (x - m) / torch.sqrt(v + eps)
def _scatter_add(tgt, idx, src, axis=0):
    return tgt.clone().index_add_(axis, idx, src)
def _segment_sum(src, seg, n):
    out = torch.zeros((n,) + src.shape[1:], dtype=src.dtype)
    return out.index_add_(0, seg, src)
def _pad(x, pw):
    flat = tuple(v for pair in reversed(pw) for v in pair)
    return torch.nn.functional.pad(x, flat)

kernel_name = 'interleave_layers__grouped_kv_mqa__sliding_block__prompt'

def setup_inputs():

    _w = (lambda a: (lambda t: t.to(torch.bfloat16) if t.is_floating_point() else t)(torch.as_tensor(a)))
    def _A_setup():
        B, S, D, H = 1, 2048, 576, 32
        Dh = D // H
        return {
            "x": _w((lambda *s: torch.randn(*s, dtype=torch.bfloat16) * 0.05)(B, S, D)),
            "wq": _w((lambda *s: torch.randn(*s, dtype=torch.bfloat16) * 0.05)(D, H * Dh)),
            "wk": _w((lambda *s: torch.randn(*s, dtype=torch.bfloat16) * 0.05)(D, Dh)),
            "wv": _w((lambda *s: torch.randn(*s, dtype=torch.bfloat16) * 0.05)(D, Dh)),
            "wo": _w((lambda *s: torch.randn(*s, dtype=torch.bfloat16) * 0.05)(H * Dh, D)),
        }
    _A_in = _A_setup()

    def _B_setup():
        B, S, D = 1, 2048, 576
        return {
            "x": _w((lambda *s: torch.randn(*s, dtype=torch.bfloat16) * 0.05)(B, S, D)),
            "wqkv": _w((lambda *s: torch.randn(*s, dtype=torch.bfloat16) * 0.05)(D, 3 * D)),
            "wo": _w((lambda *s: torch.randn(*s, dtype=torch.bfloat16) * 0.05)(D, D)),
        }
    _B_in = _B_setup()

    return {
        "A_x": _A_in["x"],
        "A_wq": _A_in["wq"],
        "A_wk": _A_in["wk"],
        "A_wv": _A_in["wv"],
        "A_wo": _A_in["wo"],
        "B_x": _B_in["x"],
        "B_wqkv": _B_in["wqkv"],
        "B_wo": _B_in["wo"],
    }

def reference(A_x, A_wq, A_wk, A_wv, A_wo, B_x, B_wqkv, B_wo):
    def _A_ref(x, wq, wk, wv, wo):
        B, S, D = x.shape
        H = 32
        Dh = D // H
        q = (lambda x, *d: x.permute(*d))((x @ wq).reshape(B, S, H, Dh), 0, 2, 1, 3)
        k = x @ wk
        v = x @ wv
        scores = torch.einsum("bhqd,bkd->bhqk", q, k) * (Dh ** -0.5)
        p = _softmax(scores, axis=-1)
        o = torch.einsum("bhqk,bkd->bhqd", p, v)
        return (lambda x, *d: x.permute(*d))(o, 0, 2, 1, 3).reshape(B, S, H * Dh) @ wo

    def _B_ref(x, wqkv, wo):
        B, S, D = x.shape
        H = 32; Dh = D // H; W = 256
        qkv = (lambda x, *d: x.permute(*d))((x @ wqkv).reshape(B, S, 3, H, Dh), 2, 0, 3, 1, 4)
        q, k, v = qkv[0], qkv[1], qkv[2]
        scores = torch.einsum("bhqd,bhkd->bhqk", q, k) * (Dh ** -0.5)
        idx = torch.arange(S)
        mask = (idx[:, None] - idx[None, :] >= 0) & (idx[:, None] - idx[None, :] < W)
        scores = torch.where(mask[None, None], scores, -1e9)
        p = _softmax(scores, axis=-1)
        o = torch.einsum("bhqk,bhkd->bhqd", p, v)
        return (lambda x, *d: x.permute(*d))(o, 0, 2, 1, 3).reshape(B, S, D) @ wo

    x = A_x
    x = x + _A_ref(_layernorm(x, axis=-1), A_wq, A_wk, A_wv, A_wo)
    x = x + _B_ref(_layernorm(x, axis=-1), B_wqkv, B_wo)
    x = x + _A_ref(_layernorm(x, axis=-1), A_wq, A_wk, A_wv, A_wo)
    x = x + _B_ref(_layernorm(x, axis=-1), B_wqkv, B_wo)
    return x
```

```asm
; @launch grid=(256,1,1) block=(512,1,1) lds=163840
.amdgcn_target "amdgcn-amd-amdhsa--gfx950"
.text
.globl interleave_layers__grouped_kv_mqa__sliding_block__prompt_kernel
.p2align 8
.type interleave_layers__grouped_kv_mqa__sliding_block__prompt_kernel,@function
interleave_layers__grouped_kv_mqa__sliding_block__prompt_kernel:
    s_cmp_ge_u32 s2, 256
    s_cbranch_scc1 L_end
    s_load_dwordx16 s[32:47], s[0:1], 0
    s_load_dwordx4 s[48:51], s[0:1], 64
    s_load_dwordx2 s[4:5], s[0:1], 80
    s_memrealtime s[22:23]
    v_lshrrev_b32 v4, 6, v0
    v_and_b32 v5, 63, v0
    v_readfirstlane_b32 s3, v4
    v_lshlrev_b32 v1, 4, v5
    v_and_b32 v2, 31, v5
    v_lshrrev_b32 v3, 5, v5
    s_mov_b32 s6, 0x10000000
    s_mov_b32 s7, 0x20000
    s_mov_b32 s11, 0x20000
    s_mov_b32 s18, 0xfffffc0
    s_mov_b32 s19, 0x20000
    s_and_b32 s12, s2, 7
    s_lshr_b32 s13, s2, 3
    s_mov_b32 s15, 0
    s_mov_b32 s20, 200000
    s_mov_b32 s99, 0
    v_mov_b32 v15, 0
    v_mov_b32 v111, 0
    s_cmp_lg_u32 s3, 5
    s_cbranch_scc1 L_nocodepf
    s_getpc_b64 s[26:27]
    s_lshl_b32 s24, s13, 11
    s_cmp_ge_u32 s24, CODE_END - L_nocodepf - 2048
    s_cbranch_scc1 L_nocodepf
    s_add_u32 s26, s26, s24
    s_addc_u32 s27, s27, 0
    v_lshlrev_b32 v4, 1, v1
    v_mov_b32 v5, s27
    v_add_co_u32 v4, vcc, s26, v4
    s_nop 1
    v_addc_co_u32 v5, vcc, 0, v5, vcc
    global_load_dword v100, v[4:5], off
L_nocodepf:
    v_lshlrev_b32 v4, 2, v3
    v_sub_u32 v4, v2, v4
    v_cmp_le_i32 s[64:65], 0, v4
    v_cmp_le_i32 s[66:67], 1, v4
    v_cmp_le_i32 s[68:69], 2, v4
    v_cmp_le_i32 s[70:71], 3, v4
    v_cmp_le_i32 s[72:73], 8, v4
    v_cmp_le_i32 s[74:75], 9, v4
    v_cmp_le_i32 s[76:77], 10, v4
    v_cmp_le_i32 s[78:79], 11, v4
    v_cmp_le_i32 s[80:81], 16, v4
    v_cmp_le_i32 s[82:83], 17, v4
    v_cmp_le_i32 s[84:85], 18, v4
    v_cmp_le_i32 s[86:87], 19, v4
    v_cmp_le_i32 s[88:89], 24, v4
    v_cmp_le_i32 s[90:91], 25, v4
    v_cmp_le_i32 s[92:93], 26, v4
    v_cmp_le_i32 s[94:95], 27, v4
    s_waitcnt lgkmcnt(0)
    s_mov_b32 s16, s4
    s_mov_b32 s17, s5
    s_mov_b32 s56, s50
    s_mov_b32 s57, s51
    s_mov_b32 s58, 256
    s_mov_b32 s59, 0x20000
    s_mov_b32 s52, s32
    s_mov_b32 s53, s33
    s_mov_b32 s54, 2359296
    s_mov_b32 s55, 0x20000
    s_mov_b32 s60, 0x3f803f80
    s_or_b32 s24, s2, s3
    s_cmp_lg_u32 s24, 0
    s_cbranch_scc1 L_nononce
    s_or_b32 s22, s22, 1
    v_mov_b32 v4, s22
    s_mov_b64 exec, 1
    buffer_store_dword v4, off, s[56:59], 0 sc1
    s_mov_b64 exec, -1
L_nononce:
    v_and_b32 v4, 0x13, v2
    v_and_b32 v5, 4, v2
    v_lshl_or_b32 v4, v5, 1, v4
    v_and_b32 v5, 8, v2
    v_lshrrev_b32 v5, 1, v5
    v_or_b32 v12, v4, v5
    v_lshlrev_b32 v12, 1, v12
    v_mov_b32 v11, 0x40000
    s_mov_b32 s100, 0x40000000
    s_mov_b32 s101, 0
    s_cmp_ge_u32 s2, 252
    s_cbranch_scc1 L_pn
    s_cmp_ge_u32 s2, 180
    s_cbranch_scc1 L_po
    s_cmp_ge_u32 s2, 36
    s_cbranch_scc1 L_pb
    s_mov_b32 s8, s34
    s_mov_b32 s9, s35
    s_mov_b32 s10, 663552
    s_mul_i32 s22, s2, 18432
    s_lshl_b32 s23, s3, 10
    s_add_u32 s22, s22, s23
    s_add_u32 m0, s23, 114688
    s_nop 0
    buffer_load_dwordx4 v1, s[8:11], s22 offen lds
    s_add_u32 m0, m0, 8192
    s_add_u32 s22, s22, 8192
    s_nop 0
    buffer_load_dwordx4 v1, s[8:11], s22 offen lds
    s_cmp_ge_u32 s3, 4
    s_cbranch_scc1 L_pa1
    s_cmp_ge_u32 s3, 2
    s_cbranch_scc1 L_pa0
    s_add_u32 m0, m0, 8192
    s_add_u32 s22, s22, 8192
    s_nop 0
    buffer_load_dwordx4 v1, s[8:11], s22 offen lds
    s_branch L_pa1
L_pa0:
    s_cmp_eq_u32 s3, 2
    s_cselect_b32 s8, s36, s38
    s_cselect_b32 s9, s37, s39
    s_mov_b32 s10, 20736
    s_mul_i32 s22, s2, 576
    s_add_u32 m0, m0, 8192
    s_nop 0
    buffer_load_dwordx4 v1, s[8:11], s22 offen lds
L_pa1:
    s_call_b64 s[30:31], L_x0
    v_mul_u32_u24 v10, 9216, v3
    v_add_u32 v10, 114688, v10
    s_add_u32 s22, s3, 0
    s_mul_i32 s23, s22, 86
    s_lshr_b32 s23, s23, 8
    s_mul_i32 s24, s23, 3
    s_sub_u32 s24, s22, s24
    s_mul_i32 s23, s23, 144
    s_mul_i32 s25, s24, 72
    s_cmp_eq_u32 s24, 2
    s_cselect_b32 s25, 32, s25
    s_cselect_b32 s26, 1, 4
    s_cselect_b32 s27, 1, 15
    s_cselect_b32 s28, 8, 32
    s_add_u32 s23, s23, s25
    v_lshrrev_b32 v4, s26, v2
    v_mul_u32_u24 v4, 36, v4
    v_and_b32 v5, s27, v2
    v_lshl_add_u32 v4, v5, 1, v4
    v_add3_u32 v4, v4, v10, s23
    v_cmp_gt_u32 vcc, s28, v2
    s_nop 1
    v_cndmask_b32 v4, v11, v4, vcc
    ds_read_u16 v24, v4 offset:0
    ds_read_u16 v25, v4 offset:1152
    ds_read_u16 v26, v4 offset:2304
    ds_read_u16 v27, v4 offset:3456
    ds_read_u16 v28, v4 offset:4608
    ds_read_u16 v29, v4 offset:5760
    ds_read_u16 v30, v4 offset:6912
    ds_read_u16 v31, v4 offset:8064
    s_add_u32 s22, s3, 8
    s_mul_i32 s23, s22, 86
    s_lshr_b32 s23, s23, 8
    s_mul_i32 s24, s23, 3
    s_sub_u32 s24, s22, s24
    s_mul_i32 s23, s23, 144
    s_mul_i32 s25, s24, 72
    s_cmp_eq_u32 s24, 2
    s_cselect_b32 s25, 32, s25
    s_cselect_b32 s26, 1, 4
    s_cselect_b32 s27, 1, 15
    s_cselect_b32 s28, 8, 32
    s_add_u32 s23, s23, s25
    v_lshrrev_b32 v4, s26, v2
    v_mul_u32_u24 v4, 36, v4
    v_and_b32 v5, s27, v2
    v_lshl_add_u32 v4, v5, 1, v4
    v_add3_u32 v4, v4, v10, s23
    v_cmp_gt_u32 vcc, s28, v2
    s_nop 1
    v_cndmask_b32 v4, v11, v4, vcc
    ds_read_u16 v32, v4 offset:0
    ds_read_u16 v33, v4 offset:1152
    ds_read_u16 v34, v4 offset:2304
    ds_read_u16 v35, v4 offset:3456
    ds_read_u16 v36, v4 offset:4608
    ds_read_u16 v37, v4 offset:5760
    ds_read_u16 v38, v4 offset:6912
    ds_read_u16 v39, v4 offset:8064
    s_add_u32 s22, s3, 16
    s_mul_i32 s23, s22, 86
    s_lshr_b32 s23, s23, 8
    s_mul_i32 s24, s23, 3
    s_sub_u32 s24, s22, s24
    s_mul_i32 s23, s23, 144
    s_mul_i32 s25, s24, 72
    s_cmp_eq_u32 s24, 2
    s_cselect_b32 s25, 32, s25
    s_cselect_b32 s26, 1, 4
    s_cselect_b32 s27, 1, 15
    s_cselect_b32 s28, 8, 32
    s_add_u32 s23, s23, s25
    v_lshrrev_b32 v4, s26, v2
    v_mul_u32_u24 v4, 36, v4
    v_and_b32 v5, s27, v2
    v_lshl_add_u32 v4, v5, 1, v4
    v_add3_u32 v4, v4, v10, s23
    v_cmp_gt_u32 vcc, s28, v2
    s_nop 1
    v_cndmask_b32 v4, v11, v4, vcc
    ds_read_u16 v40, v4 offset:0
    ds_read_u16 v41, v4 offset:1152
    ds_read_u16 v42, v4 offset:2304
    ds_read_u16 v43, v4 offset:3456
    ds_read_u16 v44, v4 offset:4608
    ds_read_u16 v45, v4 offset:5760
    ds_read_u16 v46, v4 offset:6912
    ds_read_u16 v47, v4 offset:8064
    v_lshlrev_b32 v4, 1, v2
    s_cmp_eq_u32 s3, 1
    s_cselect_b64 vcc, -1, 0
    s_lshl_b32 s23, s3, 10
    s_add_u32 s23, s23, 133120
    v_cndmask_b32 v4, v4, v12, vcc
    v_mul_u32_u24 v5, 288, v3
    v_add3_u32 v4, v4, v5, s23
    v_cmp_gt_u32 vcc, 18, v2
    s_nop 1
    v_cndmask_b32 v4, v11, v4, vcc
    s_waitcnt lgkmcnt(0)
    ds_read_u16 v48, v4 offset:0
    ds_read_u16 v49, v4 offset:36
    ds_read_u16 v50, v4 offset:72
    ds_read_u16 v51, v4 offset:108
    ds_read_u16 v52, v4 offset:144
    ds_read_u16 v53, v4 offset:180
    ds_read_u16 v54, v4 offset:216
    ds_read_u16 v55, v4 offset:252
    s_mul_i32 s22, s3, 36864
    s_lshl_b32 s23, s2, 10
    s_add_u32 s22, s22, s23
    s_add_u32 s22, s22, 0xb00000
    v_lshl_or_b32 v64, v25, 16, v24
    v_lshl_or_b32 v65, v27, 16, v26
    v_lshl_or_b32 v66, v29, 16, v28
    v_lshl_or_b32 v67, v31, 16, v30
    buffer_store_dwordx4 v[64:67], v1, s[4:7], s22 offen sc1
    s_add_u32 s22, s22, 294912
    v_lshl_or_b32 v68, v33, 16, v32
    v_lshl_or_b32 v69, v35, 16, v34
    v_lshl_or_b32 v70, v37, 16, v36
    v_lshl_or_b32 v71, v39, 16, v38
    buffer_store_dwordx4 v[68:71], v1, s[4:7], s22 offen sc1
    s_add_u32 s22, s22, 294912
    v_lshl_or_b32 v72, v41, 16, v40
    v_lshl_or_b32 v73, v43, 16, v42
    v_lshl_or_b32 v74, v45, 16, v44
    v_lshl_or_b32 v75, v47, 16, v46
    buffer_store_dwordx4 v[72:75], v1, s[4:7], s22 offen sc1
    s_add_u32 s22, s22, 294912
    s_cmp_ge_u32 s3, 2
    s_cbranch_scc1 L_prep_done
    s_waitcnt lgkmcnt(0)
    v_lshl_or_b32 v76, v49, 16, v48
    v_lshl_or_b32 v77, v51, 16, v50
    v_lshl_or_b32 v78, v53, 16, v52
    v_lshl_or_b32 v79, v55, 16, v54
    buffer_store_dwordx4 v[76:79], v1, s[4:7], s22 offen sc1
    s_branch L_prep_done
L_x0:
    s_and_b32 s24, s13, 8
    s_cmp_eq_u32 s24, 0
    s_cbranch_scc1 L_x0b
    s_cmp_lt_u32 s13, 16
    s_cselect_b32 s24, s36, s38
    s_cselect_b32 s25, s37, s39
    s_mov_b32 s26, 20736
    s_mov_b32 s27, 0x20000
    s_lshl_b32 s21, s3, 10
    s_add_u32 m0, s21, 135168
    s_nop 0
    buffer_load_dwordx4 v1, s[24:27], s21 offen lds
    s_add_u32 m0, m0, 8192
    s_add_u32 s21, s21, 8192
    s_nop 0
    buffer_load_dwordx4 v1, s[24:27], s21 offen lds
    s_add_u32 m0, m0, 8192
    s_add_u32 s21, s21, 8192
    s_nop 0
    buffer_load_dwordx4 v1, s[24:27], s21 offen lds
L_x0b:
    s_and_b32 s24, s13, 3
    s_lshl_b32 s24, s24, 1
    s_lshl_b32 s25, s12, 3
    s_add_u32 s24, s24, s25
    s_mul_i32 s24, s24, 36864
    s_mul_i32 s25, s3, 9216
    s_add_u32 s24, s24, s25
    s_lshr_b32 s25, s3, 2
    s_mul_i32 s25, s25, 36864
    s_and_b32 s26, s3, 3
    s_lshl_b32 s27, s26, 10
    s_add_u32 s25, s25, s27
    s_add_u32 m0, s25, 40960
    s_and_b32 s26, s26, 1
    s_lshl_b32 s26, s26, 2
    v_lshrrev_b32 v13, 7, v1
    v_lshrrev_b32 v9, 1, v13
    v_add_u32 v9, s26, v9
    v_bfe_u32 v8, v1, 4, 3
    v_xor_b32 v9, v8, v9
    v_mul_u32_u24 v13, 1152, v13
    v_lshl_add_u32 v13, v9, 4, v13
    buffer_load_dwordx4 v13, s[52:55], s24 offen lds
    s_add_u32 m0, m0, 4096
    s_add_u32 s24, s24, 128
    buffer_load_dwordx4 v13, s[52:55], s24 offen lds
    s_add_u32 m0, m0, 4096
    s_add_u32 s24, s24, 128
    buffer_load_dwordx4 v13, s[52:55], s24 offen lds
    s_add_u32 m0, m0, 4096
    s_add_u32 s24, s24, 128
    buffer_load_dwordx4 v13, s[52:55], s24 offen lds
    s_add_u32 m0, m0, 4096
    s_add_u32 s24, s24, 128
    buffer_load_dwordx4 v13, s[52:55], s24 offen lds
    s_add_u32 m0, m0, 4096
    s_add_u32 s24, s24, 128
    buffer_load_dwordx4 v13, s[52:55], s24 offen lds
    s_add_u32 m0, m0, 4096
    s_add_u32 s24, s24, 128
    buffer_load_dwordx4 v13, s[52:55], s24 offen lds
    s_add_u32 m0, m0, 4096
    s_add_u32 s24, s24, 128
    buffer_load_dwordx4 v13, s[52:55], s24 offen lds
    s_add_u32 m0, m0, 4096
    s_add_u32 s24, s24, 128
    buffer_load_dwordx4 v13, s[52:55], s24 offen lds
    s_waitcnt vmcnt(9)
    s_barrier
    buffer_load_dword v101, off, s[56:59], 0 sc1
    s_setpc_b64 s[30:31]
L_pb:
    s_mov_b32 s8, s44
    s_mov_b32 s9, s45
    s_mov_b32 s10, 1990656
    s_sub_u32 s28, s2, 36
    s_and_b32 s29, s28, 3
    s_lshr_b32 s28, s28, 2
    s_mul_i32 s22, s28, 55296
    s_mul_i32 s23, s29, 288
    s_add_u32 s22, s22, s23
    s_lshl_b32 s23, s3, 10
    s_add_u32 m0, s23, 114688
    v_add_u32 v4, 0, v0
    v_mul_u32_u24 v5, 607, v4
    v_lshrrev_b32 v5, 15, v5
    v_mul_u32_u24 v6, 54, v5
    v_sub_u32 v4, v4, v6
    v_mul_u32_u24 v6, 57, v4
    v_lshrrev_b32 v6, 10, v6
    v_mul_u32_u24 v6, 864, v6
    v_lshl_add_u32 v4, v4, 4, v6
    v_mul_u32_u24 v5, 3456, v5
    v_add_u32 v4, v4, v5
    buffer_load_dwordx4 v4, s[8:11], s22 offen lds
    s_add_u32 m0, m0, 8192
    v_add_u32 v4, 512, v0
    v_mul_u32_u24 v5, 607, v4
    v_lshrrev_b32 v5, 15, v5
    v_mul_u32_u24 v6, 54, v5
    v_sub_u32 v4, v4, v6
    v_mul_u32_u24 v6, 57, v4
    v_lshrrev_b32 v6, 10, v6
    v_mul_u32_u24 v6, 864, v6
    v_lshl_add_u32 v4, v4, 4, v6
    v_mul_u32_u24 v5, 3456, v5
    v_add_u32 v4, v4, v5
    buffer_load_dwordx4 v4, s[8:11], s22 offen lds
    s_call_b64 s[30:31], L_x0
    v_mul_u32_u24 v10, 6912, v3
    s_mul_i32 s23, s3, 36
    s_add_u32 s23, s23, 114688
    v_add_u32 v10, s23, v10
    v_lshrrev_b32 v4, 4, v2
    v_mul_u32_u24 v4, 288, v4
    v_and_b32 v5, 15, v2
    v_lshl_add_u32 v4, v5, 1, v4
    v_add_u32 v4, v4, v10
    ds_read_u16 v24, v4 offset:0
    ds_read_u16 v25, v4 offset:864
    ds_read_u16 v26, v4 offset:1728
    ds_read_u16 v27, v4 offset:2592
    ds_read_u16 v28, v4 offset:3456
    ds_read_u16 v29, v4 offset:4320
    ds_read_u16 v30, v4 offset:5184
    ds_read_u16 v31, v4 offset:6048
    v_add_u32 v4, 576, v12
    v_cmp_gt_u32 vcc, 18, v2
    v_bfe_u32 v5, v2, 1, 1
    v_mul_u32_u24 v5, 288, v5
    v_cndmask_b32 v4, v11, v4, vcc
    v_and_b32 v6, 1, v2
    v_lshl_add_u32 v5, v6, 1, v5
    v_lshrrev_b32 v6, 2, v2
    v_cmp_eq_u32 vcc, 6, v6
    v_add_u32 v5, 32, v5
    s_nop 0
    v_cndmask_b32 v4, v4, v5, vcc
    v_add_u32 v4, v4, v10
    ds_read_u16 v32, v4 offset:0
    ds_read_u16 v33, v4 offset:864
    ds_read_u16 v34, v4 offset:1728
    ds_read_u16 v35, v4 offset:2592
    ds_read_u16 v36, v4 offset:3456
    ds_read_u16 v37, v4 offset:4320
    ds_read_u16 v38, v4 offset:5184
    ds_read_u16 v39, v4 offset:6048
    s_lshl_b32 s22, s29, 3
    s_add_u32 s22, s22, s3
    s_mul_i32 s22, s22, 73728
    s_lshl_b32 s23, s28, 10
    s_add_u32 s22, s22, s23
    s_add_u32 s22, s22, 0xc00000
    s_mov_b32 s100, s22
    s_mov_b32 s101, 36864
    s_waitcnt lgkmcnt(0)
    v_lshl_or_b32 v16, v25, 16, v24
    v_lshl_or_b32 v17, v27, 16, v26
    v_lshl_or_b32 v18, v29, 16, v28
    v_lshl_or_b32 v19, v31, 16, v30
    v_lshl_or_b32 v20, v33, 16, v32
    v_lshl_or_b32 v21, v35, 16, v34
    v_lshl_or_b32 v22, v37, 16, v36
    v_lshl_or_b32 v23, v39, 16, v38
    s_branch L_prep_done
L_po:
    s_cmp_ge_u32 s2, 216
    s_cselect_b32 s8, s46, s40
    s_cselect_b32 s9, s47, s41
    s_cselect_b32 s28, 36, 0
    s_cselect_b32 s29, 16, 15
    s_mov_b32 s10, 663552
    s_sub_u32 s28, s2, s28
    s_sub_u32 s28, s28, 180
    s_mul_i32 s22, s28, 20736
    s_sub_u32 s23, s28, 32
    s_mul_i32 s23, s23, 165888
    s_add_u32 s23, s23, 18432
    s_cmp_ge_u32 s28, 32
    s_cselect_b32 s22, s23, s22
    s_cselect_b32 s24, 18432, 0
    s_lshl_b32 s23, s3, 10
    s_add_u32 m0, s23, 114688
    v_add_u32 v4, 0, v0
    v_mul_u32_u24 v5, 1821, v4
    v_lshrrev_b32 v5, 18, v5
    v_mul_lo_u32 v5, v5, s24
    v_lshl_add_u32 v4, v4, 4, v5
    buffer_load_dwordx4 v4, s[8:11], s22 offen lds
    s_add_u32 m0, m0, 8192
    v_add_u32 v4, 512, v0
    v_mul_u32_u24 v5, 1821, v4
    v_lshrrev_b32 v5, 18, v5
    v_mul_lo_u32 v5, v5, s24
    v_lshl_add_u32 v4, v4, 4, v5
    buffer_load_dwordx4 v4, s[8:11], s22 offen lds
    s_add_u32 m0, m0, 8192
    s_cmp_ge_u32 s3, 2
    s_cbranch_scc1 L_po1
    v_add_u32 v4, 1024, v0
    v_mul_u32_u24 v5, 1821, v4
    v_lshrrev_b32 v5, 18, v5
    v_mul_lo_u32 v5, v5, s24
    v_lshl_add_u32 v4, v4, 4, v5
    buffer_load_dwordx4 v4, s[8:11], s22 offen lds
L_po1:
    s_call_b64 s[30:31], L_x0
    v_mul_u32_u24 v10, 9216, v3
    s_lshl_b32 s23, s3, 6
    s_add_u32 s23, s23, 114688
    v_add3_u32 v4, v10, v12, s23
    ds_read_u16 v24, v4 offset:0
    ds_read_u16 v25, v4 offset:1152
    ds_read_u16 v26, v4 offset:2304
    ds_read_u16 v27, v4 offset:3456
    ds_read_u16 v28, v4 offset:4608
    ds_read_u16 v29, v4 offset:5760
    ds_read_u16 v30, v4 offset:6912
    ds_read_u16 v31, v4 offset:8064
    v_add_u32 v4, 512, v4
    ds_read_u16 v32, v4 offset:0
    ds_read_u16 v33, v4 offset:1152
    ds_read_u16 v34, v4 offset:2304
    ds_read_u16 v35, v4 offset:3456
    ds_read_u16 v36, v4 offset:4608
    ds_read_u16 v37, v4 offset:5760
    ds_read_u16 v38, v4 offset:6912
    ds_read_u16 v39, v4 offset:8064
    v_add_u32 v4, 512, v4
    s_waitcnt lgkmcnt(0)
    ds_read_u16 v40, v4 offset:0
    ds_read_u16 v41, v4 offset:1152
    ds_read_u16 v42, v4 offset:2304
    ds_read_u16 v43, v4 offset:3456
    ds_read_u16 v44, v4 offset:4608
    ds_read_u16 v45, v4 offset:5760
    ds_read_u16 v46, v4 offset:6912
    ds_read_u16 v47, v4 offset:8064
    v_add_u32 v4, 512, v4
    s_lshl_b32 s29, s29, 20
    s_mul_i32 s22, s3, 36864
    s_lshl_b32 s23, s28, 10
    s_add_u32 s22, s22, s23
    s_add_u32 s22, s22, s29
    s_mov_b32 s100, s22
    s_mov_b32 s101, 294912
    s_waitcnt lgkmcnt(0)
    v_lshl_or_b32 v16, v25, 16, v24
    v_lshl_or_b32 v17, v27, 16, v26
    v_lshl_or_b32 v18, v29, 16, v28
    v_lshl_or_b32 v19, v31, 16, v30
    v_lshl_or_b32 v20, v33, 16, v32
    v_lshl_or_b32 v21, v35, 16, v34
    v_lshl_or_b32 v22, v37, 16, v36
    v_lshl_or_b32 v23, v39, 16, v38
    v_lshl_or_b32 v112, v41, 16, v40
    v_lshl_or_b32 v113, v43, 16, v42
    v_lshl_or_b32 v114, v45, 16, v44
    v_lshl_or_b32 v115, v47, 16, v46
    s_branch L_prep_done
L_pn:
    s_call_b64 s[30:31], L_x0
L_prep_done:
    s_and_b32 s24, s13, 8
    s_cmp_eq_u32 s24, 0
    s_cbranch_scc1 L_pd_nokv
    v_lshlrev_b32 v4, 1, v2
    s_cmp_ge_u32 s13, 16
    s_cselect_b64 vcc, -1, 0
    s_mul_i32 s23, s3, 576
    s_add_u32 s23, s23, 135168
    v_cndmask_b32 v4, v4, v12, vcc
    v_mul_u32_u24 v5, 288, v3
    v_add3_u32 v4, v4, v5, s23
    v_cmp_gt_u32 vcc, 18, v2
    s_lshl_b32 s23, s3, 10
    v_add_u32 v5, s23, v1
    v_cndmask_b32 v4, v11, v4, vcc
    ds_read_u16 v24, v4 offset:0
    ds_read_u16 v25, v4 offset:36
    ds_read_u16 v26, v4 offset:72
    ds_read_u16 v27, v4 offset:108
    ds_read_u16 v28, v4 offset:144
    ds_read_u16 v29, v4 offset:180
    ds_read_u16 v30, v4 offset:216
    ds_read_u16 v31, v4 offset:252
    ds_read_u16 v32, v4 offset:4608
    ds_read_u16 v33, v4 offset:4644
    ds_read_u16 v34, v4 offset:4680
    ds_read_u16 v35, v4 offset:4716
    ds_read_u16 v36, v4 offset:4752
    ds_read_u16 v37, v4 offset:4788
    ds_read_u16 v38, v4 offset:4824
    ds_read_u16 v39, v4 offset:4860
    s_waitcnt lgkmcnt(0)
    ds_read_u16 v40, v4 offset:9216
    ds_read_u16 v41, v4 offset:9252
    ds_read_u16 v42, v4 offset:9288
    ds_read_u16 v43, v4 offset:9324
    ds_read_u16 v44, v4 offset:9360
    ds_read_u16 v45, v4 offset:9396
    ds_read_u16 v46, v4 offset:9432
    ds_read_u16 v47, v4 offset:9468
    ds_read_u16 v48, v4 offset:13824
    ds_read_u16 v49, v4 offset:13860
    ds_read_u16 v50, v4 offset:13896
    ds_read_u16 v51, v4 offset:13932
    ds_read_u16 v52, v4 offset:13968
    ds_read_u16 v53, v4 offset:14004
    ds_read_u16 v54, v4 offset:14040
    ds_read_u16 v55, v4 offset:14076
    s_waitcnt lgkmcnt(0)
    ds_read_u16 v56, v4 offset:18432
    ds_read_u16 v57, v4 offset:18468
    ds_read_u16 v58, v4 offset:18504
    ds_read_u16 v59, v4 offset:18540
    ds_read_u16 v60, v4 offset:18576
    ds_read_u16 v61, v4 offset:18612
    ds_read_u16 v62, v4 offset:18648
    ds_read_u16 v63, v4 offset:18684
    s_waitcnt lgkmcnt(0)
    v_lshl_or_b32 v24, v25, 16, v24
    v_lshl_or_b32 v25, v27, 16, v26
    v_lshl_or_b32 v26, v29, 16, v28
    v_lshl_or_b32 v27, v31, 16, v30
    ds_write_b128 v5, v[24:27] offset:0
    v_lshl_or_b32 v32, v33, 16, v32
    v_lshl_or_b32 v33, v35, 16, v34
    v_lshl_or_b32 v34, v37, 16, v36
    v_lshl_or_b32 v35, v39, 16, v38
    ds_write_b128 v5, v[32:35] offset:8192
    v_lshl_or_b32 v40, v41, 16, v40
    v_lshl_or_b32 v41, v43, 16, v42
    v_lshl_or_b32 v42, v45, 16, v44
    v_lshl_or_b32 v43, v47, 16, v46
    ds_write_b128 v5, v[40:43] offset:16384
    v_lshl_or_b32 v48, v49, 16, v48
    v_lshl_or_b32 v49, v51, 16, v50
    v_lshl_or_b32 v50, v53, 16, v52
    v_lshl_or_b32 v51, v55, 16, v54
    ds_write_b128 v5, v[48:51] offset:24576
    v_lshl_or_b32 v56, v57, 16, v56
    v_lshl_or_b32 v57, v59, 16, v58
    v_lshl_or_b32 v58, v61, 16, v60
    v_lshl_or_b32 v59, v63, 16, v62
    ds_write_b128 v5, v[56:59] offset:32768
L_pd_nokv:
    s_mov_b32 s8, s48
    s_mov_b32 s9, s49
    s_mov_b32 s10, 2359296
    v_mov_b32 v5, 162816
    s_cmp_lg_u32 s3, 7
    s_cbranch_scc1 L_pd_w
    s_mov_b32 s21, 0
    s_waitcnt vmcnt(0)
    v_mov_b32 v4, v101
    v_cmp_eq_u32 vcc, 0, v101
    s_cbranch_vccz L_pd_got
L_pd_poll:
    buffer_load_dword v4, off, s[56:59], 0 sc1
    s_add_u32 s21, s21, 1
    s_cmp_gt_u32 s21, s20
    s_waitcnt vmcnt(0)
    s_cbranch_scc1 L_pd_got
    v_cmp_eq_u32 vcc, 0, v4
    s_cbranch_vccnz L_pd_poll
L_pd_got:
    ds_write_b32 v5, v4
    v_mov_b32 v4, 0
    ds_write_b32 v5, v4 offset:4
    ds_write_b32 v5, v4 offset:8
L_pd_w:
    s_waitcnt vmcnt(0) lgkmcnt(0)
    s_barrier
    s_mov_b32 s33, 0
    ds_read_b32 v14, v5
    s_waitcnt lgkmcnt(0)
    v_readfirstlane_b32 s14, v14
    s_getreg_b32 s34, hwreg(HW_REG_XCC_ID)
    s_lshl_b32 s34, s34, 1
    s_add_u32 s34, s34, s14
    s_cmp_lg_u32 s3, 1
    s_cbranch_scc1 L_nocensus
    v_mov_b32 v5, s34
    v_lshlrev_b32 v4, 3, v1
    s_lshl_b32 s22, s12, 12
    s_lshl_b32 s23, s13, 7
    s_add_u32 s22, s22, s23
    s_add_u32 s22, s22, 0x510014
    s_mov_b64 exec, 1
    buffer_store_dword v5, off, s[4:7], s22 sc1
    s_mul_i32 s22, s12, 18944
    s_mul_i32 s23, s13, 640
    s_add_u32 s22, s22, s23
    s_add_u32 s22, s22, 0xad0000
    s_mov_b64 exec, 31
    buffer_load_dword v100, v4, s[4:7], s22 offen sc1
    s_mov_b64 exec, -1
L_nocensus:
    s_cmp_lg_u32 s3, 3
    s_cbranch_scc1 L_pd_noflag
    s_cmp_ge_u32 s2, 36
    s_cbranch_scc1 L_pd_noflag
    s_lshl_b32 s22, s2, 7
    s_add_u32 s22, s22, 0x10c0000
    s_mov_b64 exec, 1
    buffer_store_dword v14, off, s[4:7], s22 sc1
    s_mov_b64 exec, -1
L_pd_noflag:
L_it:
    s_and_b32 s45, s13, 3
    s_lshl_b32 s45, s45, 1
    s_lshl_b32 s46, s12, 3
    s_add_u32 s45, s45, s46
    s_lshr_b32 s46, s13, 2
    s_cmp_ge_u32 s3, 5
    s_cbranch_scc1 L_A_q2
    s_cmp_eq_u32 s3, 4
    s_cbranch_scc1 L_A_kv
    s_cmp_ge_u32 s3, 2
    s_cbranch_scc1 L_A_st
    s_add_u32 s22, s45, s3
    s_cmp_eq_u32 s15, 0
    s_cbranch_scc1 L_A_ld3
    s_lshl_b32 s23, s22, 9
    s_add_u32 s23, s23, 0x510010
    v_lshlrev_b32 v5, 3, v1
    s_mov_b64 exec, 15
    s_mov_b32 s21, 0
Lp_1:
    buffer_load_dword v4, v5, s[16:19], s23 offen sc1
    s_add_u32 s21, s21, 1
    s_cmp_gt_u32 s21, s20
    s_cselect_b32 s20, 0, s20
    s_waitcnt vmcnt(0)
    s_cbranch_scc1 Lpd_2
    v_cmp_ne_u32 vcc, s14, v4
    s_cbranch_vccnz Lp_1
Lpd_2:
    s_mov_b64 exec, -1
    s_mul_i32 s22, s22, 36864
    s_add_u32 s22, s22, 0x600000
    s_mul_i32 s23, s3, 36864
    s_add_u32 m0, s23, 40960
    s_nop 0
    buffer_load_dwordx4 v1, s[4:7], s22 offen sc1 lds
    s_add_u32 m0, m0, 1024
    s_add_u32 s22, s22, 1024
    s_nop 0
    buffer_load_dwordx4 v1, s[4:7], s22 offen sc1 lds
    s_add_u32 m0, m0, 1024
    s_add_u32 s22, s22, 1024
    s_nop 0
    buffer_load_dwordx4 v1, s[4:7], s22 offen sc1 lds
    s_add_u32 m0, m0, 1024
    s_add_u32 s22, s22, 1024
    s_nop 0
    buffer_load_dwordx4 v1, s[4:7], s22 offen sc1 lds
    s_add_u32 m0, m0, 1024
    s_add_u32 s22, s22, 1024
    s_nop 0
    buffer_load_dwordx4 v1, s[4:7], s22 offen sc1 lds
    s_add_u32 m0, m0, 1024
    s_add_u32 s22, s22, 1024
    s_nop 0
    buffer_load_dwordx4 v1, s[4:7], s22 offen sc1 lds
    s_add_u32 m0, m0, 1024
    s_add_u32 s22, s22, 1024
    s_nop 0
    buffer_load_dwordx4 v1, s[4:7], s22 offen sc1 lds
    s_add_u32 m0, m0, 1024
    s_add_u32 s22, s22, 1024
    s_nop 0
    buffer_load_dwordx4 v1, s[4:7], s22 offen sc1 lds
    s_add_u32 m0, m0, 1024
    s_add_u32 s22, s22, 1024
    s_nop 0
    buffer_load_dwordx4 v1, s[4:7], s22 offen sc1 lds
    s_add_u32 m0, m0, 1024
    s_add_u32 s22, s22, 1024
    s_nop 0
    buffer_load_dwordx4 v1, s[4:7], s22 offen sc1 lds
    s_add_u32 m0, m0, 1024
    s_add_u32 s22, s22, 1024
    s_nop 0
    buffer_load_dwordx4 v1, s[4:7], s22 offen sc1 lds
    s_add_u32 m0, m0, 1024
    s_add_u32 s22, s22, 1024
    s_nop 0
    buffer_load_dwordx4 v1, s[4:7], s22 offen sc1 lds
    s_add_u32 m0, m0, 1024
    s_add_u32 s22, s22, 1024
    s_nop 0
    buffer_load_dwordx4 v1, s[4:7], s22 offen sc1 lds
    s_add_u32 m0, m0, 1024
    s_add_u32 s22, s22, 1024
    s_nop 0
    buffer_load_dwordx4 v1, s[4:7], s22 offen sc1 lds
    s_add_u32 m0, m0, 1024
    s_add_u32 s22, s22, 1024
    s_nop 0
    buffer_load_dwordx4 v1, s[4:7], s22 offen sc1 lds
    s_add_u32 m0, m0, 1024
    s_add_u32 s22, s22, 1024
    s_nop 0
    buffer_load_dwordx4 v1, s[4:7], s22 offen sc1 lds
    s_add_u32 m0, m0, 1024
    s_add_u32 s22, s22, 1024
    s_nop 0
    buffer_load_dwordx4 v1, s[4:7], s22 offen sc1 lds
    s_add_u32 m0, m0, 1024
    s_add_u32 s22, s22, 1024
    s_nop 0
    buffer_load_dwordx4 v1, s[4:7], s22 offen sc1 lds
    s_add_u32 m0, m0, 1024
    s_add_u32 s22, s22, 1024
    s_nop 0
    buffer_load_dwordx4 v1, s[4:7], s22 offen sc1 lds
    s_add_u32 m0, m0, 1024
    s_add_u32 s22, s22, 1024
    s_nop 0
    buffer_load_dwordx4 v1, s[4:7], s22 offen sc1 lds
    s_add_u32 m0, m0, 1024
    s_add_u32 s22, s22, 1024
    s_nop 0
    buffer_load_dwordx4 v1, s[4:7], s22 offen sc1 lds
    s_add_u32 m0, m0, 1024
    s_add_u32 s22, s22, 1024
    s_nop 0
    buffer_load_dwordx4 v1, s[4:7], s22 offen sc1 lds
    s_add_u32 m0, m0, 1024
    s_add_u32 s22, s22, 1024
    s_nop 0
    buffer_load_dwordx4 v1, s[4:7], s22 offen sc1 lds
    s_add_u32 m0, m0, 1024
    s_add_u32 s22, s22, 1024
    s_nop 0
    buffer_load_dwordx4 v1, s[4:7], s22 offen sc1 lds
    s_add_u32 m0, m0, 1024
    s_add_u32 s22, s22, 1024
    s_nop 0
    buffer_load_dwordx4 v1, s[4:7], s22 offen sc1 lds
    s_add_u32 m0, m0, 1024
    s_add_u32 s22, s22, 1024
    s_nop 0
    buffer_load_dwordx4 v1, s[4:7], s22 offen sc1 lds
    s_add_u32 m0, m0, 1024
    s_add_u32 s22, s22, 1024
    s_nop 0
    buffer_load_dwordx4 v1, s[4:7], s22 offen sc1 lds
    s_add_u32 m0, m0, 1024
    s_add_u32 s22, s22, 1024
    s_nop 0
    buffer_load_dwordx4 v1, s[4:7], s22 offen sc1 lds
    s_add_u32 m0, m0, 1024
    s_add_u32 s22, s22, 1024
    s_nop 0
    buffer_load_dwordx4 v1, s[4:7], s22 offen sc1 lds
    s_add_u32 m0, m0, 1024
    s_add_u32 s22, s22, 1024
    s_nop 0
    buffer_load_dwordx4 v1, s[4:7], s22 offen sc1 lds
    s_add_u32 m0, m0, 1024
    s_add_u32 s22, s22, 1024
    s_nop 0
    buffer_load_dwordx4 v1, s[4:7], s22 offen sc1 lds
    s_add_u32 m0, m0, 1024
    s_add_u32 s22, s22, 1024
    s_nop 0
    buffer_load_dwordx4 v1, s[4:7], s22 offen sc1 lds
    s_add_u32 m0, m0, 1024
    s_add_u32 s22, s22, 1024
    s_nop 0
    buffer_load_dwordx4 v1, s[4:7], s22 offen sc1 lds
    s_add_u32 m0, m0, 1024
    s_add_u32 s22, s22, 1024
    s_nop 0
    buffer_load_dwordx4 v1, s[4:7], s22 offen sc1 lds
    s_add_u32 m0, m0, 1024
    s_add_u32 s22, s22, 1024
    s_nop 0
    buffer_load_dwordx4 v1, s[4:7], s22 offen sc1 lds
    s_add_u32 m0, m0, 1024
    s_add_u32 s22, s22, 1024
    s_nop 0
    buffer_load_dwordx4 v1, s[4:7], s22 offen sc1 lds
L_A_ld2:
    s_waitcnt vmcnt(24)
    s_barrier
    s_waitcnt vmcnt(12)
    s_barrier
    s_waitcnt vmcnt(0)
    s_barrier
L_A_ld3:
    s_cmp_lg_u32 s3, 0
    s_cbranch_scc1 L_A_q
    s_lshl_b32 s23, s12, 12
    s_add_u32 s23, s23, 0x510000
    v_lshlrev_b32 v5, 3, v1
    s_mov_b32 exec_lo, 0xffff
    s_mov_b32 exec_hi, 0x0
    s_mov_b32 s21, 0
Lp_3:
    buffer_load_dword v4, v5, s[16:19], s23 offen sc1
    s_add_u32 s21, s21, 1
    s_cmp_gt_u32 s21, s20
    s_cselect_b32 s20, 0, s20
    s_waitcnt vmcnt(0)
    s_cbranch_scc1 Lpd_4
    v_cmp_ne_u32 vcc, s14, v4
    s_cbranch_vccnz Lp_3
Lpd_4:
    s_mov_b64 exec, -1
    s_mul_i32 s22, s12, 18944
    s_add_u32 s22, s22, 0xad0000
    s_mov_b32 m0, 0
    s_nop 0
    buffer_load_dwordx4 v1, s[4:7], s22 offen sc1 lds
    s_add_u32 m0, m0, 1024
    s_add_u32 s22, s22, 1024
    s_nop 0
    buffer_load_dwordx4 v1, s[4:7], s22 offen sc1 lds
    s_add_u32 m0, m0, 1024
    s_add_u32 s22, s22, 1024
    s_nop 0
    buffer_load_dwordx4 v1, s[4:7], s22 offen sc1 lds
    s_add_u32 m0, m0, 1024
    s_add_u32 s22, s22, 1024
    s_nop 0
    buffer_load_dwordx4 v1, s[4:7], s22 offen sc1 lds
    s_add_u32 m0, m0, 1024
    s_add_u32 s22, s22, 1024
    s_nop 0
    buffer_load_dwordx4 v1, s[4:7], s22 offen sc1 lds
    s_add_u32 m0, m0, 1024
    s_add_u32 s22, s22, 1024
    s_nop 0
    buffer_load_dwordx4 v1, s[4:7], s22 offen sc1 lds
    s_add_u32 m0, m0, 1024
    s_add_u32 s22, s22, 1024
    s_nop 0
    buffer_load_dwordx4 v1, s[4:7], s22 offen sc1 lds
    s_add_u32 m0, m0, 1024
    s_add_u32 s22, s22, 1024
    s_nop 0
    buffer_load_dwordx4 v1, s[4:7], s22 offen sc1 lds
    s_add_u32 m0, m0, 1024
    s_add_u32 s22, s22, 1024
    s_nop 0
    buffer_load_dwordx4 v1, s[4:7], s22 offen sc1 lds
    s_add_u32 m0, m0, 1024
    s_add_u32 s22, s22, 1024
    s_nop 0
    buffer_load_dwordx4 v1, s[4:7], s22 offen sc1 lds
    s_add_u32 m0, m0, 1024
    s_add_u32 s22, s22, 1024
    s_nop 0
    buffer_load_dwordx4 v1, s[4:7], s22 offen sc1 lds
    s_add_u32 m0, m0, 1024
    s_add_u32 s22, s22, 1024
    s_nop 0
    buffer_load_dwordx4 v1, s[4:7], s22 offen sc1 lds
    s_add_u32 m0, m0, 1024
    s_add_u32 s22, s22, 1024
    s_nop 0
    buffer_load_dwordx4 v1, s[4:7], s22 offen sc1 lds
    s_add_u32 m0, m0, 1024
    s_add_u32 s22, s22, 1024
    s_nop 0
    buffer_load_dwordx4 v1, s[4:7], s22 offen sc1 lds
    s_add_u32 m0, m0, 1024
    s_add_u32 s22, s22, 1024
    s_nop 0
    buffer_load_dwordx4 v1, s[4:7], s22 offen sc1 lds
    s_add_u32 m0, m0, 1024
    s_add_u32 s22, s22, 1024
    s_nop 0
    buffer_load_dwordx4 v1, s[4:7], s22 offen sc1 lds
    s_add_u32 m0, m0, 1024
    s_add_u32 s22, s22, 1024
    s_nop 0
    buffer_load_dwordx4 v1, s[4:7], s22 offen sc1 lds
    s_add_u32 m0, m0, 1024
    s_add_u32 s22, s22, 1024
    s_nop 0
    buffer_load_dwordx4 v1, s[4:7], s22 offen sc1 lds
    s_add_u32 m0, m0, 1024
    s_add_u32 s22, s22, 1024
    s_mov_b32 exec_hi, 0
    buffer_load_dwordx4 v1, s[4:7], s22 offen sc1 lds
    s_mov_b64 exec, -1
    s_waitcnt vmcnt(0)
    s_branch L_A_q
L_A_idle:
    s_cmp_eq_u32 s15, 0
    s_cbranch_scc1 L_A_q
    s_barrier
    s_barrier
    s_barrier
    s_branch L_A_q
L_A_st:
    s_sub_u32 s24, s3, 2
    s_cmp_eq_u32 s15, 0
    s_cbranch_scc0 L_A_st1
    s_mul_i32 s25, s24, 36864
    s_add_u32 s25, s25, 40960
    s_cmp_eq_u32 s15, 0
    s_cbranch_scc1 Lxa_5
    v_add_u32 v40, s25, v1
    v_add_u32 v41, 1024, v40
    v_add_u32 v42, 2048, v40
    v_add_u32 v43, 3072, v40
    s_branch Lxe_6
Lxa_5:
    v_bfe_u32 v4, v2, 1, 3
    v_xor_b32 v4, v4, v3
    v_lshlrev_b32 v43, 7, v2
    v_add_u32 v43, s25, v43
    v_lshl_add_u32 v40, v4, 4, v43
    v_xor_b32 v4, 2, v4
    v_lshl_add_u32 v41, v4, 4, v43
    v_xor_b32 v4, 6, v4
    v_lshl_add_u32 v42, v4, 4, v43
    v_xor_b32 v4, 2, v4
    v_lshl_add_u32 v43, v4, 4, v43
Lxe_6:
    v_mov_b32 v88, 0
    v_mov_b32 v89, 0
    v_mov_b32 v90, 0
    v_mov_b32 v91, 0
    s_mov_b32 s25, 0
L_A_st0:
    ds_read_b128 v[116:119], v40 offset:0
    ds_read_b128 v[120:123], v41 offset:0
    ds_read_b128 v[124:127], v42 offset:0
    ds_read_b128 v[128:131], v43 offset:0
    ds_read_b128 v[132:135], v40 offset:4096
    ds_read_b128 v[136:139], v41 offset:4096
    ds_read_b128 v[140:143], v42 offset:4096
    ds_read_b128 v[144:147], v43 offset:4096
    ds_read_b128 v[148:151], v40 offset:8192
    ds_read_b128 v[152:155], v41 offset:8192
    ds_read_b128 v[156:159], v42 offset:8192
    ds_read_b128 v[160:163], v43 offset:8192
    s_waitcnt lgkmcnt(11)
    v_dot2_f32_bf16 v88, v116, s60, v88
    v_dot2_f32_bf16 v89, v116, v116, v89
    v_dot2_f32_bf16 v90, v117, s60, v90
    v_dot2_f32_bf16 v91, v117, v117, v91
    v_dot2_f32_bf16 v88, v118, s60, v88
    v_dot2_f32_bf16 v89, v118, v118, v89
    v_dot2_f32_bf16 v90, v119, s60, v90
    v_dot2_f32_bf16 v91, v119, v119, v91
    s_waitcnt lgkmcnt(10)
    v_dot2_f32_bf16 v88, v120, s60, v88
    v_dot2_f32_bf16 v89, v120, v120, v89
    v_dot2_f32_bf16 v90, v121, s60, v90
    v_dot2_f32_bf16 v91, v121, v121, v91
    v_dot2_f32_bf16 v88, v122, s60, v88
    v_dot2_f32_bf16 v89, v122, v122, v89
    v_dot2_f32_bf16 v90, v123, s60, v90
    v_dot2_f32_bf16 v91, v123, v123, v91
    s_waitcnt lgkmcnt(9)
    v_dot2_f32_bf16 v88, v124, s60, v88
    v_dot2_f32_bf16 v89, v124, v124, v89
    v_dot2_f32_bf16 v90, v125, s60, v90
    v_dot2_f32_bf16 v91, v125, v125, v91
    v_dot2_f32_bf16 v88, v126, s60, v88
    v_dot2_f32_bf16 v89, v126, v126, v89
    v_dot2_f32_bf16 v90, v127, s60, v90
    v_dot2_f32_bf16 v91, v127, v127, v91
    s_waitcnt lgkmcnt(8)
    v_dot2_f32_bf16 v88, v128, s60, v88
    v_dot2_f32_bf16 v89, v128, v128, v89
    v_dot2_f32_bf16 v90, v129, s60, v90
    v_dot2_f32_bf16 v91, v129, v129, v91
    v_dot2_f32_bf16 v88, v130, s60, v88
    v_dot2_f32_bf16 v89, v130, v130, v89
    v_dot2_f32_bf16 v90, v131, s60, v90
    v_dot2_f32_bf16 v91, v131, v131, v91
    s_waitcnt lgkmcnt(7)
    v_dot2_f32_bf16 v88, v132, s60, v88
    v_dot2_f32_bf16 v89, v132, v132, v89
    v_dot2_f32_bf16 v90, v133, s60, v90
    v_dot2_f32_bf16 v91, v133, v133, v91
    v_dot2_f32_bf16 v88, v134, s60, v88
    v_dot2_f32_bf16 v89, v134, v134, v89
    v_dot2_f32_bf16 v90, v135, s60, v90
    v_dot2_f32_bf16 v91, v135, v135, v91
    s_waitcnt lgkmcnt(6)
    v_dot2_f32_bf16 v88, v136, s60, v88
    v_dot2_f32_bf16 v89, v136, v136, v89
    v_dot2_f32_bf16 v90, v137, s60, v90
    v_dot2_f32_bf16 v91, v137, v137, v91
    v_dot2_f32_bf16 v88, v138, s60, v88
    v_dot2_f32_bf16 v89, v138, v138, v89
    v_dot2_f32_bf16 v90, v139, s60, v90
    v_dot2_f32_bf16 v91, v139, v139, v91
    s_waitcnt lgkmcnt(5)
    v_dot2_f32_bf16 v88, v140, s60, v88
    v_dot2_f32_bf16 v89, v140, v140, v89
    v_dot2_f32_bf16 v90, v141, s60, v90
    v_dot2_f32_bf16 v91, v141, v141, v91
    v_dot2_f32_bf16 v88, v142, s60, v88
    v_dot2_f32_bf16 v89, v142, v142, v89
    v_dot2_f32_bf16 v90, v143, s60, v90
    v_dot2_f32_bf16 v91, v143, v143, v91
    s_waitcnt lgkmcnt(4)
    v_dot2_f32_bf16 v88, v144, s60, v88
    v_dot2_f32_bf16 v89, v144, v144, v89
    v_dot2_f32_bf16 v90, v145, s60, v90
    v_dot2_f32_bf16 v91, v145, v145, v91
    v_dot2_f32_bf16 v88, v146, s60, v88
    v_dot2_f32_bf16 v89, v146, v146, v89
    v_dot2_f32_bf16 v90, v147, s60, v90
    v_dot2_f32_bf16 v91, v147, v147, v91
    s_waitcnt lgkmcnt(3)
    v_dot2_f32_bf16 v88, v148, s60, v88
    v_dot2_f32_bf16 v89, v148, v148, v89
    v_dot2_f32_bf16 v90, v149, s60, v90
    v_dot2_f32_bf16 v91, v149, v149, v91
    v_dot2_f32_bf16 v88, v150, s60, v88
    v_dot2_f32_bf16 v89, v150, v150, v89
    v_dot2_f32_bf16 v90, v151, s60, v90
    v_dot2_f32_bf16 v91, v151, v151, v91
    s_waitcnt lgkmcnt(2)
    v_dot2_f32_bf16 v88, v152, s60, v88
    v_dot2_f32_bf16 v89, v152, v152, v89
    v_dot2_f32_bf16 v90, v153, s60, v90
    v_dot2_f32_bf16 v91, v153, v153, v91
    v_dot2_f32_bf16 v88, v154, s60, v88
    v_dot2_f32_bf16 v89, v154, v154, v89
    v_dot2_f32_bf16 v90, v155, s60, v90
    v_dot2_f32_bf16 v91, v155, v155, v91
    s_waitcnt lgkmcnt(1)
    v_dot2_f32_bf16 v88, v156, s60, v88
    v_dot2_f32_bf16 v89, v156, v156, v89
    v_dot2_f32_bf16 v90, v157, s60, v90
    v_dot2_f32_bf16 v91, v157, v157, v91
    v_dot2_f32_bf16 v88, v158, s60, v88
    v_dot2_f32_bf16 v89, v158, v158, v89
    v_dot2_f32_bf16 v90, v159, s60, v90
    v_dot2_f32_bf16 v91, v159, v159, v91
    s_waitcnt lgkmcnt(0)
    v_dot2_f32_bf16 v88, v160, s60, v88
    v_dot2_f32_bf16 v89, v160, v160, v89
    v_dot2_f32_bf16 v90, v161, s60, v90
    v_dot2_f32_bf16 v91, v161, v161, v91
    v_dot2_f32_bf16 v88, v162, s60, v88
    v_dot2_f32_bf16 v89, v162, v162, v89
    v_dot2_f32_bf16 v90, v163, s60, v90
    v_dot2_f32_bf16 v91, v163, v163, v91
    v_add_u32 v40, 12288, v40
    v_add_u32 v41, 12288, v41
    v_add_u32 v42, 12288, v42
    v_add_u32 v43, 12288, v43
    s_add_u32 s25, s25, 1
    s_cmp_lt_u32 s25, 3
    s_cbranch_scc1 L_A_st0
    v_add_f32 v88, v88, v90
    v_add_f32 v89, v89, v91
    s_nop 1
    v_permlane32_swap_b32 v88, v89
    s_nop 1
    v_add_f32 v88, v88, v89
    s_branch L_A_st2
L_A_st1:
    s_add_u32 s25, s45, s24
    s_barrier
    v_lshrrev_b32 v4, 2, v1
    s_mul_i32 s40, s25, 4608
    s_add_u32 s40, s40, 0xa80000
    buffer_load_dword v88, v4, s[4:7], s40 offen offset:0 sc1
    buffer_load_dword v89, v4, s[4:7], s40 offen offset:256 sc1
    buffer_load_dword v90, v4, s[4:7], s40 offen offset:512 sc1
    buffer_load_dword v91, v4, s[4:7], s40 offen offset:768 sc1
    buffer_load_dword v92, v4, s[4:7], s40 offen offset:1024 sc1
    buffer_load_dword v93, v4, s[4:7], s40 offen offset:1280 sc1
    buffer_load_dword v94, v4, s[4:7], s40 offen offset:1536 sc1
    buffer_load_dword v95, v4, s[4:7], s40 offen offset:1792 sc1
    buffer_load_dword v96, v4, s[4:7], s40 offen offset:2048 sc1
    buffer_load_dword v97, v4, s[4:7], s40 offen offset:2304 sc1
    buffer_load_dword v98, v4, s[4:7], s40 offen offset:2560 sc1
    buffer_load_dword v99, v4, s[4:7], s40 offen offset:2816 sc1
    buffer_load_dword v100, v4, s[4:7], s40 offen offset:3072 sc1
    buffer_load_dword v101, v4, s[4:7], s40 offen offset:3328 sc1
    buffer_load_dword v102, v4, s[4:7], s40 offen offset:3584 sc1
    buffer_load_dword v103, v4, s[4:7], s40 offen offset:3840 sc1
    s_add_u32 s40, s40, 4096
    buffer_load_dword v104, v4, s[4:7], s40 offen offset:0 sc1
    buffer_load_dword v105, v4, s[4:7], s40 offen offset:256 sc1
    s_barrier
    s_waitcnt vmcnt(0)
    v_add_f32 v88, v88, v97
    v_add_f32 v89, v89, v98
    v_add_f32 v90, v90, v99
    v_add_f32 v91, v91, v100
    v_add_f32 v92, v92, v101
    v_add_f32 v93, v93, v102
    v_add_f32 v94, v94, v103
    v_add_f32 v95, v95, v104
    v_add_f32 v96, v96, v105
    v_add_f32 v88, v88, v89
    v_add_f32 v90, v90, v91
    v_add_f32 v92, v92, v93
    v_add_f32 v94, v94, v95
    v_add_f32 v88, v88, v90
    v_add_f32 v92, v92, v94
    v_add_f32 v88, v88, v92
    v_add_f32 v88, v88, v96
L_A_st2:
    v_mov_b32 v89, v88
    s_nop 1
    v_permlane32_swap_b32 v88, v89
    s_nop 1
    v_mul_f32 v88, 0x3ae38e39, v88
    v_mul_f32 v89, 0x3ae38e39, v89
    v_fma_f32 v89, -v88, v88, v89
    v_max_f32 v89, 0, v89
    v_cvt_pk_bf16_f32 v8, -v88, -v88
    v_mov_b32 v9, 0
    v_cvt_pk_bf16_f32 v89, v89, v89
    v_lshlrev_b32 v89, 16, v89
    v_add_f32 v89, 0x3727c5ac, v89
    v_cvt_pk_bf16_f32 v89, v89, v89
    v_lshlrev_b32 v89, 16, v89
    v_sqrt_f32 v89, v89
    s_nop 0
    v_cvt_pk_bf16_f32 v89, v89, v89
    v_lshlrev_b32 v89, 16, v89
    v_rcp_f32 v12, v89
    s_nop 0
    s_lshl_b32 s24, s24, 8
    s_add_u32 s24, s24, 160768
    v_lshl_add_u32 v4, v2, 2, s24
    ds_write_b32 v4, v12
    ds_write_b32 v4, v8 offset:128
    s_waitcnt lgkmcnt(0)
    s_cmp_eq_u32 s15, 0
    s_cbranch_scc1 L_A_st3
    s_barrier
    s_branch L_A_q
L_A_st3:
    v_mov_b32 v5, 162824
    v_mov_b32 v6, 1
    s_mov_b64 exec, 1
    ds_add_u32 v5, v6
    s_mov_b64 exec, -1
    s_branch L_A_q
L_A_kv:
    s_and_b32 s24, s46, 2
    s_cmp_eq_u32 s24, 0
    s_cbranch_scc1 L_A_idle
    s_and_b32 s24, s46, 1
    s_add_u32 s47, s45, s24
    s_lshl_b32 s27, s24, 8
    s_add_u32 s27, s27, 160768
    s_mul_i32 s24, s24, 36864
    s_add_u32 s24, s24, 40960
    s_cmp_eq_u32 s15, 0
    s_cbranch_scc1 Lxa_7
    v_add_u32 v40, s24, v1
    v_add_u32 v41, 1024, v40
    v_add_u32 v42, 2048, v40
    v_add_u32 v43, 3072, v40
    s_branch Lxe_8
Lxa_7:
    v_bfe_u32 v4, v2, 1, 3
    v_xor_b32 v4, v4, v3
    v_lshlrev_b32 v43, 7, v2
    v_add_u32 v43, s24, v43
    v_lshl_add_u32 v40, v4, 4, v43
    v_xor_b32 v4, 2, v4
    v_lshl_add_u32 v41, v4, 4, v43
    v_xor_b32 v4, 6, v4
    v_lshl_add_u32 v42, v4, 4, v43
    v_xor_b32 v4, 2, v4
    v_lshl_add_u32 v43, v4, 4, v43
Lxe_8:
    v_lshl_add_u32 v6, v2, 2, s27
    v_lshl_add_u32 v5, v3, 4, s27
    s_lshr_b32 s28, s47, 2
    s_mul_i32 s28, s28, 9472
    s_add_u32 s28, s28, 0x0
    s_and_b32 s29, s47, 3
    s_setprio 3
    s_waitcnt vmcnt(0)
    s_cmp_eq_u32 s15, 0
    s_cbranch_scc0 L_A_kv1
    ds_read_b128 v[112:115], v1 offset:0
    ds_read_b128 v[116:119], v1 offset:1024
    ds_read_b128 v[120:123], v1 offset:2048
    ds_read_b128 v[124:127], v1 offset:3072
    ds_read_b128 v[128:131], v1 offset:4096
    ds_read_b128 v[132:135], v1 offset:5120
    ds_read_b128 v[136:139], v1 offset:6144
    ds_read_b128 v[140:143], v1 offset:7168
    ds_read_b128 v[144:147], v1 offset:8192
    ds_read_b128 v[148:151], v1 offset:9216
    ds_read_b128 v[152:155], v1 offset:10240
    ds_read_b128 v[156:159], v1 offset:11264
    s_waitcnt lgkmcnt(0)
    ds_read_b128 v[160:163], v1 offset:12288
    ds_read_b128 v[164:167], v1 offset:13312
    ds_read_b128 v[168:171], v1 offset:14336
    ds_read_b128 v[172:175], v1 offset:15360
    ds_read_b128 v[176:179], v1 offset:16384
    ds_read_b128 v[180:183], v1 offset:17408
    ds_read_b128 v[184:187], v1 offset:18432
    ds_read_b128 v[188:191], v1 offset:19456
    ds_read_b128 v[192:195], v1 offset:20480
    ds_read_b128 v[196:199], v1 offset:21504
    ds_read_b128 v[200:203], v1 offset:22528
    ds_read_b128 v[204:207], v1 offset:23552
    s_waitcnt lgkmcnt(0)
    ds_read_b128 v[208:211], v1 offset:24576
    ds_read_b128 v[212:215], v1 offset:25600
    ds_read_b128 v[216:219], v1 offset:26624
    ds_read_b128 v[220:223], v1 offset:27648
    ds_read_b128 v[224:227], v1 offset:28672
    ds_read_b128 v[228:231], v1 offset:29696
    ds_read_b128 v[232:235], v1 offset:30720
    ds_read_b128 v[236:239], v1 offset:31744
    ds_read_b128 v[240:243], v1 offset:32768
    ds_read_b128 v[244:247], v1 offset:33792
    ds_read_b128 v[248:251], v1 offset:34816
    ds_read_b128 v[252:255], v1 offset:35840
    s_waitcnt lgkmcnt(0)
L_A_kv1:
    s_cmp_ge_u32 s46, 4
    s_cbranch_scc1 L_A_v
    v_mov_b32 v9, 0
    v_mov_b32 v11, 0
    s_cmp_eq_u32 s15, 0
    s_cbranch_scc1 Lb_9
    s_barrier
Lb_9:
    ds_read_b128 v[56:59], v40 offset:0
    ds_read_b128 v[60:63], v41 offset:0
    ds_read_b128 v[64:67], v42 offset:0
    ds_read_b128 v[68:71], v43 offset:0
    ds_read_b128 v[72:75], v40 offset:4096
    ds_read_b128 v[76:79], v41 offset:4096
    ds_read_b128 v[80:83], v42 offset:4096
    ds_read_b128 v[84:87], v43 offset:4096
    s_waitcnt lgkmcnt(7)
    v_mfma_f32_32x32x16_bf16 v[24:39], v[112:115], v[56:59], 0
    ds_read_b128 v[56:59], v40 offset:8192
    s_waitcnt lgkmcnt(7)
    v_mfma_f32_32x32x16_bf16 v[24:39], v[116:119], v[60:63], v[24:39]
    ds_read_b128 v[60:63], v41 offset:8192
    s_waitcnt lgkmcnt(7)
    v_mfma_f32_32x32x16_bf16 v[24:39], v[120:123], v[64:67], v[24:39]
    ds_read_b128 v[64:67], v42 offset:8192
    s_waitcnt lgkmcnt(7)
    v_mfma_f32_32x32x16_bf16 v[24:39], v[124:127], v[68:71], v[24:39]
    ds_read_b128 v[68:71], v43 offset:8192
    s_waitcnt lgkmcnt(7)
    v_mfma_f32_32x32x16_bf16 v[24:39], v[128:131], v[72:75], v[24:39]
    s_cmp_eq_u32 s15, 0
    s_cbranch_scc1 Lb_10
    s_barrier
Lb_10:
    ds_read_b128 v[72:75], v40 offset:12288
    s_waitcnt lgkmcnt(7)
    v_mfma_f32_32x32x16_bf16 v[24:39], v[132:135], v[76:79], v[24:39]
    ds_read_b128 v[76:79], v41 offset:12288
    s_waitcnt lgkmcnt(7)
    v_mfma_f32_32x32x16_bf16 v[24:39], v[136:139], v[80:83], v[24:39]
    ds_read_b128 v[80:83], v42 offset:12288
    s_waitcnt lgkmcnt(7)
    v_mfma_f32_32x32x16_bf16 v[24:39], v[140:143], v[84:87], v[24:39]
    ds_read_b128 v[84:87], v43 offset:12288
    s_waitcnt lgkmcnt(7)
    v_mfma_f32_32x32x16_bf16 v[24:39], v[144:147], v[56:59], v[24:39]
    ds_read_b128 v[56:59], v40 offset:16384
    s_waitcnt lgkmcnt(7)
    v_mfma_f32_32x32x16_bf16 v[24:39], v[148:151], v[60:63], v[24:39]
    ds_read_b128 v[60:63], v41 offset:16384
    s_waitcnt lgkmcnt(7)
    v_mfma_f32_32x32x16_bf16 v[24:39], v[152:155], v[64:67], v[24:39]
    ds_read_b128 v[64:67], v42 offset:16384
    s_waitcnt lgkmcnt(7)
    v_mfma_f32_32x32x16_bf16 v[24:39], v[156:159], v[68:71], v[24:39]
    ds_read_b128 v[68:71], v43 offset:16384
    s_waitcnt lgkmcnt(7)
    v_mfma_f32_32x32x16_bf16 v[24:39], v[160:163], v[72:75], v[24:39]
    v_lshlrev_b32 v45, 7, v2
    s_lshl_b32 s22, s12, 12
    s_add_u32 s22, s22, 0x510014
    buffer_load_dword v44, v45, s[4:7], s22 offen sc1
    ds_read_b128 v[72:75], v40 offset:20480
    s_waitcnt lgkmcnt(7)
    v_mfma_f32_32x32x16_bf16 v[24:39], v[164:167], v[76:79], v[24:39]
    ds_read_b128 v[76:79], v41 offset:20480
    s_waitcnt lgkmcnt(7)
    v_mfma_f32_32x32x16_bf16 v[24:39], v[168:171], v[80:83], v[24:39]
    ds_read_b128 v[80:83], v42 offset:20480
    s_waitcnt lgkmcnt(7)
    v_mfma_f32_32x32x16_bf16 v[24:39], v[172:175], v[84:87], v[24:39]
    ds_read_b128 v[84:87], v43 offset:20480
    s_waitcnt lgkmcnt(7)
    v_mfma_f32_32x32x16_bf16 v[24:39], v[176:179], v[56:59], v[24:39]
    s_cmp_eq_u32 s15, 0
    s_cbranch_scc1 Lb_11
    s_barrier
Lb_11:
    ds_read_b32 v12, v6
    ds_read_b32 v8, v6 offset:128
    ds_read_b128 v[56:59], v40 offset:24576
    s_waitcnt lgkmcnt(7)
    v_mfma_f32_32x32x16_bf16 v[24:39], v[180:183], v[60:63], v[24:39]
    ds_read_b128 v[60:63], v41 offset:24576
    s_waitcnt lgkmcnt(7)
    v_mfma_f32_32x32x16_bf16 v[24:39], v[184:187], v[64:67], v[24:39]
    ds_read_b128 v[64:67], v42 offset:24576
    s_waitcnt lgkmcnt(7)
    v_mfma_f32_32x32x16_bf16 v[24:39], v[188:191], v[68:71], v[24:39]
    ds_read_b128 v[68:71], v43 offset:24576
    s_waitcnt lgkmcnt(7)
    v_mfma_f32_32x32x16_bf16 v[24:39], v[192:195], v[72:75], v[24:39]
    ds_read_b128 v[72:75], v40 offset:28672
    s_waitcnt lgkmcnt(7)
    v_mfma_f32_32x32x16_bf16 v[24:39], v[196:199], v[76:79], v[24:39]
    ds_read_b128 v[76:79], v41 offset:28672
    s_waitcnt lgkmcnt(7)
    v_mfma_f32_32x32x16_bf16 v[24:39], v[200:203], v[80:83], v[24:39]
    ds_read_b128 v[80:83], v42 offset:28672
    s_waitcnt lgkmcnt(7)
    v_mfma_f32_32x32x16_bf16 v[24:39], v[204:207], v[84:87], v[24:39]
    ds_read_b128 v[84:87], v43 offset:28672
    s_waitcnt lgkmcnt(7)
    v_mfma_f32_32x32x16_bf16 v[24:39], v[208:211], v[56:59], v[24:39]
    ds_read_b128 v[56:59], v40 offset:32768
    s_waitcnt lgkmcnt(7)
    v_mfma_f32_32x32x16_bf16 v[24:39], v[212:215], v[60:63], v[24:39]
    ds_read_b128 v[60:63], v41 offset:32768
    s_waitcnt lgkmcnt(7)
    v_mfma_f32_32x32x16_bf16 v[24:39], v[216:219], v[64:67], v[24:39]
    ds_read_b128 v[64:67], v42 offset:32768
    s_waitcnt lgkmcnt(7)
    v_mfma_f32_32x32x16_bf16 v[24:39], v[220:223], v[68:71], v[24:39]
    ds_read_b128 v[68:71], v43 offset:32768
    s_waitcnt lgkmcnt(7)
    v_mfma_f32_32x32x16_bf16 v[24:39], v[224:227], v[72:75], v[24:39]
    s_waitcnt lgkmcnt(6)
    v_mfma_f32_32x32x16_bf16 v[24:39], v[228:231], v[76:79], v[24:39]
    s_waitcnt lgkmcnt(5)
    v_mfma_f32_32x32x16_bf16 v[24:39], v[232:235], v[80:83], v[24:39]
    s_waitcnt lgkmcnt(4)
    v_mfma_f32_32x32x16_bf16 v[24:39], v[236:239], v[84:87], v[24:39]
    s_waitcnt lgkmcnt(3)
    v_mfma_f32_32x32x16_bf16 v[24:39], v[240:243], v[56:59], v[24:39]
    s_waitcnt lgkmcnt(2)
    v_mfma_f32_32x32x16_bf16 v[24:39], v[244:247], v[60:63], v[24:39]
    s_waitcnt lgkmcnt(1)
    v_mfma_f32_32x32x16_bf16 v[24:39], v[248:251], v[64:67], v[24:39]
    s_waitcnt lgkmcnt(0)
    v_mfma_f32_32x32x16_bf16 v[24:39], v[252:255], v[68:71], v[24:39]
    s_cmp_eq_u32 s15, 0
    s_cbranch_scc0 Lst_12
    s_call_b64 s[30:31], L_A_cs
    v_mov_b32 v46, v5
    v_mov_b32 v47, v6
    s_mov_b32 s50, 162824
    s_mov_b32 s51, 2
    s_call_b64 s[30:31], L_B_wait
    v_mov_b32 v5, v46
    v_mov_b32 v6, v47
    ds_read_b32 v12, v6
    ds_read_b32 v8, v6 offset:128
    s_waitcnt lgkmcnt(0)
Lst_12:
    v_mfma_f32_32x32x8_bf16 v[24:39], v[110:111], v[8:9], v[24:39]
    s_lshl_b32 s30, s29, 10
    s_add_u32 s30, s30, s28
    s_add_u32 s31, s30, 0xad0000
    s_lshr_b32 s24, s29, 1
    s_lshl_b32 s24, s24, 8
    s_and_b32 s25, s29, 1
    s_lshl_b32 s25, s25, 2
    s_add_u32 s24, s24, s25
    s_add_u32 s24, s24, s28
    s_add_u32 s24, s24, 4096
    s_add_u32 s25, s24, 0xad0000
    v_lshlrev_b32 v4, 30, v3
    v_lshl_add_u32 v4, v2, 3, v4
    v_mul_f32 v24, v12, v24
    v_mul_f32 v25, v12, v25
    v_mul_f32 v26, v12, v26
    v_mul_f32 v27, v12, v27
    v_mul_f32 v28, v12, v28
    v_mul_f32 v29, v12, v29
    v_mul_f32 v30, v12, v30
    v_mul_f32 v31, v12, v31
    v_mul_f32 v32, v12, v32
    v_mul_f32 v33, v12, v33
    v_cvt_pk_bf16_f32 v24, v24, v25
    v_cvt_pk_bf16_f32 v25, v26, v27
    v_cvt_pk_bf16_f32 v26, v28, v29
    v_cvt_pk_bf16_f32 v27, v30, v31
    v_cvt_pk_bf16_f32 v28, v32, v33
    s_waitcnt vmcnt(0)
    v_cmp_ne_u32 vcc, s34, v44
    s_cmp_eq_u64 vcc, 0
    s_cselect_b32 s99, 1, 2
    s_cmp_eq_u32 s99, 1
    s_cbranch_scc1 Ls_13
    buffer_store_dwordx4 v[24:27], v1, s[4:7], s31 offen sc1
    buffer_store_dword v28, v4, s[4:7], s25 offen sc1
    s_branch Lse_14
Ls_13:
    buffer_store_dwordx4 v[24:27], v1, s[4:7], s31 offen
    buffer_store_dword v28, v4, s[4:7], s25 offen
Lse_14:
    s_add_u32 s30, s30, s33
    s_add_u32 s24, s24, s33
    buffer_store_dwordx4 v[24:27], v1, s[16:19], s30 offen sc1
    buffer_store_dword v28, v4, s[16:19], s24 offen sc1
    s_mov_b32 s26, 0
    s_branch L_A_kvflag
L_A_v:
    v_mov_b32 v9, 0
    v_mov_b32 v11, 0
    s_cmp_eq_u32 s15, 0
    s_cbranch_scc1 Lb_15
    s_barrier
Lb_15:
    ds_read_b128 v[56:59], v40 offset:0
    ds_read_b128 v[60:63], v41 offset:0
    ds_read_b128 v[64:67], v42 offset:0
    ds_read_b128 v[68:71], v43 offset:0
    ds_read_b128 v[72:75], v40 offset:4096
    ds_read_b128 v[76:79], v41 offset:4096
    ds_read_b128 v[80:83], v42 offset:4096
    ds_read_b128 v[84:87], v43 offset:4096
    s_waitcnt lgkmcnt(7)
    v_mfma_f32_32x32x16_bf16 v[24:39], v[56:59], v[112:115], 0
    ds_read_b128 v[56:59], v40 offset:8192
    s_waitcnt lgkmcnt(7)
    v_mfma_f32_32x32x16_bf16 v[24:39], v[60:63], v[116:119], v[24:39]
    ds_read_b128 v[60:63], v41 offset:8192
    s_waitcnt lgkmcnt(7)
    v_mfma_f32_32x32x16_bf16 v[24:39], v[64:67], v[120:123], v[24:39]
    ds_read_b128 v[64:67], v42 offset:8192
    s_waitcnt lgkmcnt(7)
    v_mfma_f32_32x32x16_bf16 v[24:39], v[68:71], v[124:127], v[24:39]
    ds_read_b128 v[68:71], v43 offset:8192
    s_waitcnt lgkmcnt(7)
    v_mfma_f32_32x32x16_bf16 v[24:39], v[72:75], v[128:131], v[24:39]
    s_cmp_eq_u32 s15, 0
    s_cbranch_scc1 Lb_16
    s_barrier
Lb_16:
    ds_read_b128 v[72:75], v40 offset:12288
    s_waitcnt lgkmcnt(7)
    v_mfma_f32_32x32x16_bf16 v[24:39], v[76:79], v[132:135], v[24:39]
    ds_read_b128 v[76:79], v41 offset:12288
    s_waitcnt lgkmcnt(7)
    v_mfma_f32_32x32x16_bf16 v[24:39], v[80:83], v[136:139], v[24:39]
    ds_read_b128 v[80:83], v42 offset:12288
    s_waitcnt lgkmcnt(7)
    v_mfma_f32_32x32x16_bf16 v[24:39], v[84:87], v[140:143], v[24:39]
    ds_read_b128 v[84:87], v43 offset:12288
    s_waitcnt lgkmcnt(7)
    v_mfma_f32_32x32x16_bf16 v[24:39], v[56:59], v[144:147], v[24:39]
    ds_read_b128 v[56:59], v40 offset:16384
    s_waitcnt lgkmcnt(7)
    v_mfma_f32_32x32x16_bf16 v[24:39], v[60:63], v[148:151], v[24:39]
    ds_read_b128 v[60:63], v41 offset:16384
    s_waitcnt lgkmcnt(7)
    v_mfma_f32_32x32x16_bf16 v[24:39], v[64:67], v[152:155], v[24:39]
    ds_read_b128 v[64:67], v42 offset:16384
    s_waitcnt lgkmcnt(7)
    v_mfma_f32_32x32x16_bf16 v[24:39], v[68:71], v[156:159], v[24:39]
    ds_read_b128 v[68:71], v43 offset:16384
    s_waitcnt lgkmcnt(7)
    v_mfma_f32_32x32x16_bf16 v[24:39], v[72:75], v[160:163], v[24:39]
    v_lshlrev_b32 v45, 7, v2
    s_lshl_b32 s22, s12, 12
    s_add_u32 s22, s22, 0x510014
    buffer_load_dword v44, v45, s[4:7], s22 offen sc1
    ds_read_b128 v[72:75], v40 offset:20480
    s_waitcnt lgkmcnt(7)
    v_mfma_f32_32x32x16_bf16 v[24:39], v[76:79], v[164:167], v[24:39]
    ds_read_b128 v[76:79], v41 offset:20480
    s_waitcnt lgkmcnt(7)
    v_mfma_f32_32x32x16_bf16 v[24:39], v[80:83], v[168:171], v[24:39]
    ds_read_b128 v[80:83], v42 offset:20480
    s_waitcnt lgkmcnt(7)
    v_mfma_f32_32x32x16_bf16 v[24:39], v[84:87], v[172:175], v[24:39]
    ds_read_b128 v[84:87], v43 offset:20480
    s_waitcnt lgkmcnt(7)
    v_mfma_f32_32x32x16_bf16 v[24:39], v[56:59], v[176:179], v[24:39]
    s_cmp_eq_u32 s15, 0
    s_cbranch_scc1 Lb_17
    s_barrier
Lb_17:
    ds_read_b32 v8, v6 offset:128
    ds_read_b128 v[88:91], v5 offset:0
    ds_read_b128 v[92:95], v5 offset:32
    ds_read_b128 v[96:99], v5 offset:64
    ds_read_b128 v[100:103], v5 offset:96
    ds_read_b128 v[56:59], v40 offset:24576
    s_waitcnt lgkmcnt(7)
    v_mfma_f32_32x32x16_bf16 v[24:39], v[60:63], v[180:183], v[24:39]
    ds_read_b128 v[60:63], v41 offset:24576
    s_waitcnt lgkmcnt(7)
    v_mfma_f32_32x32x16_bf16 v[24:39], v[64:67], v[184:187], v[24:39]
    ds_read_b128 v[64:67], v42 offset:24576
    s_waitcnt lgkmcnt(7)
    v_mfma_f32_32x32x16_bf16 v[24:39], v[68:71], v[188:191], v[24:39]
    ds_read_b128 v[68:71], v43 offset:24576
    s_waitcnt lgkmcnt(7)
    v_mfma_f32_32x32x16_bf16 v[24:39], v[72:75], v[192:195], v[24:39]
    ds_read_b128 v[72:75], v40 offset:28672
    s_waitcnt lgkmcnt(7)
    v_mfma_f32_32x32x16_bf16 v[24:39], v[76:79], v[196:199], v[24:39]
    ds_read_b128 v[76:79], v41 offset:28672
    s_waitcnt lgkmcnt(7)
    v_mfma_f32_32x32x16_bf16 v[24:39], v[80:83], v[200:203], v[24:39]
    ds_read_b128 v[80:83], v42 offset:28672
    s_waitcnt lgkmcnt(7)
    v_mfma_f32_32x32x16_bf16 v[24:39], v[84:87], v[204:207], v[24:39]
    ds_read_b128 v[84:87], v43 offset:28672
    s_waitcnt lgkmcnt(7)
    v_mfma_f32_32x32x16_bf16 v[24:39], v[56:59], v[208:211], v[24:39]
    ds_read_b128 v[56:59], v40 offset:32768
    s_waitcnt lgkmcnt(7)
    v_mfma_f32_32x32x16_bf16 v[24:39], v[60:63], v[212:215], v[24:39]
    ds_read_b128 v[60:63], v41 offset:32768
    s_waitcnt lgkmcnt(7)
    v_mfma_f32_32x32x16_bf16 v[24:39], v[64:67], v[216:219], v[24:39]
    ds_read_b128 v[64:67], v42 offset:32768
    s_waitcnt lgkmcnt(7)
    v_mfma_f32_32x32x16_bf16 v[24:39], v[68:71], v[220:223], v[24:39]
    ds_read_b128 v[68:71], v43 offset:32768
    s_waitcnt lgkmcnt(7)
    v_mfma_f32_32x32x16_bf16 v[24:39], v[72:75], v[224:227], v[24:39]
    s_waitcnt lgkmcnt(6)
    v_mfma_f32_32x32x16_bf16 v[24:39], v[76:79], v[228:231], v[24:39]
    s_waitcnt lgkmcnt(5)
    v_mfma_f32_32x32x16_bf16 v[24:39], v[80:83], v[232:235], v[24:39]
    s_waitcnt lgkmcnt(4)
    v_mfma_f32_32x32x16_bf16 v[24:39], v[84:87], v[236:239], v[24:39]
    s_waitcnt lgkmcnt(3)
    v_mfma_f32_32x32x16_bf16 v[24:39], v[56:59], v[240:243], v[24:39]
    s_waitcnt lgkmcnt(2)
    v_mfma_f32_32x32x16_bf16 v[24:39], v[60:63], v[244:247], v[24:39]
    s_waitcnt lgkmcnt(1)
    v_mfma_f32_32x32x16_bf16 v[24:39], v[64:67], v[248:251], v[24:39]
    s_waitcnt lgkmcnt(0)
    v_mfma_f32_32x32x16_bf16 v[24:39], v[68:71], v[252:255], v[24:39]
    s_cmp_eq_u32 s15, 0
    s_cbranch_scc0 Lst_18
    s_call_b64 s[30:31], L_A_cs
    v_mov_b32 v46, v5
    v_mov_b32 v47, v6
    s_mov_b32 s50, 162824
    s_mov_b32 s51, 2
    s_call_b64 s[30:31], L_B_wait
    v_mov_b32 v5, v46
    v_mov_b32 v6, v47
    ds_read_b32 v8, v6 offset:128
    ds_read_b128 v[88:91], v5 offset:0
    ds_read_b128 v[92:95], v5 offset:32
    ds_read_b128 v[96:99], v5 offset:64
    ds_read_b128 v[100:103], v5 offset:96
    s_waitcnt lgkmcnt(0)
Lst_18:
    v_mfma_f32_32x32x8_bf16 v[24:39], v[8:9], v[110:111], v[24:39]
    s_mul_i32 s30, s29, 1216
    s_add_u32 s30, s30, s28
    s_add_u32 s30, s30, 4608
    s_add_u32 s31, s30, 0xad0000
    v_mul_u32_u24 v4, 304, v3
    v_lshl_add_u32 v4, v2, 4, v4
    v_mov_b32 v5, 0x40000000
    v_cmp_ge_u32 vcc, 18, v2
    s_nop 1
    v_cndmask_b32 v4, v5, v4, vcc
    s_nop 1
    v_mul_f32 v24, v88, v24
    v_mul_f32 v25, v89, v25
    v_mul_f32 v26, v90, v26
    v_mul_f32 v27, v91, v27
    v_mul_f32 v28, v92, v28
    v_mul_f32 v29, v93, v29
    v_mul_f32 v30, v94, v30
    v_mul_f32 v31, v95, v31
    v_mul_f32 v32, v96, v32
    v_mul_f32 v33, v97, v33
    v_mul_f32 v34, v98, v34
    v_mul_f32 v35, v99, v35
    v_mul_f32 v36, v100, v36
    v_mul_f32 v37, v101, v37
    v_mul_f32 v38, v102, v38
    v_mul_f32 v39, v103, v39
    v_cvt_pk_bf16_f32 v24, v24, v25
    v_cvt_pk_bf16_f32 v25, v26, v27
    v_cvt_pk_bf16_f32 v26, v28, v29
    v_cvt_pk_bf16_f32 v27, v30, v31
    v_cvt_pk_bf16_f32 v28, v32, v33
    v_cvt_pk_bf16_f32 v29, v34, v35
    v_cvt_pk_bf16_f32 v30, v36, v37
    v_cvt_pk_bf16_f32 v31, v38, v39
    s_mov_b32 s24, 0x40000
    s_mov_b32 s25, 0x40000
    s_mov_b64 exec, s[24:25]
    v_mov_b32 v24, s60
    v_mov_b32 v25, s60
    v_mov_b32 v26, s60
    v_mov_b32 v27, s60
    v_mov_b32 v28, s60
    v_mov_b32 v29, s60
    v_mov_b32 v30, s60
    v_mov_b32 v31, s60
    s_mov_b64 exec, -1
    s_waitcnt vmcnt(0)
    v_cmp_ne_u32 vcc, s34, v44
    s_cmp_eq_u64 vcc, 0
    s_cselect_b32 s99, 1, 2
    s_cmp_eq_u32 s99, 1
    s_cbranch_scc1 Ls_19
    buffer_store_dwordx4 v[24:27], v4, s[4:7], s31 offen sc1
    buffer_store_dwordx4 v[28:31], v4, s[4:7], s31 offen offset:608 sc1
    s_branch Lse_20
Ls_19:
    buffer_store_dwordx4 v[24:27], v4, s[4:7], s31 offen
    buffer_store_dwordx4 v[28:31], v4, s[4:7], s31 offen offset:608
Lse_20:
    s_add_u32 s30, s30, s33
    buffer_store_dwordx4 v[24:27], v4, s[16:19], s30 offen sc1
    buffer_store_dwordx4 v[28:31], v4, s[16:19], s30 offen offset:608 sc1
    s_mov_b32 s26, 128
L_A_kvflag:
    s_lshl_b32 s24, s47, 8
    s_add_u32 s24, s24, s26
    s_lshl_b32 s25, s12, 11
    s_add_u32 s25, s25, s24
    s_add_u32 s25, s25, 0x510000
    s_add_u32 s24, s24, 0x518000
    s_waitcnt vmcnt(2)
    s_mov_b64 exec, 1
    s_cmp_eq_u32 s99, 1
    s_cbranch_scc1 Ls_21
    buffer_store_dword v14, off, s[16:19], s25 sc1
    s_branch Lse_22
Ls_21:
    buffer_store_dword v14, off, s[16:19], s25
Lse_22:
    s_mov_b64 exec, -1
    s_waitcnt vmcnt(1)
    s_mov_b64 exec, 1
    buffer_store_dword v14, off, s[16:19], s24 sc1
    s_mov_b64 exec, -1
    s_setprio 0
    s_branch L_A_q
L_A_q2:
    s_cmp_eq_u32 s15, 0
    s_cbranch_scc1 Lxa_23
    v_add_u32 v88, 40960, v1
    v_add_u32 v89, 1024, v88
    v_add_u32 v90, 2048, v88
    v_add_u32 v91, 3072, v88
    s_branch Lxe_24
Lxa_23:
    v_bfe_u32 v4, v2, 1, 3
    v_xor_b32 v4, v4, v3
    v_lshlrev_b32 v91, 7, v2
    v_add_u32 v91, 40960, v91
    v_lshl_add_u32 v88, v4, 4, v91
    v_xor_b32 v4, 2, v4
    v_lshl_add_u32 v89, v4, 4, v91
    v_xor_b32 v4, 6, v4
    v_lshl_add_u32 v90, v4, 4, v91
    v_xor_b32 v4, 2, v4
    v_lshl_add_u32 v91, v4, 4, v91
Lxe_24:
    v_add_u32 v92, 36864, v88
    v_add_u32 v93, 36864, v89
    v_add_u32 v94, 36864, v90
    v_add_u32 v95, 36864, v91
    v_lshlrev_b32 v5, 2, v2
    v_add_u32 v5, 160768, v5
    s_cmp_eq_u32 s15, 0
    s_cbranch_scc0 Lfw_25
    s_mov_b32 s23, 0x10c0000
    v_lshlrev_b32 v13, 3, v1
    s_mov_b32 exec_lo, -1
    s_mov_b32 exec_hi, 0xf
    s_mov_b32 s21, 0
Lp_27:
    buffer_load_dword v4, v13, s[4:7], s23 offen sc1
    s_add_u32 s21, s21, 1
    s_cmp_gt_u32 s21, s20
    s_cselect_b32 s20, 0, s20
    s_waitcnt vmcnt(0)
    s_cbranch_scc1 Lpd_28
    v_cmp_ne_u32 vcc, s14, v4
    s_cbranch_vccnz Lp_27
Lpd_28:
    s_mov_b64 exec, -1
    s_cmp_lt_u32 s3, 4
    s_cbranch_scc1 Lfw_25
    s_lshr_b32 s23, s13, 2
    s_mul_i32 s22, s23, 3
    s_add_u32 s22, s22, s3
    s_sub_u32 s22, s22, 5
    s_cmp_lg_u32 s3, 4
    s_cbranch_scc1 Lwa_29
    s_and_b32 s24, s23, 2
    s_cmp_eq_u32 s24, 0
    s_cbranch_scc1 Lfw_25
    s_lshr_b32 s22, s23, 2
    s_add_u32 s22, s22, 24
Lwa_29:
    s_mul_i32 s40, s22, 36864
    s_add_u32 s40, s40, 0xb00000
    s_add_u32 s61, s40, 0
    buffer_load_dwordx4 v[112:115], v1, s[4:7], s61 offen offset:0
    buffer_load_dwordx4 v[116:119], v1, s[4:7], s61 offen offset:1024
    buffer_load_dwordx4 v[120:123], v1, s[4:7], s61 offen offset:2048
    buffer_load_dwordx4 v[124:127], v1, s[4:7], s61 offen offset:3072
    s_add_u32 s61, s40, 4096
    buffer_load_dwordx4 v[128:131], v1, s[4:7], s61 offen offset:0
    buffer_load_dwordx4 v[132:135], v1, s[4:7], s61 offen offset:1024
    buffer_load_dwordx4 v[136:139], v1, s[4:7], s61 offen offset:2048
    buffer_load_dwordx4 v[140:143], v1, s[4:7], s61 offen offset:3072
    s_add_u32 s61, s40, 8192
    buffer_load_dwordx4 v[144:147], v1, s[4:7], s61 offen offset:0
    buffer_load_dwordx4 v[148:151], v1, s[4:7], s61 offen offset:1024
    buffer_load_dwordx4 v[152:155], v1, s[4:7], s61 offen offset:2048
    buffer_load_dwordx4 v[156:159], v1, s[4:7], s61 offen offset:3072
    s_branch Lfe_26
Lfw_25:
    s_waitcnt vmcnt(0)
Lfe_26:
    v_mov_b32 v9, 0
    v_mov_b32 v11, 0
    s_cmp_eq_u32 s15, 0
    s_cbranch_scc1 Lb_30
    s_barrier
Lb_30:
    s_cmp_eq_u32 s15, 0
    s_cbranch_scc1 Lb_31
    s_barrier
Lb_31:
    s_cmp_eq_u32 s15, 0
    s_cbranch_scc1 Lb_32
    s_barrier
Lb_32:
    ds_read_b32 v12, v5 offset:0
    ds_read_b32 v8, v5 offset:128
    ds_read_b32 v13, v5 offset:256
    ds_read_b32 v10, v5 offset:384
    ds_read_b128 v[56:59], v88 offset:0
    ds_read_b128 v[60:63], v92 offset:0
    ds_read_b128 v[64:67], v89 offset:0
    ds_read_b128 v[68:71], v93 offset:0
    ds_read_b128 v[72:75], v90 offset:0
    ds_read_b128 v[76:79], v94 offset:0
    ds_read_b128 v[80:83], v91 offset:0
    s_cmp_eq_u32 s15, 1
    ds_read_b128 v[84:87], v95 offset:0
    s_cbranch_scc1 Lcs_33
    s_add_u32 s61, s40, 12288
    buffer_load_dwordx4 v[160:163], v1, s[4:7], s61 offen offset:0
    buffer_load_dwordx4 v[164:167], v1, s[4:7], s61 offen offset:1024
    buffer_load_dwordx4 v[168:171], v1, s[4:7], s61 offen offset:2048
    buffer_load_dwordx4 v[172:175], v1, s[4:7], s61 offen offset:3072
    s_waitcnt vmcnt(12)
    v_dot2_f32_bf16 v106, v112, s60, 0
    v_dot2_f32_bf16 v107, v113, s60, 0
    v_dot2_f32_bf16 v108, v114, s60, 0
    v_dot2_f32_bf16 v109, v115, s60, 0
    v_dot2_f32_bf16 v106, v116, s60, v106
    v_dot2_f32_bf16 v107, v117, s60, v107
    v_dot2_f32_bf16 v108, v118, s60, v108
    v_dot2_f32_bf16 v109, v119, s60, v109
    v_dot2_f32_bf16 v106, v120, s60, v106
    v_dot2_f32_bf16 v107, v121, s60, v107
    v_dot2_f32_bf16 v108, v122, s60, v108
    v_dot2_f32_bf16 v109, v123, s60, v109
    v_dot2_f32_bf16 v106, v124, s60, v106
    v_dot2_f32_bf16 v107, v125, s60, v107
    v_dot2_f32_bf16 v108, v126, s60, v108
    v_dot2_f32_bf16 v109, v127, s60, v109
    s_cmp_eq_u32 s15, 1
Lcs_33:
    s_waitcnt lgkmcnt(7)
    v_mfma_f32_32x32x16_bf16 v[24:39], v[112:115], v[56:59], 0
    ds_read_b128 v[56:59], v88 offset:4096
    s_waitcnt lgkmcnt(7)
    v_mfma_f32_32x32x16_bf16 v[40:55], v[112:115], v[60:63], 0
    ds_read_b128 v[60:63], v92 offset:4096
    s_waitcnt lgkmcnt(7)
    v_mfma_f32_32x32x16_bf16 v[24:39], v[116:119], v[64:67], v[24:39]
    ds_read_b128 v[64:67], v89 offset:4096
    s_waitcnt lgkmcnt(7)
    v_mfma_f32_32x32x16_bf16 v[40:55], v[116:119], v[68:71], v[40:55]
    ds_read_b128 v[68:71], v93 offset:4096
    s_waitcnt lgkmcnt(7)
    v_mfma_f32_32x32x16_bf16 v[24:39], v[120:123], v[72:75], v[24:39]
    ds_read_b128 v[72:75], v90 offset:4096
    s_waitcnt lgkmcnt(7)
    v_mfma_f32_32x32x16_bf16 v[40:55], v[120:123], v[76:79], v[40:55]
    ds_read_b128 v[76:79], v94 offset:4096
    s_waitcnt lgkmcnt(7)
    v_mfma_f32_32x32x16_bf16 v[24:39], v[124:127], v[80:83], v[24:39]
    ds_read_b128 v[80:83], v91 offset:4096
    s_waitcnt lgkmcnt(7)
    v_mfma_f32_32x32x16_bf16 v[40:55], v[124:127], v[84:87], v[40:55]
    ds_read_b128 v[84:87], v95 offset:4096
    s_cbranch_scc1 Lcs_34
    s_add_u32 s61, s40, 16384
    buffer_load_dwordx4 v[176:179], v1, s[4:7], s61 offen offset:0
    buffer_load_dwordx4 v[180:183], v1, s[4:7], s61 offen offset:1024
    buffer_load_dwordx4 v[184:187], v1, s[4:7], s61 offen offset:2048
    buffer_load_dwordx4 v[188:191], v1, s[4:7], s61 offen offset:3072
    s_waitcnt vmcnt(12)
    v_dot2_f32_bf16 v106, v128, s60, v106
    v_dot2_f32_bf16 v107, v129, s60, v107
    v_dot2_f32_bf16 v108, v130, s60, v108
    v_dot2_f32_bf16 v109, v131, s60, v109
    v_dot2_f32_bf16 v106, v132, s60, v106
    v_dot2_f32_bf16 v107, v133, s60, v107
    v_dot2_f32_bf16 v108, v134, s60, v108
    v_dot2_f32_bf16 v109, v135, s60, v109
    v_dot2_f32_bf16 v106, v136, s60, v106
    v_dot2_f32_bf16 v107, v137, s60, v107
    v_dot2_f32_bf16 v108, v138, s60, v108
    v_dot2_f32_bf16 v109, v139, s60, v109
    v_dot2_f32_bf16 v106, v140, s60, v106
    v_dot2_f32_bf16 v107, v141, s60, v107
    v_dot2_f32_bf16 v108, v142, s60, v108
    v_dot2_f32_bf16 v109, v143, s60, v109
    s_cmp_eq_u32 s15, 1
Lcs_34:
    s_waitcnt lgkmcnt(7)
    v_mfma_f32_32x32x16_bf16 v[24:39], v[128:131], v[56:59], v[24:39]
    ds_read_b128 v[56:59], v88 offset:8192
    s_waitcnt lgkmcnt(7)
    v_mfma_f32_32x32x16_bf16 v[40:55], v[128:131], v[60:63], v[40:55]
    ds_read_b128 v[60:63], v92 offset:8192
    s_waitcnt lgkmcnt(7)
    v_mfma_f32_32x32x16_bf16 v[24:39], v[132:135], v[64:67], v[24:39]
    ds_read_b128 v[64:67], v89 offset:8192
    s_waitcnt lgkmcnt(7)
    v_mfma_f32_32x32x16_bf16 v[40:55], v[132:135], v[68:71], v[40:55]
    ds_read_b128 v[68:71], v93 offset:8192
    s_waitcnt lgkmcnt(7)
    v_mfma_f32_32x32x16_bf16 v[24:39], v[136:139], v[72:75], v[24:39]
    ds_read_b128 v[72:75], v90 offset:8192
    s_waitcnt lgkmcnt(7)
    v_mfma_f32_32x32x16_bf16 v[40:55], v[136:139], v[76:79], v[40:55]
    ds_read_b128 v[76:79], v94 offset:8192
    s_waitcnt lgkmcnt(7)
    v_mfma_f32_32x32x16_bf16 v[24:39], v[140:143], v[80:83], v[24:39]
    ds_read_b128 v[80:83], v91 offset:8192
    s_waitcnt lgkmcnt(7)
    v_mfma_f32_32x32x16_bf16 v[40:55], v[140:143], v[84:87], v[40:55]
    ds_read_b128 v[84:87], v95 offset:8192
    s_cbranch_scc1 Lcs_35
    s_add_u32 s61, s40, 20480
    buffer_load_dwordx4 v[192:195], v1, s[4:7], s61 offen offset:0
    buffer_load_dwordx4 v[196:199], v1, s[4:7], s61 offen offset:1024
    buffer_load_dwordx4 v[200:203], v1, s[4:7], s61 offen offset:2048
    buffer_load_dwordx4 v[204:207], v1, s[4:7], s61 offen offset:3072
    s_waitcnt vmcnt(12)
    v_dot2_f32_bf16 v106, v144, s60, v106
    v_dot2_f32_bf16 v107, v145, s60, v107
    v_dot2_f32_bf16 v108, v146, s60, v108
    v_dot2_f32_bf16 v109, v147, s60, v109
    v_dot2_f32_bf16 v106, v148, s60, v106
    v_dot2_f32_bf16 v107, v149, s60, v107
    v_dot2_f32_bf16 v108, v150, s60, v108
    v_dot2_f32_bf16 v109, v151, s60, v109
    v_dot2_f32_bf16 v106, v152, s60, v106
    v_dot2_f32_bf16 v107, v153, s60, v107
    v_dot2_f32_bf16 v108, v154, s60, v108
    v_dot2_f32_bf16 v109, v155, s60, v109
    v_dot2_f32_bf16 v106, v156, s60, v106
    v_dot2_f32_bf16 v107, v157, s60, v107
    v_dot2_f32_bf16 v108, v158, s60, v108
    v_dot2_f32_bf16 v109, v159, s60, v109
    s_cmp_eq_u32 s15, 1
Lcs_35:
    s_waitcnt lgkmcnt(7)
    v_mfma_f32_32x32x16_bf16 v[24:39], v[144:147], v[56:59], v[24:39]
    ds_read_b128 v[56:59], v88 offset:12288
    s_waitcnt lgkmcnt(7)
    v_mfma_f32_32x32x16_bf16 v[40:55], v[144:147], v[60:63], v[40:55]
    ds_read_b128 v[60:63], v92 offset:12288
    s_waitcnt lgkmcnt(7)
    v_mfma_f32_32x32x16_bf16 v[24:39], v[148:151], v[64:67], v[24:39]
    ds_read_b128 v[64:67], v89 offset:12288
    s_waitcnt lgkmcnt(7)
    v_mfma_f32_32x32x16_bf16 v[40:55], v[148:151], v[68:71], v[40:55]
    ds_read_b128 v[68:71], v93 offset:12288
    s_waitcnt lgkmcnt(7)
    v_mfma_f32_32x32x16_bf16 v[24:39], v[152:155], v[72:75], v[24:39]
    ds_read_b128 v[72:75], v90 offset:12288
    s_waitcnt lgkmcnt(7)
    v_mfma_f32_32x32x16_bf16 v[40:55], v[152:155], v[76:79], v[40:55]
    ds_read_b128 v[76:79], v94 offset:12288
    s_waitcnt lgkmcnt(7)
    v_mfma_f32_32x32x16_bf16 v[24:39], v[156:159], v[80:83], v[24:39]
    ds_read_b128 v[80:83], v91 offset:12288
    s_waitcnt lgkmcnt(7)
    v_mfma_f32_32x32x16_bf16 v[40:55], v[156:159], v[84:87], v[40:55]
    ds_read_b128 v[84:87], v95 offset:12288
    s_cbranch_scc1 Lcs_36
    s_add_u32 s61, s40, 24576
    buffer_load_dwordx4 v[208:211], v1, s[4:7], s61 offen offset:0
    buffer_load_dwordx4 v[212:215], v1, s[4:7], s61 offen offset:1024
    buffer_load_dwordx4 v[216:219], v1, s[4:7], s61 offen offset:2048
    buffer_load_dwordx4 v[220:223], v1, s[4:7], s61 offen offset:3072
    s_waitcnt vmcnt(12)
    v_dot2_f32_bf16 v106, v160, s60, v106
    v_dot2_f32_bf16 v107, v161, s60, v107
    v_dot2_f32_bf16 v108, v162, s60, v108
    v_dot2_f32_bf16 v109, v163, s60, v109
    v_dot2_f32_bf16 v106, v164, s60, v106
    v_dot2_f32_bf16 v107, v165, s60, v107
    v_dot2_f32_bf16 v108, v166, s60, v108
    v_dot2_f32_bf16 v109, v167, s60, v109
    v_dot2_f32_bf16 v106, v168, s60, v106
    v_dot2_f32_bf16 v107, v169, s60, v107
    v_dot2_f32_bf16 v108, v170, s60, v108
    v_dot2_f32_bf16 v109, v171, s60, v109
    v_dot2_f32_bf16 v106, v172, s60, v106
    v_dot2_f32_bf16 v107, v173, s60, v107
    v_dot2_f32_bf16 v108, v174, s60, v108
    v_dot2_f32_bf16 v109, v175, s60, v109
    s_cmp_eq_u32 s15, 1
Lcs_36:
    s_waitcnt lgkmcnt(7)
    v_mfma_f32_32x32x16_bf16 v[24:39], v[160:163], v[56:59], v[24:39]
    ds_read_b128 v[56:59], v88 offset:16384
    s_waitcnt lgkmcnt(7)
    v_mfma_f32_32x32x16_bf16 v[40:55], v[160:163], v[60:63], v[40:55]
    ds_read_b128 v[60:63], v92 offset:16384
    s_waitcnt lgkmcnt(7)
    v_mfma_f32_32x32x16_bf16 v[24:39], v[164:167], v[64:67], v[24:39]
    ds_read_b128 v[64:67], v89 offset:16384
    s_waitcnt lgkmcnt(7)
    v_mfma_f32_32x32x16_bf16 v[40:55], v[164:167], v[68:71], v[40:55]
    ds_read_b128 v[68:71], v93 offset:16384
    s_waitcnt lgkmcnt(7)
    v_mfma_f32_32x32x16_bf16 v[24:39], v[168:171], v[72:75], v[24:39]
    ds_read_b128 v[72:75], v90 offset:16384
    s_waitcnt lgkmcnt(7)
    v_mfma_f32_32x32x16_bf16 v[40:55], v[168:171], v[76:79], v[40:55]
    ds_read_b128 v[76:79], v94 offset:16384
    s_waitcnt lgkmcnt(7)
    v_mfma_f32_32x32x16_bf16 v[24:39], v[172:175], v[80:83], v[24:39]
    ds_read_b128 v[80:83], v91 offset:16384
    s_waitcnt lgkmcnt(7)
    v_mfma_f32_32x32x16_bf16 v[40:55], v[172:175], v[84:87], v[40:55]
    ds_read_b128 v[84:87], v95 offset:16384
    s_cbranch_scc1 Lcs_37
    s_add_u32 s61, s40, 28672
    buffer_load_dwordx4 v[224:227], v1, s[4:7], s61 offen offset:0
    buffer_load_dwordx4 v[228:231], v1, s[4:7], s61 offen offset:1024
    buffer_load_dwordx4 v[232:235], v1, s[4:7], s61 offen offset:2048
    buffer_load_dwordx4 v[236:239], v1, s[4:7], s61 offen offset:3072
    s_waitcnt vmcnt(12)
    v_dot2_f32_bf16 v106, v176, s60, v106
    v_dot2_f32_bf16 v107, v177, s60, v107
    v_dot2_f32_bf16 v108, v178, s60, v108
    v_dot2_f32_bf16 v109, v179, s60, v109
    v_dot2_f32_bf16 v106, v180, s60, v106
    v_dot2_f32_bf16 v107, v181, s60, v107
    v_dot2_f32_bf16 v108, v182, s60, v108
    v_dot2_f32_bf16 v109, v183, s60, v109
    v_dot2_f32_bf16 v106, v184, s60, v106
    v_dot2_f32_bf16 v107, v185, s60, v107
    v_dot2_f32_bf16 v108, v186, s60, v108
    v_dot2_f32_bf16 v109, v187, s60, v109
    v_dot2_f32_bf16 v106, v188, s60, v106
    v_dot2_f32_bf16 v107, v189, s60, v107
    v_dot2_f32_bf16 v108, v190, s60, v108
    v_dot2_f32_bf16 v109, v191, s60, v109
    s_cmp_eq_u32 s15, 1
Lcs_37:
    s_waitcnt lgkmcnt(7)
    v_mfma_f32_32x32x16_bf16 v[24:39], v[176:179], v[56:59], v[24:39]
    ds_read_b128 v[56:59], v88 offset:20480
    s_waitcnt lgkmcnt(7)
    v_mfma_f32_32x32x16_bf16 v[40:55], v[176:179], v[60:63], v[40:55]
    ds_read_b128 v[60:63], v92 offset:20480
    s_waitcnt lgkmcnt(7)
    v_mfma_f32_32x32x16_bf16 v[24:39], v[180:183], v[64:67], v[24:39]
    ds_read_b128 v[64:67], v89 offset:20480
    s_waitcnt lgkmcnt(7)
    v_mfma_f32_32x32x16_bf16 v[40:55], v[180:183], v[68:71], v[40:55]
    ds_read_b128 v[68:71], v93 offset:20480
    s_waitcnt lgkmcnt(7)
    v_mfma_f32_32x32x16_bf16 v[24:39], v[184:187], v[72:75], v[24:39]
    ds_read_b128 v[72:75], v90 offset:20480
    s_waitcnt lgkmcnt(7)
    v_mfma_f32_32x32x16_bf16 v[40:55], v[184:187], v[76:79], v[40:55]
    ds_read_b128 v[76:79], v94 offset:20480
    s_waitcnt lgkmcnt(7)
    v_mfma_f32_32x32x16_bf16 v[24:39], v[188:191], v[80:83], v[24:39]
    ds_read_b128 v[80:83], v91 offset:20480
    s_waitcnt lgkmcnt(7)
    v_mfma_f32_32x32x16_bf16 v[40:55], v[188:191], v[84:87], v[40:55]
    ds_read_b128 v[84:87], v95 offset:20480
    s_cbranch_scc1 Lcs_38
    s_add_u32 s61, s40, 32768
    buffer_load_dwordx4 v[240:243], v1, s[4:7], s61 offen offset:0
    buffer_load_dwordx4 v[244:247], v1, s[4:7], s61 offen offset:1024
    buffer_load_dwordx4 v[248:251], v1, s[4:7], s61 offen offset:2048
    buffer_load_dwordx4 v[252:255], v1, s[4:7], s61 offen offset:3072
    s_waitcnt vmcnt(12)
    v_dot2_f32_bf16 v106, v192, s60, v106
    v_dot2_f32_bf16 v107, v193, s60, v107
    v_dot2_f32_bf16 v108, v194, s60, v108
    v_dot2_f32_bf16 v109, v195, s60, v109
    v_dot2_f32_bf16 v106, v196, s60, v106
    v_dot2_f32_bf16 v107, v197, s60, v107
    v_dot2_f32_bf16 v108, v198, s60, v108
    v_dot2_f32_bf16 v109, v199, s60, v109
    v_dot2_f32_bf16 v106, v200, s60, v106
    v_dot2_f32_bf16 v107, v201, s60, v107
    v_dot2_f32_bf16 v108, v202, s60, v108
    v_dot2_f32_bf16 v109, v203, s60, v109
    v_dot2_f32_bf16 v106, v204, s60, v106
    v_dot2_f32_bf16 v107, v205, s60, v107
    v_dot2_f32_bf16 v108, v206, s60, v108
    v_dot2_f32_bf16 v109, v207, s60, v109
    s_cmp_eq_u32 s15, 1
Lcs_38:
    s_waitcnt lgkmcnt(7)
    v_mfma_f32_32x32x16_bf16 v[24:39], v[192:195], v[56:59], v[24:39]
    ds_read_b128 v[56:59], v88 offset:24576
    s_waitcnt lgkmcnt(7)
    v_mfma_f32_32x32x16_bf16 v[40:55], v[192:195], v[60:63], v[40:55]
    ds_read_b128 v[60:63], v92 offset:24576
    s_waitcnt lgkmcnt(7)
    v_mfma_f32_32x32x16_bf16 v[24:39], v[196:199], v[64:67], v[24:39]
    ds_read_b128 v[64:67], v89 offset:24576
    s_waitcnt lgkmcnt(7)
    v_mfma_f32_32x32x16_bf16 v[40:55], v[196:199], v[68:71], v[40:55]
    ds_read_b128 v[68:71], v93 offset:24576
    s_waitcnt lgkmcnt(7)
    v_mfma_f32_32x32x16_bf16 v[24:39], v[200:203], v[72:75], v[24:39]
    ds_read_b128 v[72:75], v90 offset:24576
    s_waitcnt lgkmcnt(7)
    v_mfma_f32_32x32x16_bf16 v[40:55], v[200:203], v[76:79], v[40:55]
    ds_read_b128 v[76:79], v94 offset:24576
    s_waitcnt lgkmcnt(7)
    v_mfma_f32_32x32x16_bf16 v[24:39], v[204:207], v[80:83], v[24:39]
    ds_read_b128 v[80:83], v91 offset:24576
    s_waitcnt lgkmcnt(7)
    v_mfma_f32_32x32x16_bf16 v[40:55], v[204:207], v[84:87], v[40:55]
    ds_read_b128 v[84:87], v95 offset:24576
    s_cbranch_scc1 Lcs_39
    s_waitcnt vmcnt(8)
    v_dot2_f32_bf16 v106, v208, s60, v106
    v_dot2_f32_bf16 v107, v209, s60, v107
    v_dot2_f32_bf16 v108, v210, s60, v108
    v_dot2_f32_bf16 v109, v211, s60, v109
    v_dot2_f32_bf16 v106, v212, s60, v106
    v_dot2_f32_bf16 v107, v213, s60, v107
    v_dot2_f32_bf16 v108, v214, s60, v108
    v_dot2_f32_bf16 v109, v215, s60, v109
    v_dot2_f32_bf16 v106, v216, s60, v106
    v_dot2_f32_bf16 v107, v217, s60, v107
    v_dot2_f32_bf16 v108, v218, s60, v108
    v_dot2_f32_bf16 v109, v219, s60, v109
    v_dot2_f32_bf16 v106, v220, s60, v106
    v_dot2_f32_bf16 v107, v221, s60, v107
    v_dot2_f32_bf16 v108, v222, s60, v108
    v_dot2_f32_bf16 v109, v223, s60, v109
    s_cmp_eq_u32 s15, 1
Lcs_39:
    s_waitcnt lgkmcnt(7)
    v_mfma_f32_32x32x16_bf16 v[24:39], v[208:211], v[56:59], v[24:39]
    ds_read_b128 v[56:59], v88 offset:28672
    s_waitcnt lgkmcnt(7)
    v_mfma_f32_32x32x16_bf16 v[40:55], v[208:211], v[60:63], v[40:55]
    ds_read_b128 v[60:63], v92 offset:28672
    s_waitcnt lgkmcnt(7)
    v_mfma_f32_32x32x16_bf16 v[24:39], v[212:215], v[64:67], v[24:39]
    ds_read_b128 v[64:67], v89 offset:28672
    s_waitcnt lgkmcnt(7)
    v_mfma_f32_32x32x16_bf16 v[40:55], v[212:215], v[68:71], v[40:55]
    ds_read_b128 v[68:71], v93 offset:28672
    s_waitcnt lgkmcnt(7)
    v_mfma_f32_32x32x16_bf16 v[24:39], v[216:219], v[72:75], v[24:39]
    ds_read_b128 v[72:75], v90 offset:28672
    s_waitcnt lgkmcnt(7)
    v_mfma_f32_32x32x16_bf16 v[40:55], v[216:219], v[76:79], v[40:55]
    ds_read_b128 v[76:79], v94 offset:28672
    s_waitcnt lgkmcnt(7)
    v_mfma_f32_32x32x16_bf16 v[24:39], v[220:223], v[80:83], v[24:39]
    ds_read_b128 v[80:83], v91 offset:28672
    s_waitcnt lgkmcnt(7)
    v_mfma_f32_32x32x16_bf16 v[40:55], v[220:223], v[84:87], v[40:55]
    ds_read_b128 v[84:87], v95 offset:28672
    s_cbranch_scc1 Lcs_40
    s_waitcnt vmcnt(4)
    v_dot2_f32_bf16 v106, v224, s60, v106
    v_dot2_f32_bf16 v107, v225, s60, v107
    v_dot2_f32_bf16 v108, v226, s60, v108
    v_dot2_f32_bf16 v109, v227, s60, v109
    v_dot2_f32_bf16 v106, v228, s60, v106
    v_dot2_f32_bf16 v107, v229, s60, v107
    v_dot2_f32_bf16 v108, v230, s60, v108
    v_dot2_f32_bf16 v109, v231, s60, v109
    v_dot2_f32_bf16 v106, v232, s60, v106
    v_dot2_f32_bf16 v107, v233, s60, v107
    v_dot2_f32_bf16 v108, v234, s60, v108
    v_dot2_f32_bf16 v109, v235, s60, v109
    v_dot2_f32_bf16 v106, v236, s60, v106
    v_dot2_f32_bf16 v107, v237, s60, v107
    v_dot2_f32_bf16 v108, v238, s60, v108
    v_dot2_f32_bf16 v109, v239, s60, v109
    s_cmp_eq_u32 s15, 1
Lcs_40:
    s_waitcnt lgkmcnt(7)
    v_mfma_f32_32x32x16_bf16 v[24:39], v[224:227], v[56:59], v[24:39]
    ds_read_b128 v[56:59], v88 offset:32768
    s_waitcnt lgkmcnt(7)
    v_mfma_f32_32x32x16_bf16 v[40:55], v[224:227], v[60:63], v[40:55]
    ds_read_b128 v[60:63], v92 offset:32768
    s_waitcnt lgkmcnt(7)
    v_mfma_f32_32x32x16_bf16 v[24:39], v[228:231], v[64:67], v[24:39]
    ds_read_b128 v[64:67], v89 offset:32768
    s_waitcnt lgkmcnt(7)
    v_mfma_f32_32x32x16_bf16 v[40:55], v[228:231], v[68:71], v[40:55]
    ds_read_b128 v[68:71], v93 offset:32768
    s_waitcnt lgkmcnt(7)
    v_mfma_f32_32x32x16_bf16 v[24:39], v[232:235], v[72:75], v[24:39]
    ds_read_b128 v[72:75], v90 offset:32768
    s_waitcnt lgkmcnt(7)
    v_mfma_f32_32x32x16_bf16 v[40:55], v[232:235], v[76:79], v[40:55]
    ds_read_b128 v[76:79], v94 offset:32768
    s_waitcnt lgkmcnt(7)
    v_mfma_f32_32x32x16_bf16 v[24:39], v[236:239], v[80:83], v[24:39]
    ds_read_b128 v[80:83], v91 offset:32768
    s_waitcnt lgkmcnt(7)
    v_mfma_f32_32x32x16_bf16 v[40:55], v[236:239], v[84:87], v[40:55]
    ds_read_b128 v[84:87], v95 offset:32768
    s_cbranch_scc1 Lcs_41
    s_waitcnt vmcnt(0)
    v_dot2_f32_bf16 v106, v240, s60, v106
    v_dot2_f32_bf16 v107, v241, s60, v107
    v_dot2_f32_bf16 v108, v242, s60, v108
    v_dot2_f32_bf16 v109, v243, s60, v109
    v_dot2_f32_bf16 v106, v244, s60, v106
    v_dot2_f32_bf16 v107, v245, s60, v107
    v_dot2_f32_bf16 v108, v246, s60, v108
    v_dot2_f32_bf16 v109, v247, s60, v109
    v_dot2_f32_bf16 v106, v248, s60, v106
    v_dot2_f32_bf16 v107, v249, s60, v107
    v_dot2_f32_bf16 v108, v250, s60, v108
    v_dot2_f32_bf16 v109, v251, s60, v109
    v_dot2_f32_bf16 v106, v252, s60, v106
    v_dot2_f32_bf16 v107, v253, s60, v107
    v_dot2_f32_bf16 v108, v254, s60, v108
    v_dot2_f32_bf16 v109, v255, s60, v109
    s_nop 2
    v_add_f32 v106, v106, v107
    v_add_f32 v108, v108, v109
    v_add_f32 v106, v106, v108
    v_cvt_pk_bf16_f32 v110, v106, v106
    v_lshlrev_b32 v110, 16, v110
    v_sub_f32 v106, v106, v110
    v_cvt_pk_bf16_f32 v110, v110, v106
    s_cmp_eq_u32 s15, 1
Lcs_41:
    s_waitcnt lgkmcnt(7)
    v_mfma_f32_32x32x16_bf16 v[24:39], v[240:243], v[56:59], v[24:39]
    s_waitcnt lgkmcnt(6)
    v_mfma_f32_32x32x16_bf16 v[40:55], v[240:243], v[60:63], v[40:55]
    s_waitcnt lgkmcnt(5)
    v_mfma_f32_32x32x16_bf16 v[24:39], v[244:247], v[64:67], v[24:39]
    s_waitcnt lgkmcnt(4)
    v_mfma_f32_32x32x16_bf16 v[40:55], v[244:247], v[68:71], v[40:55]
    s_waitcnt lgkmcnt(3)
    v_mfma_f32_32x32x16_bf16 v[24:39], v[248:251], v[72:75], v[24:39]
    s_waitcnt lgkmcnt(2)
    v_mfma_f32_32x32x16_bf16 v[40:55], v[248:251], v[76:79], v[40:55]
    s_waitcnt lgkmcnt(1)
    v_mfma_f32_32x32x16_bf16 v[24:39], v[252:255], v[80:83], v[24:39]
    s_waitcnt lgkmcnt(0)
    v_mfma_f32_32x32x16_bf16 v[40:55], v[252:255], v[84:87], v[40:55]
    s_cmp_eq_u32 s15, 0
    s_cbranch_scc0 Lst_42
    v_mov_b32 v96, v5
    v_mov_b32 v97, v6
    s_mov_b32 s50, 162824
    s_mov_b32 s51, 2
    s_call_b64 s[30:31], L_B_wait
    v_mov_b32 v5, v96
    v_mov_b32 v6, v97
    ds_read_b32 v12, v5 offset:0
    ds_read_b32 v8, v5 offset:128
    ds_read_b32 v13, v5 offset:256
    ds_read_b32 v10, v5 offset:384
    s_waitcnt lgkmcnt(0)
Lst_42:
    v_mfma_f32_32x32x8_bf16 v[24:39], v[110:111], v[8:9], v[24:39]
    v_mfma_f32_32x32x8_bf16 v[40:55], v[110:111], v[10:11], v[40:55]
    v_mul_f32 v12, 0x3eae1a93, v12
    v_mul_f32 v13, 0x3eae1a93, v13
    s_sub_u32 s24, s3, 5
    s_mul_i32 s24, s24, 4608
    s_add_u32 s24, s24, 151552
    v_add_u32 v4, s24, v1
    v_mul_u32_u24 v5, 4608, v3
    v_lshl_add_u32 v5, v2, 2, v5
    v_add_u32 v5, 152576, v5
    s_nop 3
    v_mul_f32 v24, v12, v24
    v_mul_f32 v25, v12, v25
    v_mul_f32 v26, v12, v26
    v_mul_f32 v27, v12, v27
    v_mul_f32 v28, v12, v28
    v_mul_f32 v29, v12, v29
    v_mul_f32 v30, v12, v30
    v_mul_f32 v31, v12, v31
    v_mul_f32 v32, v12, v32
    v_mul_f32 v33, v12, v33
    v_mul_f32 v34, v12, v34
    v_mul_f32 v35, v12, v35
    v_mul_f32 v36, v12, v36
    v_mul_f32 v37, v12, v37
    v_mul_f32 v38, v12, v38
    v_mul_f32 v39, v12, v39
    v_cvt_pk_bf16_f32 v24, v24, v25
    v_cvt_pk_bf16_f32 v25, v26, v27
    v_cvt_pk_bf16_f32 v26, v28, v29
    v_cvt_pk_bf16_f32 v27, v30, v31
    v_cvt_pk_bf16_f32 v28, v32, v33
    v_cvt_pk_bf16_f32 v29, v34, v35
    v_cvt_pk_bf16_f32 v30, v36, v37
    v_cvt_pk_bf16_f32 v31, v38, v39
    v_mul_f32 v40, v13, v40
    v_mul_f32 v41, v13, v41
    v_mul_f32 v42, v13, v42
    v_mul_f32 v43, v13, v43
    v_mul_f32 v44, v13, v44
    v_mul_f32 v45, v13, v45
    v_mul_f32 v46, v13, v46
    v_mul_f32 v47, v13, v47
    v_mul_f32 v48, v13, v48
    v_mul_f32 v49, v13, v49
    v_mul_f32 v50, v13, v50
    v_mul_f32 v51, v13, v51
    v_mul_f32 v52, v13, v52
    v_mul_f32 v53, v13, v53
    v_mul_f32 v54, v13, v54
    v_mul_f32 v55, v13, v55
    v_cvt_pk_bf16_f32 v40, v40, v41
    v_cvt_pk_bf16_f32 v41, v42, v43
    v_cvt_pk_bf16_f32 v42, v44, v45
    v_cvt_pk_bf16_f32 v43, v46, v47
    v_cvt_pk_bf16_f32 v44, v48, v49
    v_cvt_pk_bf16_f32 v45, v50, v51
    v_cvt_pk_bf16_f32 v46, v52, v53
    v_cvt_pk_bf16_f32 v47, v54, v55
    s_cmp_eq_u32 s3, 7
    s_cbranch_scc1 L_A_qext
    ds_write_b128 v4, v[24:27] offset:0
    ds_write_b128 v4, v[28:31] offset:2304
    ds_write_b128 v4, v[40:43] offset:1152
    ds_write_b128 v4, v[44:47] offset:3456
    s_branch L_A_q
L_A_qext:
    ds_write_b32 v5, v24 offset:0
    ds_write_b32 v5, v25 offset:2304
    ds_write_b32 v5, v40 offset:1152
    ds_write_b32 v5, v41 offset:3456
L_A_q:
    s_waitcnt vmcnt(0) lgkmcnt(0)
    s_barrier
    v_lshlrev_b32 v11, 3, v1
    s_add_u32 s47, s12, s3
    s_and_b32 s47, s47, 7
    s_lshl_b32 s23, s47, 11
    s_add_u32 s23, s23, 0x518000
    v_mov_b32 v12, v14
    s_mov_b32 exec_lo, 0xffff
    s_mov_b32 exec_hi, 0x0
    buffer_load_dword v12, v11, s[16:19], s23 offen sc1
    s_mov_b64 exec, -1
    s_mul_i32 s24, s3, 1152
    s_add_u32 s24, s24, 151552
    v_add_u32 v4, s24, v1
    v_lshl_add_u32 v5, v2, 2, s24
    ds_read_b128 v[24:27], v4
    ds_read_b32 v6, v5 offset:1024
    v_mov_b32 v8, v1
    v_lshlrev_b32 v9, 8, v3
    v_lshl_add_u32 v9, v2, 3, v9
    ds_read_b128 v[84:87], v8
    ds_read_b64 v[88:89], v9 offset:4096
    v_mul_u32_u24 v10, 304, v3
    v_min_u32 v4, 18, v2
    v_lshl_add_u32 v10, v4, 4, v10
    v_add_u32 v10, 4608, v10
    v_cmp_ge_u32 vcc, 18, v2
    v_cmp_eq_u32 s[62:63], 28, v2
    s_or_b64 vcc, vcc, s[62:63]
    v_mov_b32 v4, 0x40000
    s_nop 0
    v_cndmask_b32 v10, v4, v10, vcc
    v_cmp_eq_u32 vcc, 0, v3
    v_mov_b32 v29, 0
    v_mov_b32 v30, 0
    v_mov_b32 v33, 0
    v_mov_b32 v34, 0
    s_waitcnt lgkmcnt(0)
    v_cndmask_b32 v28, 0, v6, vcc
    v_cndmask_b32 v31, 0, v6, vcc
    v_cndmask_b32 v32, v6, 0, vcc
    v_cndmask_b32 v35, v6, 0, vcc
    v_mfma_f32_32x32x16_bf16 v[36:51], v[84:87], v[24:27], 0
    v_mfma_f32_32x32x8_bf16 v[36:51], v[88:89], v[28:29], v[36:51]
    ds_read_b128 v[84:87], v8 offset:1024
    ds_read_b128 v[92:95], v10
    s_and_b32 s22, s3, 1
    s_add_u32 s45, s45, s22
    s_lshl_b32 s46, s46, 2
    s_lshr_b32 s22, s3, 1
    s_add_u32 s46, s46, s22
    s_and_b32 s42, s13, 7
    s_lshl_b32 s43, s12, 3
    s_add_u32 s42, s42, s43
    s_lshr_b32 s44, s13, 3
    s_mul_i32 s43, s44, 9
    s_add_u32 s43, s43, 1
    s_lshr_b32 s43, s43, 1
    s_add_u32 s43, s43, s3
    s_and_b32 s44, s44, 1
    s_sub_u32 s44, 5, s44
    s_lshl_b32 s41, s13, 1
    s_add_u32 s41, s41, s3
    s_sub_u32 s41, s41, 5
    s_mul_i32 s41, s41, 36864
    s_add_u32 s41, s41, 0xc00000
    s_sub_u32 s22, s3, 5
    s_cmp_lt_u32 s22, 2
    s_cselect_b32 s41, s41, 0x40000000
    s_mul_i32 s22, s43, 36864
    s_add_u32 s22, s22, 0xf00000
    s_cmp_lt_u32 s3, s44
    s_cselect_b32 s41, s22, s41
    s_setprio 3
    v_exp_f32 v36, v36
    v_exp_f32 v37, v37
    ds_read_b128 v[96:99], v10 offset:608
    v_exp_f32 v38, v38
    v_exp_f32 v39, v39
    v_exp_f32 v40, v40
    v_cvt_pk_bf16_f32 v36, v36, v37
    s_waitcnt lgkmcnt(2)
    v_mfma_f32_32x32x16_bf16 v[52:67], v[84:87], v[24:27], 0
    ds_read_b128 v[84:87], v8 offset:2048
    v_exp_f32 v41, v41
    v_exp_f32 v42, v42
    v_exp_f32 v43, v43
    v_cvt_pk_bf16_f32 v37, v38, v39
    v_cvt_pk_bf16_f32 v38, v40, v41
    v_mfma_f32_32x32x8_bf16 v[52:67], v[88:89], v[30:31], v[52:67]
    s_setprio 2
    v_cvt_pk_bf16_f32 v39, v42, v43
    v_exp_f32 v44, v44
    v_exp_f32 v45, v45
    v_exp_f32 v46, v46
    v_exp_f32 v47, v47
    v_cvt_pk_bf16_f32 v44, v44, v45
    s_waitcnt lgkmcnt(2)
    v_mfma_f32_32x32x16_bf16 v[68:83], v[92:95], v[36:39], 0
    ds_read_b128 v[92:95], v10 offset:1216
    v_exp_f32 v48, v48
    v_exp_f32 v49, v49
    v_exp_f32 v50, v50
    v_exp_f32 v51, v51
    v_cvt_pk_bf16_f32 v45, v46, v47
    v_cvt_pk_bf16_f32 v46, v48, v49
    v_cvt_pk_bf16_f32 v47, v50, v51
    s_cmp_eq_u32 s3, 7
    s_cbranch_scc0 Lc_43
    s_call_b64 s[30:31], L_A_touch0
Lc_43:
    s_setprio 1
    v_exp_f32 v52, v52
    v_exp_f32 v53, v53
    s_waitcnt lgkmcnt(2)
    v_mfma_f32_32x32x16_bf16 v[68:83], v[96:99], v[44:47], v[68:83]
    ds_read_b128 v[96:99], v10 offset:1824
    v_exp_f32 v54, v54
    v_exp_f32 v55, v55
    v_exp_f32 v56, v56
    v_cvt_pk_bf16_f32 v52, v52, v53
    s_waitcnt lgkmcnt(2)
    v_mfma_f32_32x32x16_bf16 v[36:51], v[84:87], v[24:27], 0
    ds_read_b128 v[84:87], v8 offset:3072
    v_exp_f32 v57, v57
    v_exp_f32 v58, v58
    v_exp_f32 v59, v59
    v_cvt_pk_bf16_f32 v53, v54, v55
    v_cvt_pk_bf16_f32 v54, v56, v57
    v_mfma_f32_32x32x8_bf16 v[36:51], v[88:89], v[32:33], v[36:51]
    s_setprio 0
    v_cvt_pk_bf16_f32 v55, v58, v59
    v_exp_f32 v60, v60
    v_exp_f32 v61, v61
    v_exp_f32 v62, v62
    v_exp_f32 v63, v63
    v_cvt_pk_bf16_f32 v60, v60, v61
    s_waitcnt lgkmcnt(2)
    v_mfma_f32_32x32x16_bf16 v[68:83], v[92:95], v[52:55], v[68:83]
    ds_read_b128 v[92:95], v10 offset:2432
    v_exp_f32 v64, v64
    v_exp_f32 v65, v65
    v_exp_f32 v66, v66
    v_exp_f32 v67, v67
    v_cvt_pk_bf16_f32 v61, v62, v63
    v_cvt_pk_bf16_f32 v62, v64, v65
    v_cvt_pk_bf16_f32 v63, v66, v67
    s_sub_u32 s22, s3, 1
    s_cmp_le_u32 s22, 1
    s_cbranch_scc0 Lc_44
    s_call_b64 s[30:31], L_A_fetch
Lc_44:
    s_setprio 3
    v_exp_f32 v36, v36
    v_exp_f32 v37, v37
    s_waitcnt lgkmcnt(2)
    v_mfma_f32_32x32x16_bf16 v[68:83], v[96:99], v[60:63], v[68:83]
    ds_read_b128 v[96:99], v10 offset:3040
    v_exp_f32 v38, v38
    v_exp_f32 v39, v39
    v_exp_f32 v40, v40
    v_cvt_pk_bf16_f32 v36, v36, v37
    s_waitcnt lgkmcnt(2)
    v_mfma_f32_32x32x16_bf16 v[52:67], v[84:87], v[24:27], 0
    ds_read_b128 v[84:87], v8 offset:9472
    v_exp_f32 v41, v41
    v_exp_f32 v42, v42
    v_exp_f32 v43, v43
    v_cvt_pk_bf16_f32 v37, v38, v39
    v_cvt_pk_bf16_f32 v38, v40, v41
    v_mfma_f32_32x32x8_bf16 v[52:67], v[88:89], v[34:35], v[52:67]
    ds_read_b64 v[88:89], v9 offset:13568
    s_setprio 2
    v_cvt_pk_bf16_f32 v39, v42, v43
    v_exp_f32 v44, v44
    v_exp_f32 v45, v45
    v_exp_f32 v46, v46
    v_exp_f32 v47, v47
    v_cvt_pk_bf16_f32 v44, v44, v45
    s_waitcnt lgkmcnt(2)
    v_mfma_f32_32x32x16_bf16 v[68:83], v[92:95], v[36:39], v[68:83]
    ds_read_b128 v[92:95], v10 offset:3648
    v_exp_f32 v48, v48
    v_exp_f32 v49, v49
    v_exp_f32 v50, v50
    v_exp_f32 v51, v51
    v_cvt_pk_bf16_f32 v45, v46, v47
    v_cvt_pk_bf16_f32 v46, v48, v49
    v_cvt_pk_bf16_f32 v47, v50, v51
    s_setprio 1
    v_exp_f32 v52, v52
    v_exp_f32 v53, v53
    s_waitcnt lgkmcnt(2)
    v_mfma_f32_32x32x16_bf16 v[68:83], v[96:99], v[44:47], v[68:83]
    ds_read_b128 v[96:99], v10 offset:4256
    v_exp_f32 v54, v54
    v_exp_f32 v55, v55
    v_exp_f32 v56, v56
    v_cvt_pk_bf16_f32 v52, v52, v53
    s_waitcnt lgkmcnt(2)
    v_mfma_f32_32x32x16_bf16 v[36:51], v[84:87], v[24:27], 0
    ds_read_b128 v[84:87], v8 offset:10496
    v_exp_f32 v57, v57
    v_exp_f32 v58, v58
    v_exp_f32 v59, v59
    v_cvt_pk_bf16_f32 v53, v54, v55
    v_cvt_pk_bf16_f32 v54, v56, v57
    v_mfma_f32_32x32x8_bf16 v[36:51], v[88:89], v[28:29], v[36:51]
    s_setprio 0
    v_cvt_pk_bf16_f32 v55, v58, v59
    v_exp_f32 v60, v60
    v_exp_f32 v61, v61
    v_exp_f32 v62, v62
    v_exp_f32 v63, v63
    v_cvt_pk_bf16_f32 v60, v60, v61
    s_waitcnt lgkmcnt(2)
    v_mfma_f32_32x32x16_bf16 v[68:83], v[92:95], v[52:55], v[68:83]
    ds_read_b128 v[92:95], v10 offset:9472
    v_exp_f32 v64, v64
    v_exp_f32 v65, v65
    v_exp_f32 v66, v66
    v_exp_f32 v67, v67
    v_cvt_pk_bf16_f32 v61, v62, v63
    v_cvt_pk_bf16_f32 v62, v64, v65
    v_cvt_pk_bf16_f32 v63, v66, v67
    s_setprio 3
    v_exp_f32 v36, v36
    v_exp_f32 v37, v37
    s_waitcnt lgkmcnt(2)
    v_mfma_f32_32x32x16_bf16 v[68:83], v[96:99], v[60:63], v[68:83]
    ds_read_b128 v[96:99], v10 offset:10080
    v_exp_f32 v38, v38
    v_exp_f32 v39, v39
    v_exp_f32 v40, v40
    v_cvt_pk_bf16_f32 v36, v36, v37
    s_waitcnt lgkmcnt(2)
    v_mfma_f32_32x32x16_bf16 v[52:67], v[84:87], v[24:27], 0
    ds_read_b128 v[84:87], v8 offset:11520
    v_exp_f32 v41, v41
    v_exp_f32 v42, v42
    v_exp_f32 v43, v43
    v_cvt_pk_bf16_f32 v37, v38, v39
    v_cvt_pk_bf16_f32 v38, v40, v41
    v_mfma_f32_32x32x8_bf16 v[52:67], v[88:89], v[30:31], v[52:67]
    s_setprio 2
    v_cvt_pk_bf16_f32 v39, v42, v43
    v_exp_f32 v44, v44
    v_exp_f32 v45, v45
    v_exp_f32 v46, v46
    v_exp_f32 v47, v47
    v_cvt_pk_bf16_f32 v44, v44, v45
    s_waitcnt lgkmcnt(2)
    v_mfma_f32_32x32x16_bf16 v[68:83], v[92:95], v[36:39], v[68:83]
    ds_read_b128 v[92:95], v10 offset:10688
    v_exp_f32 v48, v48
    v_exp_f32 v49, v49
    v_exp_f32 v50, v50
    v_exp_f32 v51, v51
    v_cvt_pk_bf16_f32 v45, v46, v47
    v_cvt_pk_bf16_f32 v46, v48, v49
    v_cvt_pk_bf16_f32 v47, v50, v51
    s_setprio 1
    v_exp_f32 v52, v52
    v_exp_f32 v53, v53
    s_waitcnt lgkmcnt(2)
    v_mfma_f32_32x32x16_bf16 v[68:83], v[96:99], v[44:47], v[68:83]
    ds_read_b128 v[96:99], v10 offset:11296
    v_exp_f32 v54, v54
    v_exp_f32 v55, v55
    v_exp_f32 v56, v56
    v_cvt_pk_bf16_f32 v52, v52, v53
    s_waitcnt lgkmcnt(2)
    v_mfma_f32_32x32x16_bf16 v[36:51], v[84:87], v[24:27], 0
    ds_read_b128 v[84:87], v8 offset:12544
    v_exp_f32 v57, v57
    v_exp_f32 v58, v58
    v_exp_f32 v59, v59
    v_cvt_pk_bf16_f32 v53, v54, v55
    v_cvt_pk_bf16_f32 v54, v56, v57
    v_mfma_f32_32x32x8_bf16 v[36:51], v[88:89], v[32:33], v[36:51]
    s_setprio 0
    v_cvt_pk_bf16_f32 v55, v58, v59
    v_exp_f32 v60, v60
    v_exp_f32 v61, v61
    v_exp_f32 v62, v62
    v_exp_f32 v63, v63
    v_cvt_pk_bf16_f32 v60, v60, v61
    s_waitcnt lgkmcnt(2)
    v_mfma_f32_32x32x16_bf16 v[68:83], v[92:95], v[52:55], v[68:83]
    ds_read_b128 v[92:95], v10 offset:11904
    v_exp_f32 v64, v64
    v_exp_f32 v65, v65
    v_exp_f32 v66, v66
    v_exp_f32 v67, v67
    v_cvt_pk_bf16_f32 v61, v62, v63
    v_cvt_pk_bf16_f32 v62, v64, v65
    v_cvt_pk_bf16_f32 v63, v66, v67
    s_waitcnt vmcnt(0)
    s_barrier
    s_sub_u32 s22, s3, 3
    s_cmp_le_u32 s22, 1
    s_cbranch_scc0 Lc_45
    s_call_b64 s[30:31], L_A_fetch
Lc_45:
    s_sub_u32 s22, s3, 0
    s_cmp_le_u32 s22, 2
    s_cbranch_scc0 Lc_46
    s_call_b64 s[30:31], L_defer
Lc_46:
    s_setprio 3
    v_exp_f32 v36, v36
    v_exp_f32 v37, v37
    s_waitcnt lgkmcnt(2)
    v_mfma_f32_32x32x16_bf16 v[68:83], v[96:99], v[60:63], v[68:83]
    ds_read_b128 v[96:99], v10 offset:12512
    v_exp_f32 v38, v38
    v_exp_f32 v39, v39
    v_exp_f32 v40, v40
    v_cvt_pk_bf16_f32 v36, v36, v37
    s_waitcnt lgkmcnt(2)
    v_mfma_f32_32x32x16_bf16 v[52:67], v[84:87], v[24:27], 0
    ds_read_b128 v[84:87], v8 offset:18944
    v_exp_f32 v41, v41
    v_exp_f32 v42, v42
    v_exp_f32 v43, v43
    v_cvt_pk_bf16_f32 v37, v38, v39
    v_cvt_pk_bf16_f32 v38, v40, v41
    v_mfma_f32_32x32x8_bf16 v[52:67], v[88:89], v[34:35], v[52:67]
    ds_read_b64 v[88:89], v9 offset:23040
    s_setprio 2
    v_cvt_pk_bf16_f32 v39, v42, v43
    v_exp_f32 v44, v44
    v_exp_f32 v45, v45
    v_exp_f32 v46, v46
    v_exp_f32 v47, v47
    v_cvt_pk_bf16_f32 v44, v44, v45
    s_waitcnt lgkmcnt(2)
    v_mfma_f32_32x32x16_bf16 v[68:83], v[92:95], v[36:39], v[68:83]
    ds_read_b128 v[92:95], v10 offset:13120
    v_exp_f32 v48, v48
    v_exp_f32 v49, v49
    v_exp_f32 v50, v50
    v_exp_f32 v51, v51
    v_cvt_pk_bf16_f32 v45, v46, v47
    v_cvt_pk_bf16_f32 v46, v48, v49
    v_cvt_pk_bf16_f32 v47, v50, v51
    s_setprio 1
    v_exp_f32 v52, v52
    v_exp_f32 v53, v53
    s_waitcnt lgkmcnt(2)
    v_mfma_f32_32x32x16_bf16 v[68:83], v[96:99], v[44:47], v[68:83]
    ds_read_b128 v[96:99], v10 offset:13728
    v_exp_f32 v54, v54
    v_exp_f32 v55, v55
    v_exp_f32 v56, v56
    v_cvt_pk_bf16_f32 v52, v52, v53
    s_waitcnt lgkmcnt(2)
    v_mfma_f32_32x32x16_bf16 v[36:51], v[84:87], v[24:27], 0
    ds_read_b128 v[84:87], v8 offset:19968
    v_exp_f32 v57, v57
    v_exp_f32 v58, v58
    v_exp_f32 v59, v59
    v_cvt_pk_bf16_f32 v53, v54, v55
    v_cvt_pk_bf16_f32 v54, v56, v57
    v_mfma_f32_32x32x8_bf16 v[36:51], v[88:89], v[28:29], v[36:51]
    s_setprio 0
    v_cvt_pk_bf16_f32 v55, v58, v59
    v_exp_f32 v60, v60
    v_exp_f32 v61, v61
    v_exp_f32 v62, v62
    v_exp_f32 v63, v63
    v_cvt_pk_bf16_f32 v60, v60, v61
    s_waitcnt lgkmcnt(2)
    v_mfma_f32_32x32x16_bf16 v[68:83], v[92:95], v[52:55], v[68:83]
    ds_read_b128 v[92:95], v10 offset:18944
    v_exp_f32 v64, v64
    v_exp_f32 v65, v65
    v_exp_f32 v66, v66
    v_exp_f32 v67, v67
    v_cvt_pk_bf16_f32 v61, v62, v63
    v_cvt_pk_bf16_f32 v62, v64, v65
    v_cvt_pk_bf16_f32 v63, v66, v67
    s_setprio 3
    v_exp_f32 v36, v36
    v_exp_f32 v37, v37
    s_waitcnt lgkmcnt(2)
    v_mfma_f32_32x32x16_bf16 v[68:83], v[96:99], v[60:63], v[68:83]
    ds_read_b128 v[96:99], v10 offset:19552
    v_exp_f32 v38, v38
    v_exp_f32 v39, v39
    v_exp_f32 v40, v40
    v_cvt_pk_bf16_f32 v36, v36, v37
    s_waitcnt lgkmcnt(2)
    v_mfma_f32_32x32x16_bf16 v[52:67], v[84:87], v[24:27], 0
    ds_read_b128 v[84:87], v8 offset:20992
    v_exp_f32 v41, v41
    v_exp_f32 v42, v42
    v_exp_f32 v43, v43
    v_cvt_pk_bf16_f32 v37, v38, v39
    v_cvt_pk_bf16_f32 v38, v40, v41
    v_mfma_f32_32x32x8_bf16 v[52:67], v[88:89], v[30:31], v[52:67]
    s_setprio 2
    v_cvt_pk_bf16_f32 v39, v42, v43
    v_exp_f32 v44, v44
    v_exp_f32 v45, v45
    v_exp_f32 v46, v46
    v_exp_f32 v47, v47
    v_cvt_pk_bf16_f32 v44, v44, v45
    s_waitcnt lgkmcnt(2)
    v_mfma_f32_32x32x16_bf16 v[68:83], v[92:95], v[36:39], v[68:83]
    ds_read_b128 v[92:95], v10 offset:20160
    v_exp_f32 v48, v48
    v_exp_f32 v49, v49
    v_exp_f32 v50, v50
    v_exp_f32 v51, v51
    v_cvt_pk_bf16_f32 v45, v46, v47
    v_cvt_pk_bf16_f32 v46, v48, v49
    v_cvt_pk_bf16_f32 v47, v50, v51
    s_setprio 1
    v_exp_f32 v52, v52
    v_exp_f32 v53, v53
    s_waitcnt lgkmcnt(2)
    v_mfma_f32_32x32x16_bf16 v[68:83], v[96:99], v[44:47], v[68:83]
    ds_read_b128 v[96:99], v10 offset:20768
    v_exp_f32 v54, v54
    v_exp_f32 v55, v55
    v_exp_f32 v56, v56
    v_cvt_pk_bf16_f32 v52, v52, v53
    s_waitcnt lgkmcnt(2)
    v_mfma_f32_32x32x16_bf16 v[36:51], v[84:87], v[24:27], 0
    ds_read_b128 v[84:87], v8 offset:22016
    v_exp_f32 v57, v57
    v_exp_f32 v58, v58
    v_exp_f32 v59, v59
    v_cvt_pk_bf16_f32 v53, v54, v55
    v_cvt_pk_bf16_f32 v54, v56, v57
    v_mfma_f32_32x32x8_bf16 v[36:51], v[88:89], v[32:33], v[36:51]
    s_setprio 0
    v_cvt_pk_bf16_f32 v55, v58, v59
    v_exp_f32 v60, v60
    v_exp_f32 v61, v61
    v_exp_f32 v62, v62
    v_exp_f32 v63, v63
    v_cvt_pk_bf16_f32 v60, v60, v61
    s_waitcnt lgkmcnt(2)
    v_mfma_f32_32x32x16_bf16 v[68:83], v[92:95], v[52:55], v[68:83]
    ds_read_b128 v[92:95], v10 offset:21376
    v_exp_f32 v64, v64
    v_exp_f32 v65, v65
    v_exp_f32 v66, v66
    v_exp_f32 v67, v67
    v_cvt_pk_bf16_f32 v61, v62, v63
    v_cvt_pk_bf16_f32 v62, v64, v65
    v_cvt_pk_bf16_f32 v63, v66, v67
    s_sub_u32 s22, s3, 5
    s_cmp_le_u32 s22, 1
    s_cbranch_scc0 Lc_47
    s_call_b64 s[30:31], L_A_fetch
Lc_47:
    s_setprio 3
    v_exp_f32 v36, v36
    v_exp_f32 v37, v37
    s_waitcnt lgkmcnt(2)
    v_mfma_f32_32x32x16_bf16 v[68:83], v[96:99], v[60:63], v[68:83]
    ds_read_b128 v[96:99], v10 offset:21984
    v_exp_f32 v38, v38
    v_exp_f32 v39, v39
    v_exp_f32 v40, v40
    v_cvt_pk_bf16_f32 v36, v36, v37
    s_waitcnt lgkmcnt(2)
    v_mfma_f32_32x32x16_bf16 v[52:67], v[84:87], v[24:27], 0
    ds_read_b128 v[84:87], v8 offset:28416
    v_exp_f32 v41, v41
    v_exp_f32 v42, v42
    v_exp_f32 v43, v43
    v_cvt_pk_bf16_f32 v37, v38, v39
    v_cvt_pk_bf16_f32 v38, v40, v41
    v_mfma_f32_32x32x8_bf16 v[52:67], v[88:89], v[34:35], v[52:67]
    ds_read_b64 v[88:89], v9 offset:32512
    s_setprio 2
    v_cvt_pk_bf16_f32 v39, v42, v43
    v_exp_f32 v44, v44
    v_exp_f32 v45, v45
    v_exp_f32 v46, v46
    v_exp_f32 v47, v47
    v_cvt_pk_bf16_f32 v44, v44, v45
    s_waitcnt lgkmcnt(2)
    v_mfma_f32_32x32x16_bf16 v[68:83], v[92:95], v[36:39], v[68:83]
    ds_read_b128 v[92:95], v10 offset:22592
    v_exp_f32 v48, v48
    v_exp_f32 v49, v49
    v_exp_f32 v50, v50
    v_exp_f32 v51, v51
    v_cvt_pk_bf16_f32 v45, v46, v47
    v_cvt_pk_bf16_f32 v46, v48, v49
    v_cvt_pk_bf16_f32 v47, v50, v51
    s_setprio 1
    v_exp_f32 v52, v52
    v_exp_f32 v53, v53
    s_waitcnt lgkmcnt(2)
    v_mfma_f32_32x32x16_bf16 v[68:83], v[96:99], v[44:47], v[68:83]
    ds_read_b128 v[96:99], v10 offset:23200
    v_exp_f32 v54, v54
    v_exp_f32 v55, v55
    v_exp_f32 v56, v56
    v_cvt_pk_bf16_f32 v52, v52, v53
    s_waitcnt lgkmcnt(2)
    v_mfma_f32_32x32x16_bf16 v[36:51], v[84:87], v[24:27], 0
    ds_read_b128 v[84:87], v8 offset:29440
    v_exp_f32 v57, v57
    v_exp_f32 v58, v58
    v_exp_f32 v59, v59
    v_cvt_pk_bf16_f32 v53, v54, v55
    v_cvt_pk_bf16_f32 v54, v56, v57
    v_mfma_f32_32x32x8_bf16 v[36:51], v[88:89], v[28:29], v[36:51]
    s_setprio 0
    v_cvt_pk_bf16_f32 v55, v58, v59
    v_exp_f32 v60, v60
    v_exp_f32 v61, v61
    v_exp_f32 v62, v62
    v_exp_f32 v63, v63
    v_cvt_pk_bf16_f32 v60, v60, v61
    s_waitcnt lgkmcnt(2)
    v_mfma_f32_32x32x16_bf16 v[68:83], v[92:95], v[52:55], v[68:83]
    ds_read_b128 v[92:95], v10 offset:28416
    v_exp_f32 v64, v64
    v_exp_f32 v65, v65
    v_exp_f32 v66, v66
    v_exp_f32 v67, v67
    v_cvt_pk_bf16_f32 v61, v62, v63
    v_cvt_pk_bf16_f32 v62, v64, v65
    v_cvt_pk_bf16_f32 v63, v66, v67
    s_setprio 3
    v_exp_f32 v36, v36
    v_exp_f32 v37, v37
    s_waitcnt lgkmcnt(2)
    v_mfma_f32_32x32x16_bf16 v[68:83], v[96:99], v[60:63], v[68:83]
    ds_read_b128 v[96:99], v10 offset:29024
    v_exp_f32 v38, v38
    v_exp_f32 v39, v39
    v_exp_f32 v40, v40
    v_cvt_pk_bf16_f32 v36, v36, v37
    s_waitcnt lgkmcnt(2)
    v_mfma_f32_32x32x16_bf16 v[52:67], v[84:87], v[24:27], 0
    ds_read_b128 v[84:87], v8 offset:30464
    v_exp_f32 v41, v41
    v_exp_f32 v42, v42
    v_exp_f32 v43, v43
    v_cvt_pk_bf16_f32 v37, v38, v39
    v_cvt_pk_bf16_f32 v38, v40, v41
    v_mfma_f32_32x32x8_bf16 v[52:67], v[88:89], v[30:31], v[52:67]
    s_setprio 2
    v_cvt_pk_bf16_f32 v39, v42, v43
    v_exp_f32 v44, v44
    v_exp_f32 v45, v45
    v_exp_f32 v46, v46
    v_exp_f32 v47, v47
    v_cvt_pk_bf16_f32 v44, v44, v45
    s_waitcnt lgkmcnt(2)
    v_mfma_f32_32x32x16_bf16 v[68:83], v[92:95], v[36:39], v[68:83]
    ds_read_b128 v[92:95], v10 offset:29632
    v_exp_f32 v48, v48
    v_exp_f32 v49, v49
    v_exp_f32 v50, v50
    v_exp_f32 v51, v51
    v_cvt_pk_bf16_f32 v45, v46, v47
    v_cvt_pk_bf16_f32 v46, v48, v49
    v_cvt_pk_bf16_f32 v47, v50, v51
    s_setprio 1
    v_exp_f32 v52, v52
    v_exp_f32 v53, v53
    s_waitcnt lgkmcnt(2)
    v_mfma_f32_32x32x16_bf16 v[68:83], v[96:99], v[44:47], v[68:83]
    ds_read_b128 v[96:99], v10 offset:30240
    v_exp_f32 v54, v54
    v_exp_f32 v55, v55
    v_exp_f32 v56, v56
    v_cvt_pk_bf16_f32 v52, v52, v53
    s_waitcnt lgkmcnt(2)
    v_mfma_f32_32x32x16_bf16 v[36:51], v[84:87], v[24:27], 0
    ds_read_b128 v[84:87], v8 offset:31488
    v_exp_f32 v57, v57
    v_exp_f32 v58, v58
    v_exp_f32 v59, v59
    v_cvt_pk_bf16_f32 v53, v54, v55
    v_cvt_pk_bf16_f32 v54, v56, v57
    v_mfma_f32_32x32x8_bf16 v[36:51], v[88:89], v[32:33], v[36:51]
    s_setprio 0
    v_cvt_pk_bf16_f32 v55, v58, v59
    v_exp_f32 v60, v60
    v_exp_f32 v61, v61
    v_exp_f32 v62, v62
    v_exp_f32 v63, v63
    v_cvt_pk_bf16_f32 v60, v60, v61
    s_waitcnt lgkmcnt(2)
    v_mfma_f32_32x32x16_bf16 v[68:83], v[92:95], v[52:55], v[68:83]
    ds_read_b128 v[92:95], v10 offset:30848
    v_exp_f32 v64, v64
    v_exp_f32 v65, v65
    v_exp_f32 v66, v66
    v_exp_f32 v67, v67
    v_cvt_pk_bf16_f32 v61, v62, v63
    v_cvt_pk_bf16_f32 v62, v64, v65
    v_cvt_pk_bf16_f32 v63, v66, v67
    s_cmp_eq_u32 s3, 7
    s_cbranch_scc0 Lc_48
    s_call_b64 s[30:31], L_A_fetch
Lc_48:
    s_setprio 3
    v_exp_f32 v36, v36
    v_exp_f32 v37, v37
    s_waitcnt lgkmcnt(2)
    v_mfma_f32_32x32x16_bf16 v[68:83], v[96:99], v[60:63], v[68:83]
    ds_read_b128 v[96:99], v10 offset:31456
    v_exp_f32 v38, v38
    v_exp_f32 v39, v39
    v_exp_f32 v40, v40
    v_cvt_pk_bf16_f32 v36, v36, v37
    s_waitcnt lgkmcnt(2)
    v_mfma_f32_32x32x16_bf16 v[52:67], v[84:87], v[24:27], 0
    ds_read_b128 v[84:87], v8 offset:37888
    v_exp_f32 v41, v41
    v_exp_f32 v42, v42
    v_exp_f32 v43, v43
    v_cvt_pk_bf16_f32 v37, v38, v39
    v_cvt_pk_bf16_f32 v38, v40, v41
    v_mfma_f32_32x32x8_bf16 v[52:67], v[88:89], v[34:35], v[52:67]
    ds_read_b64 v[88:89], v9 offset:41984
    s_setprio 2
    v_cvt_pk_bf16_f32 v39, v42, v43
    v_exp_f32 v44, v44
    v_exp_f32 v45, v45
    v_exp_f32 v46, v46
    v_exp_f32 v47, v47
    v_cvt_pk_bf16_f32 v44, v44, v45
    s_waitcnt lgkmcnt(2)
    v_mfma_f32_32x32x16_bf16 v[68:83], v[92:95], v[36:39], v[68:83]
    ds_read_b128 v[92:95], v10 offset:32064
    v_exp_f32 v48, v48
    v_exp_f32 v49, v49
    v_exp_f32 v50, v50
    v_exp_f32 v51, v51
    v_cvt_pk_bf16_f32 v45, v46, v47
    v_cvt_pk_bf16_f32 v46, v48, v49
    v_cvt_pk_bf16_f32 v47, v50, v51
    s_setprio 1
    v_exp_f32 v52, v52
    v_exp_f32 v53, v53
    s_waitcnt lgkmcnt(2)
    v_mfma_f32_32x32x16_bf16 v[68:83], v[96:99], v[44:47], v[68:83]
    ds_read_b128 v[96:99], v10 offset:32672
    v_exp_f32 v54, v54
    v_exp_f32 v55, v55
    v_exp_f32 v56, v56
    v_cvt_pk_bf16_f32 v52, v52, v53
    s_waitcnt lgkmcnt(2)
    v_mfma_f32_32x32x16_bf16 v[36:51], v[84:87], v[24:27], 0
    ds_read_b128 v[84:87], v8 offset:38912
    v_exp_f32 v57, v57
    v_exp_f32 v58, v58
    v_exp_f32 v59, v59
    v_cvt_pk_bf16_f32 v53, v54, v55
    v_cvt_pk_bf16_f32 v54, v56, v57
    v_mfma_f32_32x32x8_bf16 v[36:51], v[88:89], v[28:29], v[36:51]
    s_setprio 0
    v_cvt_pk_bf16_f32 v55, v58, v59
    v_exp_f32 v60, v60
    v_exp_f32 v61, v61
    v_exp_f32 v62, v62
    v_exp_f32 v63, v63
    v_cvt_pk_bf16_f32 v60, v60, v61
    s_waitcnt lgkmcnt(2)
    v_mfma_f32_32x32x16_bf16 v[68:83], v[92:95], v[52:55], v[68:83]
    ds_read_b128 v[92:95], v10 offset:37888
    v_exp_f32 v64, v64
    v_exp_f32 v65, v65
    v_exp_f32 v66, v66
    v_exp_f32 v67, v67
    v_cvt_pk_bf16_f32 v61, v62, v63
    v_cvt_pk_bf16_f32 v62, v64, v65
    v_cvt_pk_bf16_f32 v63, v66, v67
    s_setprio 3
    v_exp_f32 v36, v36
    v_exp_f32 v37, v37
    s_waitcnt lgkmcnt(2)
    v_mfma_f32_32x32x16_bf16 v[68:83], v[96:99], v[60:63], v[68:83]
    ds_read_b128 v[96:99], v10 offset:38496
    v_exp_f32 v38, v38
    v_exp_f32 v39, v39
    v_exp_f32 v40, v40
    v_cvt_pk_bf16_f32 v36, v36, v37
    s_waitcnt lgkmcnt(2)
    v_mfma_f32_32x32x16_bf16 v[52:67], v[84:87], v[24:27], 0
    ds_read_b128 v[84:87], v8 offset:39936
    v_exp_f32 v41, v41
    v_exp_f32 v42, v42
    v_exp_f32 v43, v43
    v_cvt_pk_bf16_f32 v37, v38, v39
    v_cvt_pk_bf16_f32 v38, v40, v41
    v_mfma_f32_32x32x8_bf16 v[52:67], v[88:89], v[30:31], v[52:67]
    s_setprio 2
    v_cvt_pk_bf16_f32 v39, v42, v43
    v_exp_f32 v44, v44
    v_exp_f32 v45, v45
    v_exp_f32 v46, v46
    v_exp_f32 v47, v47
    v_cvt_pk_bf16_f32 v44, v44, v45
    s_waitcnt lgkmcnt(2)
    v_mfma_f32_32x32x16_bf16 v[68:83], v[92:95], v[36:39], v[68:83]
    ds_read_b128 v[92:95], v10 offset:39104
    v_exp_f32 v48, v48
    v_exp_f32 v49, v49
    v_exp_f32 v50, v50
    v_exp_f32 v51, v51
    v_cvt_pk_bf16_f32 v45, v46, v47
    v_cvt_pk_bf16_f32 v46, v48, v49
    v_cvt_pk_bf16_f32 v47, v50, v51
    s_setprio 1
    v_exp_f32 v52, v52
    v_exp_f32 v53, v53
    s_waitcnt lgkmcnt(2)
    v_mfma_f32_32x32x16_bf16 v[68:83], v[96:99], v[44:47], v[68:83]
    ds_read_b128 v[96:99], v10 offset:39712
    v_exp_f32 v54, v54
    v_exp_f32 v55, v55
    v_exp_f32 v56, v56
    v_cvt_pk_bf16_f32 v52, v52, v53
    s_waitcnt lgkmcnt(2)
    v_mfma_f32_32x32x16_bf16 v[36:51], v[84:87], v[24:27], 0
    ds_read_b128 v[84:87], v8 offset:40960
    v_exp_f32 v57, v57
    v_exp_f32 v58, v58
    v_exp_f32 v59, v59
    v_cvt_pk_bf16_f32 v53, v54, v55
    v_cvt_pk_bf16_f32 v54, v56, v57
    v_mfma_f32_32x32x8_bf16 v[36:51], v[88:89], v[32:33], v[36:51]
    s_setprio 0
    v_cvt_pk_bf16_f32 v55, v58, v59
    v_exp_f32 v60, v60
    v_exp_f32 v61, v61
    v_exp_f32 v62, v62
    v_exp_f32 v63, v63
    v_cvt_pk_bf16_f32 v60, v60, v61
    s_waitcnt lgkmcnt(2)
    v_mfma_f32_32x32x16_bf16 v[68:83], v[92:95], v[52:55], v[68:83]
    ds_read_b128 v[92:95], v10 offset:40320
    v_exp_f32 v64, v64
    v_exp_f32 v65, v65
    v_exp_f32 v66, v66
    v_exp_f32 v67, v67
    v_cvt_pk_bf16_f32 v61, v62, v63
    v_cvt_pk_bf16_f32 v62, v64, v65
    v_cvt_pk_bf16_f32 v63, v66, v67
    s_setprio 3
    v_exp_f32 v36, v36
    v_exp_f32 v37, v37
    s_waitcnt lgkmcnt(2)
    v_mfma_f32_32x32x16_bf16 v[68:83], v[96:99], v[60:63], v[68:83]
    ds_read_b128 v[96:99], v10 offset:40928
    v_exp_f32 v38, v38
    v_exp_f32 v39, v39
    v_exp_f32 v40, v40
    v_cvt_pk_bf16_f32 v36, v36, v37
    s_waitcnt lgkmcnt(2)
    v_mfma_f32_32x32x16_bf16 v[52:67], v[84:87], v[24:27], 0
    ds_read_b128 v[84:87], v8 offset:47360
    v_exp_f32 v41, v41
    v_exp_f32 v42, v42
    v_exp_f32 v43, v43
    v_cvt_pk_bf16_f32 v37, v38, v39
    v_cvt_pk_bf16_f32 v38, v40, v41
    v_mfma_f32_32x32x8_bf16 v[52:67], v[88:89], v[34:35], v[52:67]
    ds_read_b64 v[88:89], v9 offset:51456
    s_setprio 2
    v_cvt_pk_bf16_f32 v39, v42, v43
    v_exp_f32 v44, v44
    v_exp_f32 v45, v45
    v_exp_f32 v46, v46
    v_exp_f32 v47, v47
    v_cvt_pk_bf16_f32 v44, v44, v45
    s_waitcnt lgkmcnt(2)
    v_mfma_f32_32x32x16_bf16 v[68:83], v[92:95], v[36:39], v[68:83]
    ds_read_b128 v[92:95], v10 offset:41536
    v_exp_f32 v48, v48
    v_exp_f32 v49, v49
    v_exp_f32 v50, v50
    v_exp_f32 v51, v51
    v_cvt_pk_bf16_f32 v45, v46, v47
    v_cvt_pk_bf16_f32 v46, v48, v49
    v_cvt_pk_bf16_f32 v47, v50, v51
    s_setprio 1
    v_exp_f32 v52, v52
    v_exp_f32 v53, v53
    s_waitcnt lgkmcnt(2)
    v_mfma_f32_32x32x16_bf16 v[68:83], v[96:99], v[44:47], v[68:83]
    ds_read_b128 v[96:99], v10 offset:42144
    v_exp_f32 v54, v54
    v_exp_f32 v55, v55
    v_exp_f32 v56, v56
    v_cvt_pk_bf16_f32 v52, v52, v53
    s_waitcnt lgkmcnt(2)
    v_mfma_f32_32x32x16_bf16 v[36:51], v[84:87], v[24:27], 0
    ds_read_b128 v[84:87], v8 offset:48384
    v_exp_f32 v57, v57
    v_exp_f32 v58, v58
    v_exp_f32 v59, v59
    v_cvt_pk_bf16_f32 v53, v54, v55
    v_cvt_pk_bf16_f32 v54, v56, v57
    v_mfma_f32_32x32x8_bf16 v[36:51], v[88:89], v[28:29], v[36:51]
    s_setprio 0
    v_cvt_pk_bf16_f32 v55, v58, v59
    v_exp_f32 v60, v60
    v_exp_f32 v61, v61
    v_exp_f32 v62, v62
    v_exp_f32 v63, v63
    v_cvt_pk_bf16_f32 v60, v60, v61
    s_waitcnt lgkmcnt(2)
    v_mfma_f32_32x32x16_bf16 v[68:83], v[92:95], v[52:55], v[68:83]
    ds_read_b128 v[92:95], v10 offset:47360
    v_exp_f32 v64, v64
    v_exp_f32 v65, v65
    v_exp_f32 v66, v66
    v_exp_f32 v67, v67
    v_cvt_pk_bf16_f32 v61, v62, v63
    v_cvt_pk_bf16_f32 v62, v64, v65
    v_cvt_pk_bf16_f32 v63, v66, v67
    s_setprio 3
    v_exp_f32 v36, v36
    v_exp_f32 v37, v37
    s_waitcnt lgkmcnt(2)
    v_mfma_f32_32x32x16_bf16 v[68:83], v[96:99], v[60:63], v[68:83]
    ds_read_b128 v[96:99], v10 offset:47968
    v_exp_f32 v38, v38
    v_exp_f32 v39, v39
    v_exp_f32 v40, v40
    v_cvt_pk_bf16_f32 v36, v36, v37
    s_waitcnt lgkmcnt(2)
    v_mfma_f32_32x32x16_bf16 v[52:67], v[84:87], v[24:27], 0
    ds_read_b128 v[84:87], v8 offset:49408
    v_exp_f32 v41, v41
    v_exp_f32 v42, v42
    v_exp_f32 v43, v43
    v_cvt_pk_bf16_f32 v37, v38, v39
    v_cvt_pk_bf16_f32 v38, v40, v41
    v_mfma_f32_32x32x8_bf16 v[52:67], v[88:89], v[30:31], v[52:67]
    s_setprio 2
    v_cvt_pk_bf16_f32 v39, v42, v43
    v_exp_f32 v44, v44
    v_exp_f32 v45, v45
    v_exp_f32 v46, v46
    v_exp_f32 v47, v47
    v_cvt_pk_bf16_f32 v44, v44, v45
    s_waitcnt lgkmcnt(2)
    v_mfma_f32_32x32x16_bf16 v[68:83], v[92:95], v[36:39], v[68:83]
    ds_read_b128 v[92:95], v10 offset:48576
    v_exp_f32 v48, v48
    v_exp_f32 v49, v49
    v_exp_f32 v50, v50
    v_exp_f32 v51, v51
    v_cvt_pk_bf16_f32 v45, v46, v47
    v_cvt_pk_bf16_f32 v46, v48, v49
    v_cvt_pk_bf16_f32 v47, v50, v51
    s_setprio 1
    v_exp_f32 v52, v52
    v_exp_f32 v53, v53
    s_waitcnt lgkmcnt(2)
    v_mfma_f32_32x32x16_bf16 v[68:83], v[96:99], v[44:47], v[68:83]
    ds_read_b128 v[96:99], v10 offset:49184
    v_exp_f32 v54, v54
    v_exp_f32 v55, v55
    v_exp_f32 v56, v56
    v_cvt_pk_bf16_f32 v52, v52, v53
    s_waitcnt lgkmcnt(2)
    v_mfma_f32_32x32x16_bf16 v[36:51], v[84:87], v[24:27], 0
    ds_read_b128 v[84:87], v8 offset:50432
    v_exp_f32 v57, v57
    v_exp_f32 v58, v58
    v_exp_f32 v59, v59
    v_cvt_pk_bf16_f32 v53, v54, v55
    v_cvt_pk_bf16_f32 v54, v56, v57
    v_mfma_f32_32x32x8_bf16 v[36:51], v[88:89], v[32:33], v[36:51]
    s_setprio 0
    v_cvt_pk_bf16_f32 v55, v58, v59
    v_exp_f32 v60, v60
    v_exp_f32 v61, v61
    v_exp_f32 v62, v62
    v_exp_f32 v63, v63
    v_cvt_pk_bf16_f32 v60, v60, v61
    s_waitcnt lgkmcnt(2)
    v_mfma_f32_32x32x16_bf16 v[68:83], v[92:95], v[52:55], v[68:83]
    ds_read_b128 v[92:95], v10 offset:49792
    v_exp_f32 v64, v64
    v_exp_f32 v65, v65
    v_exp_f32 v66, v66
    v_exp_f32 v67, v67
    v_cvt_pk_bf16_f32 v61, v62, v63
    v_cvt_pk_bf16_f32 v62, v64, v65
    v_cvt_pk_bf16_f32 v63, v66, v67
    s_waitcnt vmcnt(0)
    s_barrier
    s_cmp_eq_u32 s3, 1
    s_cbranch_scc0 Lc_49
    s_call_b64 s[30:31], L_A_pflag
Lc_49:
    s_setprio 3
    v_exp_f32 v36, v36
    v_exp_f32 v37, v37
    s_waitcnt lgkmcnt(2)
    v_mfma_f32_32x32x16_bf16 v[68:83], v[96:99], v[60:63], v[68:83]
    ds_read_b128 v[96:99], v10 offset:50400
    v_exp_f32 v38, v38
    v_exp_f32 v39, v39
    v_exp_f32 v40, v40
    v_cvt_pk_bf16_f32 v36, v36, v37
    s_waitcnt lgkmcnt(2)
    v_mfma_f32_32x32x16_bf16 v[52:67], v[84:87], v[24:27], 0
    ds_read_b128 v[84:87], v8 offset:56832
    v_exp_f32 v41, v41
    v_exp_f32 v42, v42
    v_exp_f32 v43, v43
    v_cvt_pk_bf16_f32 v37, v38, v39
    v_cvt_pk_bf16_f32 v38, v40, v41
    v_mfma_f32_32x32x8_bf16 v[52:67], v[88:89], v[34:35], v[52:67]
    ds_read_b64 v[88:89], v9 offset:60928
    s_setprio 2
    v_cvt_pk_bf16_f32 v39, v42, v43
    v_exp_f32 v44, v44
    v_exp_f32 v45, v45
    v_exp_f32 v46, v46
    v_exp_f32 v47, v47
    v_cvt_pk_bf16_f32 v44, v44, v45
    s_waitcnt lgkmcnt(2)
    v_mfma_f32_32x32x16_bf16 v[68:83], v[92:95], v[36:39], v[68:83]
    ds_read_b128 v[92:95], v10 offset:51008
    v_exp_f32 v48, v48
    v_exp_f32 v49, v49
    v_exp_f32 v50, v50
    v_exp_f32 v51, v51
    v_cvt_pk_bf16_f32 v45, v46, v47
    v_cvt_pk_bf16_f32 v46, v48, v49
    v_cvt_pk_bf16_f32 v47, v50, v51
    s_sub_u32 s22, s3, 0
    s_cmp_le_u32 s22, 3
    s_cbranch_scc0 Lc_50
    s_call_b64 s[30:31], L_A_touch
Lc_50:
    s_setprio 1
    v_exp_f32 v52, v52
    v_exp_f32 v53, v53
    s_waitcnt lgkmcnt(2)
    v_mfma_f32_32x32x16_bf16 v[68:83], v[96:99], v[44:47], v[68:83]
    ds_read_b128 v[96:99], v10 offset:51616
    v_exp_f32 v54, v54
    v_exp_f32 v55, v55
    v_exp_f32 v56, v56
    v_cvt_pk_bf16_f32 v52, v52, v53
    s_waitcnt lgkmcnt(2)
    v_mfma_f32_32x32x16_bf16 v[36:51], v[84:87], v[24:27], 0
    ds_read_b128 v[84:87], v8 offset:57856
    v_exp_f32 v57, v57
    v_exp_f32 v58, v58
    v_exp_f32 v59, v59
    v_cvt_pk_bf16_f32 v53, v54, v55
    v_cvt_pk_bf16_f32 v54, v56, v57
    v_mfma_f32_32x32x8_bf16 v[36:51], v[88:89], v[28:29], v[36:51]
    s_setprio 0
    v_cvt_pk_bf16_f32 v55, v58, v59
    v_exp_f32 v60, v60
    v_exp_f32 v61, v61
    v_exp_f32 v62, v62
    v_exp_f32 v63, v63
    v_cvt_pk_bf16_f32 v60, v60, v61
    s_waitcnt lgkmcnt(2)
    v_mfma_f32_32x32x16_bf16 v[68:83], v[92:95], v[52:55], v[68:83]
    ds_read_b128 v[92:95], v10 offset:56832
    v_exp_f32 v64, v64
    v_exp_f32 v65, v65
    v_exp_f32 v66, v66
    v_exp_f32 v67, v67
    v_cvt_pk_bf16_f32 v61, v62, v63
    v_cvt_pk_bf16_f32 v62, v64, v65
    v_cvt_pk_bf16_f32 v63, v66, v67
    s_setprio 3
    v_exp_f32 v36, v36
    v_exp_f32 v37, v37
    s_waitcnt lgkmcnt(2)
    v_mfma_f32_32x32x16_bf16 v[68:83], v[96:99], v[60:63], v[68:83]
    ds_read_b128 v[96:99], v10 offset:57440
    v_exp_f32 v38, v38
    v_exp_f32 v39, v39
    v_exp_f32 v40, v40
    v_cvt_pk_bf16_f32 v36, v36, v37
    s_waitcnt lgkmcnt(2)
    v_mfma_f32_32x32x16_bf16 v[52:67], v[84:87], v[24:27], 0
    ds_read_b128 v[84:87], v8 offset:58880
    v_exp_f32 v41, v41
    v_exp_f32 v42, v42
    v_exp_f32 v43, v43
    v_cvt_pk_bf16_f32 v37, v38, v39
    v_cvt_pk_bf16_f32 v38, v40, v41
    v_mfma_f32_32x32x8_bf16 v[52:67], v[88:89], v[30:31], v[52:67]
    s_setprio 2
    v_cvt_pk_bf16_f32 v39, v42, v43
    v_exp_f32 v44, v44
    v_exp_f32 v45, v45
    v_exp_f32 v46, v46
    v_exp_f32 v47, v47
    v_cvt_pk_bf16_f32 v44, v44, v45
    s_waitcnt lgkmcnt(2)
    v_mfma_f32_32x32x16_bf16 v[68:83], v[92:95], v[36:39], v[68:83]
    ds_read_b128 v[92:95], v10 offset:58048
    v_exp_f32 v48, v48
    v_exp_f32 v49, v49
    v_exp_f32 v50, v50
    v_exp_f32 v51, v51
    v_cvt_pk_bf16_f32 v45, v46, v47
    v_cvt_pk_bf16_f32 v46, v48, v49
    v_cvt_pk_bf16_f32 v47, v50, v51
    s_setprio 1
    v_exp_f32 v52, v52
    v_exp_f32 v53, v53
    s_waitcnt lgkmcnt(2)
    v_mfma_f32_32x32x16_bf16 v[68:83], v[96:99], v[44:47], v[68:83]
    ds_read_b128 v[96:99], v10 offset:58656
    v_exp_f32 v54, v54
    v_exp_f32 v55, v55
    v_exp_f32 v56, v56
    v_cvt_pk_bf16_f32 v52, v52, v53
    s_waitcnt lgkmcnt(2)
    v_mfma_f32_32x32x16_bf16 v[36:51], v[84:87], v[24:27], 0
    ds_read_b128 v[84:87], v8 offset:59904
    v_exp_f32 v57, v57
    v_exp_f32 v58, v58
    v_exp_f32 v59, v59
    v_cvt_pk_bf16_f32 v53, v54, v55
    v_cvt_pk_bf16_f32 v54, v56, v57
    v_mfma_f32_32x32x8_bf16 v[36:51], v[88:89], v[32:33], v[36:51]
    s_setprio 0
    v_cvt_pk_bf16_f32 v55, v58, v59
    v_exp_f32 v60, v60
    v_exp_f32 v61, v61
    v_exp_f32 v62, v62
    v_exp_f32 v63, v63
    v_cvt_pk_bf16_f32 v60, v60, v61
    s_waitcnt lgkmcnt(2)
    v_mfma_f32_32x32x16_bf16 v[68:83], v[92:95], v[52:55], v[68:83]
    ds_read_b128 v[92:95], v10 offset:59264
    v_exp_f32 v64, v64
    v_exp_f32 v65, v65
    v_exp_f32 v66, v66
    v_exp_f32 v67, v67
    v_cvt_pk_bf16_f32 v61, v62, v63
    v_cvt_pk_bf16_f32 v62, v64, v65
    v_cvt_pk_bf16_f32 v63, v66, v67
    v_add_u32 v8, 56832, v8
    v_add_u32 v9, 56832, v9
    s_setprio 3
    v_exp_f32 v36, v36
    v_exp_f32 v37, v37
    s_waitcnt lgkmcnt(2)
    v_mfma_f32_32x32x16_bf16 v[68:83], v[96:99], v[60:63], v[68:83]
    ds_read_b128 v[96:99], v10 offset:59872
    v_exp_f32 v38, v38
    v_exp_f32 v39, v39
    v_exp_f32 v40, v40
    v_cvt_pk_bf16_f32 v36, v36, v37
    s_waitcnt lgkmcnt(2)
    v_mfma_f32_32x32x16_bf16 v[52:67], v[84:87], v[24:27], 0
    ds_read_b128 v[84:87], v8 offset:9472
    v_exp_f32 v41, v41
    v_exp_f32 v42, v42
    v_exp_f32 v43, v43
    v_cvt_pk_bf16_f32 v37, v38, v39
    v_cvt_pk_bf16_f32 v38, v40, v41
    v_mfma_f32_32x32x8_bf16 v[52:67], v[88:89], v[34:35], v[52:67]
    ds_read_b64 v[88:89], v9 offset:13568
    s_setprio 2
    v_cvt_pk_bf16_f32 v39, v42, v43
    v_exp_f32 v44, v44
    v_exp_f32 v45, v45
    v_exp_f32 v46, v46
    v_exp_f32 v47, v47
    v_cvt_pk_bf16_f32 v44, v44, v45
    s_waitcnt lgkmcnt(2)
    v_mfma_f32_32x32x16_bf16 v[68:83], v[92:95], v[36:39], v[68:83]
    ds_read_b128 v[92:95], v10 offset:60480
    v_exp_f32 v48, v48
    v_exp_f32 v49, v49
    v_exp_f32 v50, v50
    v_exp_f32 v51, v51
    v_cvt_pk_bf16_f32 v45, v46, v47
    v_cvt_pk_bf16_f32 v46, v48, v49
    v_cvt_pk_bf16_f32 v47, v50, v51
    s_sub_u32 s22, s3, 4
    s_cmp_le_u32 s22, 2
    s_cbranch_scc0 Lc_51
    s_call_b64 s[30:31], L_A_touch
Lc_51:
    v_add_u32 v10, 56832, v10
    s_setprio 1
    v_exp_f32 v52, v52
    v_exp_f32 v53, v53
    s_waitcnt lgkmcnt(2)
    v_mfma_f32_32x32x16_bf16 v[68:83], v[96:99], v[44:47], v[68:83]
    ds_read_b128 v[96:99], v10 offset:4256
    v_exp_f32 v54, v54
    v_exp_f32 v55, v55
    v_exp_f32 v56, v56
    v_cvt_pk_bf16_f32 v52, v52, v53
    s_waitcnt lgkmcnt(2)
    v_mfma_f32_32x32x16_bf16 v[36:51], v[84:87], v[24:27], 0
    ds_read_b128 v[84:87], v8 offset:10496
    v_exp_f32 v57, v57
    v_exp_f32 v58, v58
    v_exp_f32 v59, v59
    v_cvt_pk_bf16_f32 v53, v54, v55
    v_cvt_pk_bf16_f32 v54, v56, v57
    v_mfma_f32_32x32x8_bf16 v[36:51], v[88:89], v[28:29], v[36:51]
    s_setprio 0
    v_cvt_pk_bf16_f32 v55, v58, v59
    v_exp_f32 v60, v60
    v_exp_f32 v61, v61
    v_exp_f32 v62, v62
    v_exp_f32 v63, v63
    v_cvt_pk_bf16_f32 v60, v60, v61
    s_waitcnt lgkmcnt(2)
    v_mfma_f32_32x32x16_bf16 v[68:83], v[92:95], v[52:55], v[68:83]
    ds_read_b128 v[92:95], v10 offset:9472
    v_exp_f32 v64, v64
    v_exp_f32 v65, v65
    v_exp_f32 v66, v66
    v_exp_f32 v67, v67
    v_cvt_pk_bf16_f32 v61, v62, v63
    v_cvt_pk_bf16_f32 v62, v64, v65
    v_cvt_pk_bf16_f32 v63, v66, v67
    s_cmp_eq_u32 s3, 7
    s_cbranch_scc0 Lc_52
    s_call_b64 s[30:31], L_A_check0
Lc_52:
    s_setprio 3
    v_exp_f32 v36, v36
    v_exp_f32 v37, v37
    s_waitcnt lgkmcnt(2)
    v_mfma_f32_32x32x16_bf16 v[68:83], v[96:99], v[60:63], v[68:83]
    ds_read_b128 v[96:99], v10 offset:10080
    v_exp_f32 v38, v38
    v_exp_f32 v39, v39
    v_exp_f32 v40, v40
    v_cvt_pk_bf16_f32 v36, v36, v37
    s_waitcnt lgkmcnt(2)
    v_mfma_f32_32x32x16_bf16 v[52:67], v[84:87], v[24:27], 0
    ds_read_b128 v[84:87], v8 offset:11520
    v_exp_f32 v41, v41
    v_exp_f32 v42, v42
    v_exp_f32 v43, v43
    v_cvt_pk_bf16_f32 v37, v38, v39
    v_cvt_pk_bf16_f32 v38, v40, v41
    v_mfma_f32_32x32x8_bf16 v[52:67], v[88:89], v[30:31], v[52:67]
    s_setprio 2
    v_cvt_pk_bf16_f32 v39, v42, v43
    v_exp_f32 v44, v44
    v_exp_f32 v45, v45
    v_exp_f32 v46, v46
    v_exp_f32 v47, v47
    v_cvt_pk_bf16_f32 v44, v44, v45
    s_waitcnt lgkmcnt(2)
    v_mfma_f32_32x32x16_bf16 v[68:83], v[92:95], v[36:39], v[68:83]
    ds_read_b128 v[92:95], v10 offset:10688
    v_exp_f32 v48, v48
    v_exp_f32 v49, v49
    v_exp_f32 v50, v50
    v_exp_f32 v51, v51
    v_cvt_pk_bf16_f32 v45, v46, v47
    v_cvt_pk_bf16_f32 v46, v48, v49
    v_cvt_pk_bf16_f32 v47, v50, v51
    s_setprio 1
    v_exp_f32 v52, v52
    v_exp_f32 v53, v53
    s_waitcnt lgkmcnt(2)
    v_mfma_f32_32x32x16_bf16 v[68:83], v[96:99], v[44:47], v[68:83]
    ds_read_b128 v[96:99], v10 offset:11296
    v_exp_f32 v54, v54
    v_exp_f32 v55, v55
    v_exp_f32 v56, v56
    v_cvt_pk_bf16_f32 v52, v52, v53
    s_waitcnt lgkmcnt(2)
    v_mfma_f32_32x32x16_bf16 v[36:51], v[84:87], v[24:27], 0
    ds_read_b128 v[84:87], v8 offset:12544
    v_exp_f32 v57, v57
    v_exp_f32 v58, v58
    v_exp_f32 v59, v59
    v_cvt_pk_bf16_f32 v53, v54, v55
    v_cvt_pk_bf16_f32 v54, v56, v57
    v_mfma_f32_32x32x8_bf16 v[36:51], v[88:89], v[32:33], v[36:51]
    s_setprio 0
    v_cvt_pk_bf16_f32 v55, v58, v59
    v_exp_f32 v60, v60
    v_exp_f32 v61, v61
    v_exp_f32 v62, v62
    v_exp_f32 v63, v63
    v_cvt_pk_bf16_f32 v60, v60, v61
    s_waitcnt lgkmcnt(2)
    v_mfma_f32_32x32x16_bf16 v[68:83], v[92:95], v[52:55], v[68:83]
    ds_read_b128 v[92:95], v10 offset:11904
    v_exp_f32 v64, v64
    v_exp_f32 v65, v65
    v_exp_f32 v66, v66
    v_exp_f32 v67, v67
    v_cvt_pk_bf16_f32 v61, v62, v63
    v_cvt_pk_bf16_f32 v62, v64, v65
    v_cvt_pk_bf16_f32 v63, v66, v67
    s_setprio 3
    v_exp_f32 v36, v36
    v_exp_f32 v37, v37
    s_waitcnt lgkmcnt(2)
    v_mfma_f32_32x32x16_bf16 v[68:83], v[96:99], v[60:63], v[68:83]
    ds_read_b128 v[96:99], v10 offset:12512
    v_exp_f32 v38, v38
    v_exp_f32 v39, v39
    v_exp_f32 v40, v40
    v_cvt_pk_bf16_f32 v36, v36, v37
    s_waitcnt lgkmcnt(2)
    v_mfma_f32_32x32x16_bf16 v[52:67], v[84:87], v[24:27], 0
    ds_read_b128 v[84:87], v8 offset:18944
    v_exp_f32 v41, v41
    v_exp_f32 v42, v42
    v_exp_f32 v43, v43
    v_cvt_pk_bf16_f32 v37, v38, v39
    v_cvt_pk_bf16_f32 v38, v40, v41
    v_mfma_f32_32x32x8_bf16 v[52:67], v[88:89], v[34:35], v[52:67]
    ds_read_b64 v[88:89], v9 offset:23040
    s_setprio 2
    v_cvt_pk_bf16_f32 v39, v42, v43
    v_exp_f32 v44, v44
    v_exp_f32 v45, v45
    v_exp_f32 v46, v46
    v_exp_f32 v47, v47
    v_cvt_pk_bf16_f32 v44, v44, v45
    s_waitcnt lgkmcnt(2)
    v_mfma_f32_32x32x16_bf16 v[68:83], v[92:95], v[36:39], v[68:83]
    ds_read_b128 v[92:95], v10 offset:13120
    v_exp_f32 v48, v48
    v_exp_f32 v49, v49
    v_exp_f32 v50, v50
    v_exp_f32 v51, v51
    v_cvt_pk_bf16_f32 v45, v46, v47
    v_cvt_pk_bf16_f32 v46, v48, v49
    v_cvt_pk_bf16_f32 v47, v50, v51
    s_setprio 1
    v_exp_f32 v52, v52
    v_exp_f32 v53, v53
    s_waitcnt lgkmcnt(2)
    v_mfma_f32_32x32x16_bf16 v[68:83], v[96:99], v[44:47], v[68:83]
    ds_read_b128 v[96:99], v10 offset:13728
    v_exp_f32 v54, v54
    v_exp_f32 v55, v55
    v_exp_f32 v56, v56
    v_cvt_pk_bf16_f32 v52, v52, v53
    s_waitcnt lgkmcnt(2)
    v_mfma_f32_32x32x16_bf16 v[36:51], v[84:87], v[24:27], 0
    ds_read_b128 v[84:87], v8 offset:19968
    v_exp_f32 v57, v57
    v_exp_f32 v58, v58
    v_exp_f32 v59, v59
    v_cvt_pk_bf16_f32 v53, v54, v55
    v_cvt_pk_bf16_f32 v54, v56, v57
    v_mfma_f32_32x32x8_bf16 v[36:51], v[88:89], v[28:29], v[36:51]
    s_setprio 0
    v_cvt_pk_bf16_f32 v55, v58, v59
    v_exp_f32 v60, v60
    v_exp_f32 v61, v61
    v_exp_f32 v62, v62
    v_exp_f32 v63, v63
    v_cvt_pk_bf16_f32 v60, v60, v61
    s_waitcnt lgkmcnt(2)
    v_mfma_f32_32x32x16_bf16 v[68:83], v[92:95], v[52:55], v[68:83]
    ds_read_b128 v[92:95], v10 offset:18944
    v_exp_f32 v64, v64
    v_exp_f32 v65, v65
    v_exp_f32 v66, v66
    v_exp_f32 v67, v67
    v_cvt_pk_bf16_f32 v61, v62, v63
    v_cvt_pk_bf16_f32 v62, v64, v65
    v_cvt_pk_bf16_f32 v63, v66, v67
    s_setprio 3
    v_exp_f32 v36, v36
    v_exp_f32 v37, v37
    s_waitcnt lgkmcnt(2)
    v_mfma_f32_32x32x16_bf16 v[68:83], v[96:99], v[60:63], v[68:83]
    ds_read_b128 v[96:99], v10 offset:19552
    v_exp_f32 v38, v38
    v_exp_f32 v39, v39
    v_exp_f32 v40, v40
    v_cvt_pk_bf16_f32 v36, v36, v37
    s_waitcnt lgkmcnt(2)
    v_mfma_f32_32x32x16_bf16 v[52:67], v[84:87], v[24:27], 0
    ds_read_b128 v[84:87], v8 offset:20992
    v_exp_f32 v41, v41
    v_exp_f32 v42, v42
    v_exp_f32 v43, v43
    v_cvt_pk_bf16_f32 v37, v38, v39
    v_cvt_pk_bf16_f32 v38, v40, v41
    v_mfma_f32_32x32x8_bf16 v[52:67], v[88:89], v[30:31], v[52:67]
    s_setprio 2
    v_cvt_pk_bf16_f32 v39, v42, v43
    v_exp_f32 v44, v44
    v_exp_f32 v45, v45
    v_exp_f32 v46, v46
    v_exp_f32 v47, v47
    v_cvt_pk_bf16_f32 v44, v44, v45
    s_waitcnt lgkmcnt(2)
    v_mfma_f32_32x32x16_bf16 v[68:83], v[92:95], v[36:39], v[68:83]
    ds_read_b128 v[92:95], v10 offset:20160
    v_exp_f32 v48, v48
    v_exp_f32 v49, v49
    v_exp_f32 v50, v50
    v_exp_f32 v51, v51
    v_cvt_pk_bf16_f32 v45, v46, v47
    v_cvt_pk_bf16_f32 v46, v48, v49
    v_cvt_pk_bf16_f32 v47, v50, v51
    s_cmp_eq_u32 s3, 7
    s_cbranch_scc0 Lc_53
    s_call_b64 s[30:31], L_A_check
Lc_53:
    s_setprio 1
    v_exp_f32 v52, v52
    v_exp_f32 v53, v53
    s_waitcnt lgkmcnt(2)
    v_mfma_f32_32x32x16_bf16 v[68:83], v[96:99], v[44:47], v[68:83]
    ds_read_b128 v[96:99], v10 offset:20768
    v_exp_f32 v54, v54
    v_exp_f32 v55, v55
    v_exp_f32 v56, v56
    v_cvt_pk_bf16_f32 v52, v52, v53
    s_waitcnt lgkmcnt(2)
    v_mfma_f32_32x32x16_bf16 v[36:51], v[84:87], v[24:27], 0
    ds_read_b128 v[84:87], v8 offset:22016
    v_exp_f32 v57, v57
    v_exp_f32 v58, v58
    v_exp_f32 v59, v59
    v_cvt_pk_bf16_f32 v53, v54, v55
    v_cvt_pk_bf16_f32 v54, v56, v57
    v_mfma_f32_32x32x8_bf16 v[36:51], v[88:89], v[32:33], v[36:51]
    s_setprio 0
    v_cvt_pk_bf16_f32 v55, v58, v59
    v_exp_f32 v60, v60
    v_exp_f32 v61, v61
    v_exp_f32 v62, v62
    v_exp_f32 v63, v63
    v_cvt_pk_bf16_f32 v60, v60, v61
    s_waitcnt lgkmcnt(2)
    v_mfma_f32_32x32x16_bf16 v[68:83], v[92:95], v[52:55], v[68:83]
    ds_read_b128 v[92:95], v10 offset:21376
    v_exp_f32 v64, v64
    v_exp_f32 v65, v65
    v_exp_f32 v66, v66
    v_exp_f32 v67, v67
    v_cvt_pk_bf16_f32 v61, v62, v63
    v_cvt_pk_bf16_f32 v62, v64, v65
    v_cvt_pk_bf16_f32 v63, v66, v67
    s_setprio 3
    v_exp_f32 v36, v36
    v_exp_f32 v37, v37
    s_waitcnt lgkmcnt(2)
    v_mfma_f32_32x32x16_bf16 v[68:83], v[96:99], v[60:63], v[68:83]
    ds_read_b128 v[96:99], v10 offset:21984
    v_exp_f32 v38, v38
    v_exp_f32 v39, v39
    v_exp_f32 v40, v40
    v_cvt_pk_bf16_f32 v36, v36, v37
    s_waitcnt lgkmcnt(2)
    v_mfma_f32_32x32x16_bf16 v[52:67], v[84:87], v[24:27], 0
    ds_read_b128 v[84:87], v8 offset:28416
    v_exp_f32 v41, v41
    v_exp_f32 v42, v42
    v_exp_f32 v43, v43
    v_cvt_pk_bf16_f32 v37, v38, v39
    v_cvt_pk_bf16_f32 v38, v40, v41
    v_mfma_f32_32x32x8_bf16 v[52:67], v[88:89], v[34:35], v[52:67]
    ds_read_b64 v[88:89], v9 offset:32512
    s_setprio 2
    v_cvt_pk_bf16_f32 v39, v42, v43
    v_exp_f32 v44, v44
    v_exp_f32 v45, v45
    v_exp_f32 v46, v46
    v_exp_f32 v47, v47
    v_cvt_pk_bf16_f32 v44, v44, v45
    s_waitcnt lgkmcnt(2)
    v_mfma_f32_32x32x16_bf16 v[68:83], v[92:95], v[36:39], v[68:83]
    ds_read_b128 v[92:95], v10 offset:22592
    v_exp_f32 v48, v48
    v_exp_f32 v49, v49
    v_exp_f32 v50, v50
    v_exp_f32 v51, v51
    v_cvt_pk_bf16_f32 v45, v46, v47
    v_cvt_pk_bf16_f32 v46, v48, v49
    v_cvt_pk_bf16_f32 v47, v50, v51
    s_cmp_eq_u32 s3, 7
    s_cbranch_scc0 Lc_54
    s_call_b64 s[30:31], L_A_touch
Lc_54:
    s_setprio 1
    v_exp_f32 v52, v52
    v_exp_f32 v53, v53
    s_waitcnt lgkmcnt(2)
    v_mfma_f32_32x32x16_bf16 v[68:83], v[96:99], v[44:47], v[68:83]
    ds_read_b128 v[96:99], v10 offset:23200
    v_exp_f32 v54, v54
    v_exp_f32 v55, v55
    v_exp_f32 v56, v56
    v_cvt_pk_bf16_f32 v52, v52, v53
    s_waitcnt lgkmcnt(2)
    v_mfma_f32_32x32x16_bf16 v[36:51], v[84:87], v[24:27], 0
    ds_read_b128 v[84:87], v8 offset:29440
    v_exp_f32 v57, v57
    v_exp_f32 v58, v58
    v_exp_f32 v59, v59
    v_cvt_pk_bf16_f32 v53, v54, v55
    v_cvt_pk_bf16_f32 v54, v56, v57
    v_mfma_f32_32x32x8_bf16 v[36:51], v[88:89], v[28:29], v[36:51]
    s_setprio 0
    v_cvt_pk_bf16_f32 v55, v58, v59
    v_exp_f32 v60, v60
    v_exp_f32 v61, v61
    v_exp_f32 v62, v62
    v_exp_f32 v63, v63
    v_cvt_pk_bf16_f32 v60, v60, v61
    s_waitcnt lgkmcnt(2)
    v_mfma_f32_32x32x16_bf16 v[68:83], v[92:95], v[52:55], v[68:83]
    ds_read_b128 v[92:95], v10 offset:28416
    v_exp_f32 v64, v64
    v_exp_f32 v65, v65
    v_exp_f32 v66, v66
    v_exp_f32 v67, v67
    v_cvt_pk_bf16_f32 v61, v62, v63
    v_cvt_pk_bf16_f32 v62, v64, v65
    v_cvt_pk_bf16_f32 v63, v66, v67
    s_setprio 3
    v_exp_f32 v36, v36
    v_exp_f32 v37, v37
    s_waitcnt lgkmcnt(2)
    v_mfma_f32_32x32x16_bf16 v[68:83], v[96:99], v[60:63], v[68:83]
    ds_read_b128 v[96:99], v10 offset:29024
    v_exp_f32 v38, v38
    v_exp_f32 v39, v39
    v_exp_f32 v40, v40
    v_cvt_pk_bf16_f32 v36, v36, v37
    s_waitcnt lgkmcnt(2)
    v_mfma_f32_32x32x16_bf16 v[52:67], v[84:87], v[24:27], 0
    ds_read_b128 v[84:87], v8 offset:30464
    v_exp_f32 v41, v41
    v_exp_f32 v42, v42
    v_exp_f32 v43, v43
    v_cvt_pk_bf16_f32 v37, v38, v39
    v_cvt_pk_bf16_f32 v38, v40, v41
    v_mfma_f32_32x32x8_bf16 v[52:67], v[88:89], v[30:31], v[52:67]
    s_setprio 2
    v_cvt_pk_bf16_f32 v39, v42, v43
    v_exp_f32 v44, v44
    v_exp_f32 v45, v45
    v_exp_f32 v46, v46
    v_exp_f32 v47, v47
    v_cvt_pk_bf16_f32 v44, v44, v45
    s_waitcnt lgkmcnt(2)
    v_mfma_f32_32x32x16_bf16 v[68:83], v[92:95], v[36:39], v[68:83]
    ds_read_b128 v[92:95], v10 offset:29632
    v_exp_f32 v48, v48
    v_exp_f32 v49, v49
    v_exp_f32 v50, v50
    v_exp_f32 v51, v51
    v_cvt_pk_bf16_f32 v45, v46, v47
    v_cvt_pk_bf16_f32 v46, v48, v49
    v_cvt_pk_bf16_f32 v47, v50, v51
    s_setprio 1
    v_exp_f32 v52, v52
    v_exp_f32 v53, v53
    s_waitcnt lgkmcnt(2)
    v_mfma_f32_32x32x16_bf16 v[68:83], v[96:99], v[44:47], v[68:83]
    ds_read_b128 v[96:99], v10 offset:30240
    v_exp_f32 v54, v54
    v_exp_f32 v55, v55
    v_exp_f32 v56, v56
    v_cvt_pk_bf16_f32 v52, v52, v53
    s_waitcnt lgkmcnt(2)
    v_mfma_f32_32x32x16_bf16 v[36:51], v[84:87], v[24:27], 0
    ds_read_b128 v[84:87], v8 offset:31488
    v_exp_f32 v57, v57
    v_exp_f32 v58, v58
    v_exp_f32 v59, v59
    v_cvt_pk_bf16_f32 v53, v54, v55
    v_cvt_pk_bf16_f32 v54, v56, v57
    v_mfma_f32_32x32x8_bf16 v[36:51], v[88:89], v[32:33], v[36:51]
    s_setprio 0
    v_cvt_pk_bf16_f32 v55, v58, v59
    v_exp_f32 v60, v60
    v_exp_f32 v61, v61
    v_exp_f32 v62, v62
    v_exp_f32 v63, v63
    v_cvt_pk_bf16_f32 v60, v60, v61
    s_waitcnt lgkmcnt(2)
    v_mfma_f32_32x32x16_bf16 v[68:83], v[92:95], v[52:55], v[68:83]
    ds_read_b128 v[92:95], v10 offset:30848
    v_exp_f32 v64, v64
    v_exp_f32 v65, v65
    v_exp_f32 v66, v66
    v_exp_f32 v67, v67
    v_cvt_pk_bf16_f32 v61, v62, v63
    v_cvt_pk_bf16_f32 v62, v64, v65
    v_cvt_pk_bf16_f32 v63, v66, v67
    s_cmp_eq_u32 s15, 0
    s_cbranch_scc0 Lc_55
    s_mov_b32 s50, 162820
    s_mov_b32 s51, 1
    s_call_b64 s[30:31], L_B_wait
    v_readfirstlane_b32 s99, v6
Lc_55:
    s_setprio 3
    v_exp_f32 v36, v36
    v_exp_f32 v37, v37
    s_waitcnt lgkmcnt(2)
    v_mfma_f32_32x32x16_bf16 v[68:83], v[96:99], v[60:63], v[68:83]
    ds_read_b128 v[96:99], v10 offset:31456
    v_exp_f32 v38, v38
    v_exp_f32 v39, v39
    v_exp_f32 v40, v40
    v_cvt_pk_bf16_f32 v36, v36, v37
    s_waitcnt lgkmcnt(2)
    v_mfma_f32_32x32x16_bf16 v[52:67], v[84:87], v[24:27], 0
    ds_read_b128 v[84:87], v8 offset:37888
    v_exp_f32 v41, v41
    v_exp_f32 v42, v42
    v_exp_f32 v43, v43
    v_cvt_pk_bf16_f32 v37, v38, v39
    v_cvt_pk_bf16_f32 v38, v40, v41
    v_mfma_f32_32x32x8_bf16 v[52:67], v[88:89], v[34:35], v[52:67]
    ds_read_b64 v[88:89], v9 offset:41984
    s_add_u32 s61, s41, 0
    buffer_load_dwordx4 v[112:115], v1, s[4:7], s61 offen offset:0
    buffer_load_dwordx4 v[116:119], v1, s[4:7], s61 offen offset:1024
    s_setprio 2
    v_cvt_pk_bf16_f32 v39, v42, v43
    v_exp_f32 v44, v44
    v_exp_f32 v45, v45
    v_exp_f32 v46, v46
    v_exp_f32 v47, v47
    v_cvt_pk_bf16_f32 v44, v44, v45
    s_waitcnt lgkmcnt(2)
    v_mfma_f32_32x32x16_bf16 v[68:83], v[92:95], v[36:39], v[68:83]
    ds_read_b128 v[92:95], v10 offset:32064
    v_exp_f32 v48, v48
    v_exp_f32 v49, v49
    v_exp_f32 v50, v50
    v_exp_f32 v51, v51
    v_cvt_pk_bf16_f32 v45, v46, v47
    v_cvt_pk_bf16_f32 v46, v48, v49
    v_cvt_pk_bf16_f32 v47, v50, v51
    s_setprio 1
    v_exp_f32 v52, v52
    v_exp_f32 v53, v53
    s_waitcnt lgkmcnt(2)
    v_mfma_f32_32x32x16_bf16 v[68:83], v[96:99], v[44:47], v[68:83]
    ds_read_b128 v[96:99], v10 offset:32672
    v_exp_f32 v54, v54
    v_exp_f32 v55, v55
    v_exp_f32 v56, v56
    v_cvt_pk_bf16_f32 v52, v52, v53
    s_waitcnt lgkmcnt(2)
    v_mfma_f32_32x32x16_bf16 v[36:51], v[84:87], v[24:27], 0
    ds_read_b128 v[84:87], v8 offset:38912
    v_exp_f32 v57, v57
    v_exp_f32 v58, v58
    v_exp_f32 v59, v59
    v_cvt_pk_bf16_f32 v53, v54, v55
    v_cvt_pk_bf16_f32 v54, v56, v57
    v_mfma_f32_32x32x8_bf16 v[36:51], v[88:89], v[28:29], v[36:51]
    buffer_load_dwordx4 v[120:123], v1, s[4:7], s61 offen offset:2048
    buffer_load_dwordx4 v[124:127], v1, s[4:7], s61 offen offset:3072
    s_setprio 0
    v_cvt_pk_bf16_f32 v55, v58, v59
    v_exp_f32 v60, v60
    v_exp_f32 v61, v61
    v_exp_f32 v62, v62
    v_exp_f32 v63, v63
    v_cvt_pk_bf16_f32 v60, v60, v61
    s_waitcnt lgkmcnt(2)
    v_mfma_f32_32x32x16_bf16 v[68:83], v[92:95], v[52:55], v[68:83]
    ds_read_b128 v[92:95], v10 offset:37888
    v_exp_f32 v64, v64
    v_exp_f32 v65, v65
    v_exp_f32 v66, v66
    v_exp_f32 v67, v67
    v_cvt_pk_bf16_f32 v61, v62, v63
    v_cvt_pk_bf16_f32 v62, v64, v65
    v_cvt_pk_bf16_f32 v63, v66, v67
    s_setprio 3
    v_exp_f32 v36, v36
    v_exp_f32 v37, v37
    s_waitcnt lgkmcnt(2)
    v_mfma_f32_32x32x16_bf16 v[68:83], v[96:99], v[60:63], v[68:83]
    ds_read_b128 v[96:99], v10 offset:38496
    v_exp_f32 v38, v38
    v_exp_f32 v39, v39
    v_exp_f32 v40, v40
    v_cvt_pk_bf16_f32 v36, v36, v37
    s_waitcnt lgkmcnt(2)
    v_mfma_f32_32x32x16_bf16 v[52:67], v[84:87], v[24:27], 0
    ds_read_b128 v[84:87], v8 offset:39936
    v_exp_f32 v41, v41
    v_exp_f32 v42, v42
    v_exp_f32 v43, v43
    v_cvt_pk_bf16_f32 v37, v38, v39
    v_cvt_pk_bf16_f32 v38, v40, v41
    v_mfma_f32_32x32x8_bf16 v[52:67], v[88:89], v[30:31], v[52:67]
    s_add_u32 s61, s41, 4096
    buffer_load_dwordx4 v[128:131], v1, s[4:7], s61 offen offset:0
    buffer_load_dwordx4 v[132:135], v1, s[4:7], s61 offen offset:1024
    s_setprio 2
    v_cvt_pk_bf16_f32 v39, v42, v43
    v_exp_f32 v44, v44
    v_exp_f32 v45, v45
    v_exp_f32 v46, v46
    v_exp_f32 v47, v47
    v_cvt_pk_bf16_f32 v44, v44, v45
    s_waitcnt lgkmcnt(2)
    v_mfma_f32_32x32x16_bf16 v[68:83], v[92:95], v[36:39], v[68:83]
    ds_read_b128 v[92:95], v10 offset:39104
    v_exp_f32 v48, v48
    v_exp_f32 v49, v49
    v_exp_f32 v50, v50
    v_exp_f32 v51, v51
    v_cvt_pk_bf16_f32 v45, v46, v47
    v_cvt_pk_bf16_f32 v46, v48, v49
    v_cvt_pk_bf16_f32 v47, v50, v51
    s_setprio 1
    v_exp_f32 v52, v52
    v_exp_f32 v53, v53
    s_waitcnt lgkmcnt(2)
    v_mfma_f32_32x32x16_bf16 v[68:83], v[96:99], v[44:47], v[68:83]
    ds_read_b128 v[96:99], v10 offset:39712
    v_exp_f32 v54, v54
    v_exp_f32 v55, v55
    v_exp_f32 v56, v56
    v_cvt_pk_bf16_f32 v52, v52, v53
    s_waitcnt lgkmcnt(2)
    v_mfma_f32_32x32x16_bf16 v[36:51], v[84:87], v[24:27], 0
    ds_read_b128 v[84:87], v8 offset:40960
    v_exp_f32 v57, v57
    v_exp_f32 v58, v58
    v_exp_f32 v59, v59
    v_cvt_pk_bf16_f32 v53, v54, v55
    v_cvt_pk_bf16_f32 v54, v56, v57
    v_mfma_f32_32x32x8_bf16 v[36:51], v[88:89], v[32:33], v[36:51]
    buffer_load_dwordx4 v[136:139], v1, s[4:7], s61 offen offset:2048
    buffer_load_dwordx4 v[140:143], v1, s[4:7], s61 offen offset:3072
    s_setprio 0
    v_cvt_pk_bf16_f32 v55, v58, v59
    v_exp_f32 v60, v60
    v_exp_f32 v61, v61
    v_exp_f32 v62, v62
    v_exp_f32 v63, v63
    v_cvt_pk_bf16_f32 v60, v60, v61
    s_waitcnt lgkmcnt(2)
    v_mfma_f32_32x32x16_bf16 v[68:83], v[92:95], v[52:55], v[68:83]
    ds_read_b128 v[92:95], v10 offset:40320
    v_exp_f32 v64, v64
    v_exp_f32 v65, v65
    v_exp_f32 v66, v66
    v_exp_f32 v67, v67
    v_cvt_pk_bf16_f32 v61, v62, v63
    v_cvt_pk_bf16_f32 v62, v64, v65
    v_cvt_pk_bf16_f32 v63, v66, v67
    s_setprio 3
    v_exp_f32 v36, v36
    v_exp_f32 v37, v37
    s_waitcnt lgkmcnt(2)
    v_mfma_f32_32x32x16_bf16 v[68:83], v[96:99], v[60:63], v[68:83]
    ds_read_b128 v[96:99], v10 offset:40928
    v_exp_f32 v38, v38
    v_exp_f32 v39, v39
    v_exp_f32 v40, v40
    v_cvt_pk_bf16_f32 v36, v36, v37
    s_waitcnt lgkmcnt(2)
    v_mfma_f32_32x32x16_bf16 v[52:67], v[84:87], v[24:27], 0
    ds_read_b128 v[84:87], v8 offset:47360
    v_exp_f32 v41, v41
    v_exp_f32 v42, v42
    v_exp_f32 v43, v43
    v_cvt_pk_bf16_f32 v37, v38, v39
    v_cvt_pk_bf16_f32 v38, v40, v41
    v_mfma_f32_32x32x8_bf16 v[52:67], v[88:89], v[34:35], v[52:67]
    ds_read_b64 v[88:89], v9 offset:51456
    s_add_u32 s61, s41, 8192
    buffer_load_dwordx4 v[144:147], v1, s[4:7], s61 offen offset:0
    buffer_load_dwordx4 v[148:151], v1, s[4:7], s61 offen offset:1024
    s_setprio 2
    v_cvt_pk_bf16_f32 v39, v42, v43
    v_exp_f32 v44, v44
    v_exp_f32 v45, v45
    v_exp_f32 v46, v46
    v_exp_f32 v47, v47
    v_cvt_pk_bf16_f32 v44, v44, v45
    s_waitcnt lgkmcnt(2)
    v_mfma_f32_32x32x16_bf16 v[68:83], v[92:95], v[36:39], v[68:83]
    ds_read_b128 v[92:95], v10 offset:41536
    v_exp_f32 v48, v48
    v_exp_f32 v49, v49
    v_exp_f32 v50, v50
    v_exp_f32 v51, v51
    v_cvt_pk_bf16_f32 v45, v46, v47
    v_cvt_pk_bf16_f32 v46, v48, v49
    v_cvt_pk_bf16_f32 v47, v50, v51
    s_setprio 1
    v_exp_f32 v52, v52
    v_exp_f32 v53, v53
    s_waitcnt lgkmcnt(2)
    v_mfma_f32_32x32x16_bf16 v[68:83], v[96:99], v[44:47], v[68:83]
    ds_read_b128 v[96:99], v10 offset:42144
    v_exp_f32 v54, v54
    v_exp_f32 v55, v55
    v_exp_f32 v56, v56
    v_cvt_pk_bf16_f32 v52, v52, v53
    s_waitcnt lgkmcnt(2)
    v_mfma_f32_32x32x16_bf16 v[36:51], v[84:87], v[24:27], 0
    ds_read_b128 v[84:87], v8 offset:48384
    v_exp_f32 v57, v57
    v_exp_f32 v58, v58
    v_exp_f32 v59, v59
    v_cvt_pk_bf16_f32 v53, v54, v55
    v_cvt_pk_bf16_f32 v54, v56, v57
    v_mfma_f32_32x32x8_bf16 v[36:51], v[88:89], v[28:29], v[36:51]
    buffer_load_dwordx4 v[152:155], v1, s[4:7], s61 offen offset:2048
    buffer_load_dwordx4 v[156:159], v1, s[4:7], s61 offen offset:3072
    s_setprio 0
    v_cvt_pk_bf16_f32 v55, v58, v59
    v_exp_f32 v60, v60
    v_exp_f32 v61, v61
    v_exp_f32 v62, v62
    v_exp_f32 v63, v63
    v_cvt_pk_bf16_f32 v60, v60, v61
    s_waitcnt lgkmcnt(2)
    v_mfma_f32_32x32x16_bf16 v[68:83], v[92:95], v[52:55], v[68:83]
    ds_read_b128 v[92:95], v10 offset:47360
    v_exp_f32 v64, v64
    v_exp_f32 v65, v65
    v_exp_f32 v66, v66
    v_exp_f32 v67, v67
    v_cvt_pk_bf16_f32 v61, v62, v63
    v_cvt_pk_bf16_f32 v62, v64, v65
    v_cvt_pk_bf16_f32 v63, v66, v67
    s_setprio 3
    v_exp_f32 v36, v36
    v_exp_f32 v37, v37
    s_waitcnt lgkmcnt(2)
    v_mfma_f32_32x32x16_bf16 v[68:83], v[96:99], v[60:63], v[68:83]
    ds_read_b128 v[96:99], v10 offset:47968
    v_exp_f32 v38, v38
    v_exp_f32 v39, v39
    v_exp_f32 v40, v40
    v_cvt_pk_bf16_f32 v36, v36, v37
    s_waitcnt lgkmcnt(2)
    v_mfma_f32_32x32x16_bf16 v[52:67], v[84:87], v[24:27], 0
    ds_read_b128 v[84:87], v8 offset:49408
    v_exp_f32 v41, v41
    v_exp_f32 v42, v42
    v_exp_f32 v43, v43
    v_cvt_pk_bf16_f32 v37, v38, v39
    v_cvt_pk_bf16_f32 v38, v40, v41
    v_mfma_f32_32x32x8_bf16 v[52:67], v[88:89], v[30:31], v[52:67]
    s_add_u32 s61, s41, 12288
    buffer_load_dwordx4 v[160:163], v1, s[4:7], s61 offen offset:0
    buffer_load_dwordx4 v[164:167], v1, s[4:7], s61 offen offset:1024
    s_setprio 2
    v_cvt_pk_bf16_f32 v39, v42, v43
    v_exp_f32 v44, v44
    v_exp_f32 v45, v45
    v_exp_f32 v46, v46
    v_exp_f32 v47, v47
    v_cvt_pk_bf16_f32 v44, v44, v45
    s_waitcnt lgkmcnt(2)
    v_mfma_f32_32x32x16_bf16 v[68:83], v[92:95], v[36:39], v[68:83]
    ds_read_b128 v[92:95], v10 offset:48576
    v_exp_f32 v48, v48
    v_exp_f32 v49, v49
    v_exp_f32 v50, v50
    v_exp_f32 v51, v51
    v_cvt_pk_bf16_f32 v45, v46, v47
    v_cvt_pk_bf16_f32 v46, v48, v49
    v_cvt_pk_bf16_f32 v47, v50, v51
    s_setprio 1
    v_exp_f32 v52, v52
    v_exp_f32 v53, v53
    s_waitcnt lgkmcnt(2)
    v_mfma_f32_32x32x16_bf16 v[68:83], v[96:99], v[44:47], v[68:83]
    ds_read_b128 v[96:99], v10 offset:49184
    v_exp_f32 v54, v54
    v_exp_f32 v55, v55
    v_exp_f32 v56, v56
    v_cvt_pk_bf16_f32 v52, v52, v53
    s_waitcnt lgkmcnt(2)
    v_mfma_f32_32x32x16_bf16 v[36:51], v[84:87], v[24:27], 0
    ds_read_b128 v[84:87], v8 offset:50432
    v_exp_f32 v57, v57
    v_exp_f32 v58, v58
    v_exp_f32 v59, v59
    v_cvt_pk_bf16_f32 v53, v54, v55
    v_cvt_pk_bf16_f32 v54, v56, v57
    v_mfma_f32_32x32x8_bf16 v[36:51], v[88:89], v[32:33], v[36:51]
    buffer_load_dwordx4 v[168:171], v1, s[4:7], s61 offen offset:2048
    buffer_load_dwordx4 v[172:175], v1, s[4:7], s61 offen offset:3072
    s_setprio 0
    v_cvt_pk_bf16_f32 v55, v58, v59
    v_exp_f32 v60, v60
    v_exp_f32 v61, v61
    v_exp_f32 v62, v62
    v_exp_f32 v63, v63
    v_cvt_pk_bf16_f32 v60, v60, v61
    s_waitcnt lgkmcnt(2)
    v_mfma_f32_32x32x16_bf16 v[68:83], v[92:95], v[52:55], v[68:83]
    ds_read_b128 v[92:95], v10 offset:49792
    v_exp_f32 v64, v64
    v_exp_f32 v65, v65
    v_exp_f32 v66, v66
    v_exp_f32 v67, v67
    v_cvt_pk_bf16_f32 v61, v62, v63
    v_cvt_pk_bf16_f32 v62, v64, v65
    v_cvt_pk_bf16_f32 v63, v66, v67
    s_setprio 3
    v_exp_f32 v36, v36
    v_exp_f32 v37, v37
    s_waitcnt lgkmcnt(2)
    v_mfma_f32_32x32x16_bf16 v[68:83], v[96:99], v[60:63], v[68:83]
    ds_read_b128 v[96:99], v10 offset:50400
    v_exp_f32 v38, v38
    v_exp_f32 v39, v39
    v_exp_f32 v40, v40
    v_cvt_pk_bf16_f32 v36, v36, v37
    s_waitcnt lgkmcnt(2)
    v_mfma_f32_32x32x16_bf16 v[52:67], v[84:87], v[24:27], 0
    ds_read_b128 v[84:87], v8 offset:56832
    v_exp_f32 v41, v41
    v_exp_f32 v42, v42
    v_exp_f32 v43, v43
    v_cvt_pk_bf16_f32 v37, v38, v39
    v_cvt_pk_bf16_f32 v38, v40, v41
    v_mfma_f32_32x32x8_bf16 v[52:67], v[88:89], v[34:35], v[52:67]
    ds_read_b64 v[88:89], v9 offset:60928
    s_add_u32 s61, s41, 16384
    buffer_load_dwordx4 v[176:179], v1, s[4:7], s61 offen offset:0
    buffer_load_dwordx4 v[180:183], v1, s[4:7], s61 offen offset:1024
    s_setprio 2
    v_cvt_pk_bf16_f32 v39, v42, v43
    v_exp_f32 v44, v44
    v_exp_f32 v45, v45
    v_exp_f32 v46, v46
    v_exp_f32 v47, v47
    v_cvt_pk_bf16_f32 v44, v44, v45
    s_waitcnt lgkmcnt(2)
    v_mfma_f32_32x32x16_bf16 v[68:83], v[92:95], v[36:39], v[68:83]
    ds_read_b128 v[92:95], v10 offset:51008
    v_exp_f32 v48, v48
    v_exp_f32 v49, v49
    v_exp_f32 v50, v50
    v_exp_f32 v51, v51
    v_cvt_pk_bf16_f32 v45, v46, v47
    v_cvt_pk_bf16_f32 v46, v48, v49
    v_cvt_pk_bf16_f32 v47, v50, v51
    s_setprio 1
    v_exp_f32 v52, v52
    v_exp_f32 v53, v53
    s_waitcnt lgkmcnt(2)
    v_mfma_f32_32x32x16_bf16 v[68:83], v[96:99], v[44:47], v[68:83]
    ds_read_b128 v[96:99], v10 offset:51616
    v_exp_f32 v54, v54
    v_exp_f32 v55, v55
    v_exp_f32 v56, v56
    v_cvt_pk_bf16_f32 v52, v52, v53
    s_waitcnt lgkmcnt(2)
    v_mfma_f32_32x32x16_bf16 v[36:51], v[84:87], v[24:27], 0
    ds_read_b128 v[84:87], v8 offset:57856
    v_exp_f32 v57, v57
    v_exp_f32 v58, v58
    v_exp_f32 v59, v59
    v_cvt_pk_bf16_f32 v53, v54, v55
    v_cvt_pk_bf16_f32 v54, v56, v57
    v_mfma_f32_32x32x8_bf16 v[36:51], v[88:89], v[28:29], v[36:51]
    buffer_load_dwordx4 v[184:187], v1, s[4:7], s61 offen offset:2048
    buffer_load_dwordx4 v[188:191], v1, s[4:7], s61 offen offset:3072
    s_setprio 0
    v_cvt_pk_bf16_f32 v55, v58, v59
    v_exp_f32 v60, v60
    v_exp_f32 v61, v61
    v_exp_f32 v62, v62
    v_exp_f32 v63, v63
    v_cvt_pk_bf16_f32 v60, v60, v61
    s_waitcnt lgkmcnt(2)
    v_mfma_f32_32x32x16_bf16 v[68:83], v[92:95], v[52:55], v[68:83]
    ds_read_b128 v[92:95], v10 offset:56832
    v_exp_f32 v64, v64
    v_exp_f32 v65, v65
    v_exp_f32 v66, v66
    v_exp_f32 v67, v67
    v_cvt_pk_bf16_f32 v61, v62, v63
    v_cvt_pk_bf16_f32 v62, v64, v65
    v_cvt_pk_bf16_f32 v63, v66, v67
    s_setprio 3
    v_exp_f32 v36, v36
    v_exp_f32 v37, v37
    s_waitcnt lgkmcnt(2)
    v_mfma_f32_32x32x16_bf16 v[68:83], v[96:99], v[60:63], v[68:83]
    ds_read_b128 v[96:99], v10 offset:57440
    v_exp_f32 v38, v38
    v_exp_f32 v39, v39
    v_exp_f32 v40, v40
    v_cvt_pk_bf16_f32 v36, v36, v37
    s_waitcnt lgkmcnt(2)
    v_mfma_f32_32x32x16_bf16 v[52:67], v[84:87], v[24:27], 0
    ds_read_b128 v[84:87], v8 offset:58880
    v_exp_f32 v41, v41
    v_exp_f32 v42, v42
    v_exp_f32 v43, v43
    v_cvt_pk_bf16_f32 v37, v38, v39
    v_cvt_pk_bf16_f32 v38, v40, v41
    v_mfma_f32_32x32x8_bf16 v[52:67], v[88:89], v[30:31], v[52:67]
    s_add_u32 s61, s41, 20480
    buffer_load_dwordx4 v[192:195], v1, s[4:7], s61 offen offset:0
    buffer_load_dwordx4 v[196:199], v1, s[4:7], s61 offen offset:1024
    s_setprio 2
    v_cvt_pk_bf16_f32 v39, v42, v43
    v_exp_f32 v44, v44
    v_exp_f32 v45, v45
    v_exp_f32 v46, v46
    v_exp_f32 v47, v47
    v_cvt_pk_bf16_f32 v44, v44, v45
    s_waitcnt lgkmcnt(2)
    v_mfma_f32_32x32x16_bf16 v[68:83], v[92:95], v[36:39], v[68:83]
    ds_read_b128 v[92:95], v10 offset:58048
    v_exp_f32 v48, v48
    v_exp_f32 v49, v49
    v_exp_f32 v50, v50
    v_exp_f32 v51, v51
    v_cvt_pk_bf16_f32 v45, v46, v47
    v_cvt_pk_bf16_f32 v46, v48, v49
    v_cvt_pk_bf16_f32 v47, v50, v51
    s_setprio 1
    v_exp_f32 v52, v52
    v_exp_f32 v53, v53
    s_waitcnt lgkmcnt(2)
    v_mfma_f32_32x32x16_bf16 v[68:83], v[96:99], v[44:47], v[68:83]
    ds_read_b128 v[96:99], v10 offset:58656
    v_exp_f32 v54, v54
    v_exp_f32 v55, v55
    v_exp_f32 v56, v56
    v_cvt_pk_bf16_f32 v52, v52, v53
    s_waitcnt lgkmcnt(2)
    v_mfma_f32_32x32x16_bf16 v[36:51], v[84:87], v[24:27], 0
    ds_read_b128 v[84:87], v8 offset:59904
    v_exp_f32 v57, v57
    v_exp_f32 v58, v58
    v_exp_f32 v59, v59
    v_cvt_pk_bf16_f32 v53, v54, v55
    v_cvt_pk_bf16_f32 v54, v56, v57
    v_mfma_f32_32x32x8_bf16 v[36:51], v[88:89], v[32:33], v[36:51]
    buffer_load_dwordx4 v[200:203], v1, s[4:7], s61 offen offset:2048
    buffer_load_dwordx4 v[204:207], v1, s[4:7], s61 offen offset:3072
    s_setprio 0
    v_cvt_pk_bf16_f32 v55, v58, v59
    v_exp_f32 v60, v60
    v_exp_f32 v61, v61
    v_exp_f32 v62, v62
    v_exp_f32 v63, v63
    v_cvt_pk_bf16_f32 v60, v60, v61
    s_waitcnt lgkmcnt(2)
    v_mfma_f32_32x32x16_bf16 v[68:83], v[92:95], v[52:55], v[68:83]
    ds_read_b128 v[92:95], v10 offset:59264
    v_exp_f32 v64, v64
    v_exp_f32 v65, v65
    v_exp_f32 v66, v66
    v_exp_f32 v67, v67
    v_cvt_pk_bf16_f32 v61, v62, v63
    v_cvt_pk_bf16_f32 v62, v64, v65
    v_cvt_pk_bf16_f32 v63, v66, v67
    v_add_u32 v8, 56832, v8
    v_add_u32 v9, 56832, v9
    s_setprio 3
    v_exp_f32 v36, v36
    v_exp_f32 v37, v37
    s_waitcnt lgkmcnt(2)
    v_mfma_f32_32x32x16_bf16 v[68:83], v[96:99], v[60:63], v[68:83]
    ds_read_b128 v[96:99], v10 offset:59872
    v_exp_f32 v38, v38
    v_exp_f32 v39, v39
    v_exp_f32 v40, v40
    v_cvt_pk_bf16_f32 v36, v36, v37
    s_waitcnt lgkmcnt(2)
    v_mfma_f32_32x32x16_bf16 v[52:67], v[84:87], v[24:27], 0
    ds_read_b128 v[84:87], v8 offset:9472
    v_exp_f32 v41, v41
    v_exp_f32 v42, v42
    v_exp_f32 v43, v43
    v_cvt_pk_bf16_f32 v37, v38, v39
    v_cvt_pk_bf16_f32 v38, v40, v41
    v_mfma_f32_32x32x8_bf16 v[52:67], v[88:89], v[34:35], v[52:67]
    ds_read_b64 v[88:89], v9 offset:13568
    s_add_u32 s61, s41, 24576
    buffer_load_dwordx4 v[208:211], v1, s[4:7], s61 offen offset:0
    buffer_load_dwordx4 v[212:215], v1, s[4:7], s61 offen offset:1024
    s_setprio 2
    v_cvt_pk_bf16_f32 v39, v42, v43
    v_exp_f32 v44, v44
    v_exp_f32 v45, v45
    v_exp_f32 v46, v46
    v_exp_f32 v47, v47
    v_cvt_pk_bf16_f32 v44, v44, v45
    s_waitcnt lgkmcnt(2)
    v_mfma_f32_32x32x16_bf16 v[68:83], v[92:95], v[36:39], v[68:83]
    ds_read_b128 v[92:95], v10 offset:60480
    v_exp_f32 v48, v48
    v_exp_f32 v49, v49
    v_exp_f32 v50, v50
    v_exp_f32 v51, v51
    v_cvt_pk_bf16_f32 v45, v46, v47
    v_cvt_pk_bf16_f32 v46, v48, v49
    v_cvt_pk_bf16_f32 v47, v50, v51
    v_add_u32 v10, 56832, v10
    s_setprio 1
    v_exp_f32 v52, v52
    v_exp_f32 v53, v53
    s_waitcnt lgkmcnt(2)
    v_mfma_f32_32x32x16_bf16 v[68:83], v[96:99], v[44:47], v[68:83]
    ds_read_b128 v[96:99], v10 offset:4256
    v_exp_f32 v54, v54
    v_exp_f32 v55, v55
    v_exp_f32 v56, v56
    v_cvt_pk_bf16_f32 v52, v52, v53
    s_waitcnt lgkmcnt(2)
    v_mfma_f32_32x32x16_bf16 v[36:51], v[84:87], v[24:27], 0
    ds_read_b128 v[84:87], v8 offset:10496
    v_exp_f32 v57, v57
    v_exp_f32 v58, v58
    v_exp_f32 v59, v59
    v_cvt_pk_bf16_f32 v53, v54, v55
    v_cvt_pk_bf16_f32 v54, v56, v57
    v_mfma_f32_32x32x8_bf16 v[36:51], v[88:89], v[28:29], v[36:51]
    buffer_load_dwordx4 v[216:219], v1, s[4:7], s61 offen offset:2048
    buffer_load_dwordx4 v[220:223], v1, s[4:7], s61 offen offset:3072
    s_setprio 0
    v_cvt_pk_bf16_f32 v55, v58, v59
    v_exp_f32 v60, v60
    v_exp_f32 v61, v61
    v_exp_f32 v62, v62
    v_exp_f32 v63, v63
    v_cvt_pk_bf16_f32 v60, v60, v61
    s_waitcnt lgkmcnt(2)
    v_mfma_f32_32x32x16_bf16 v[68:83], v[92:95], v[52:55], v[68:83]
    ds_read_b128 v[92:95], v10 offset:9472
    v_exp_f32 v64, v64
    v_exp_f32 v65, v65
    v_exp_f32 v66, v66
    v_exp_f32 v67, v67
    v_cvt_pk_bf16_f32 v61, v62, v63
    v_cvt_pk_bf16_f32 v62, v64, v65
    v_cvt_pk_bf16_f32 v63, v66, v67
    s_setprio 3
    v_exp_f32 v36, v36
    v_exp_f32 v37, v37
    s_waitcnt lgkmcnt(2)
    v_mfma_f32_32x32x16_bf16 v[68:83], v[96:99], v[60:63], v[68:83]
    ds_read_b128 v[96:99], v10 offset:10080
    v_exp_f32 v38, v38
    v_exp_f32 v39, v39
    v_exp_f32 v40, v40
    v_cvt_pk_bf16_f32 v36, v36, v37
    s_waitcnt lgkmcnt(2)
    v_mfma_f32_32x32x16_bf16 v[52:67], v[84:87], v[24:27], 0
    ds_read_b128 v[84:87], v8 offset:11520
    v_exp_f32 v41, v41
    v_exp_f32 v42, v42
    v_exp_f32 v43, v43
    v_cvt_pk_bf16_f32 v37, v38, v39
    v_cvt_pk_bf16_f32 v38, v40, v41
    v_mfma_f32_32x32x8_bf16 v[52:67], v[88:89], v[30:31], v[52:67]
    s_add_u32 s61, s41, 28672
    buffer_load_dwordx4 v[224:227], v1, s[4:7], s61 offen offset:0
    buffer_load_dwordx4 v[228:231], v1, s[4:7], s61 offen offset:1024
    s_setprio 2
    v_cvt_pk_bf16_f32 v39, v42, v43
    v_exp_f32 v44, v44
    v_exp_f32 v45, v45
    v_exp_f32 v46, v46
    v_exp_f32 v47, v47
    v_cvt_pk_bf16_f32 v44, v44, v45
    s_waitcnt lgkmcnt(2)
    v_mfma_f32_32x32x16_bf16 v[68:83], v[92:95], v[36:39], v[68:83]
    ds_read_b128 v[92:95], v10 offset:10688
    v_exp_f32 v48, v48
    v_exp_f32 v49, v49
    v_exp_f32 v50, v50
    v_exp_f32 v51, v51
    v_cvt_pk_bf16_f32 v45, v46, v47
    v_cvt_pk_bf16_f32 v46, v48, v49
    v_cvt_pk_bf16_f32 v47, v50, v51
    s_setprio 1
    v_exp_f32 v52, v52
    v_exp_f32 v53, v53
    s_waitcnt lgkmcnt(2)
    v_mfma_f32_32x32x16_bf16 v[68:83], v[96:99], v[44:47], v[68:83]
    ds_read_b128 v[96:99], v10 offset:11296
    v_exp_f32 v54, v54
    v_exp_f32 v55, v55
    v_exp_f32 v56, v56
    v_cvt_pk_bf16_f32 v52, v52, v53
    s_waitcnt lgkmcnt(2)
    v_mfma_f32_32x32x16_bf16 v[36:51], v[84:87], v[24:27], 0
    ds_read_b128 v[84:87], v8 offset:12544
    v_exp_f32 v57, v57
    v_exp_f32 v58, v58
    v_exp_f32 v59, v59
    v_cvt_pk_bf16_f32 v53, v54, v55
    v_cvt_pk_bf16_f32 v54, v56, v57
    v_mfma_f32_32x32x8_bf16 v[36:51], v[88:89], v[32:33], v[36:51]
    buffer_load_dwordx4 v[232:235], v1, s[4:7], s61 offen offset:2048
    buffer_load_dwordx4 v[236:239], v1, s[4:7], s61 offen offset:3072
    s_setprio 0
    v_cvt_pk_bf16_f32 v55, v58, v59
    v_exp_f32 v60, v60
    v_exp_f32 v61, v61
    v_exp_f32 v62, v62
    v_exp_f32 v63, v63
    v_cvt_pk_bf16_f32 v60, v60, v61
    s_waitcnt lgkmcnt(2)
    v_mfma_f32_32x32x16_bf16 v[68:83], v[92:95], v[52:55], v[68:83]
    ds_read_b128 v[92:95], v10 offset:11904
    v_exp_f32 v64, v64
    v_exp_f32 v65, v65
    v_exp_f32 v66, v66
    v_exp_f32 v67, v67
    v_cvt_pk_bf16_f32 v61, v62, v63
    v_cvt_pk_bf16_f32 v62, v64, v65
    v_cvt_pk_bf16_f32 v63, v66, v67
    s_setprio 3
    v_exp_f32 v36, v36
    v_exp_f32 v37, v37
    s_waitcnt lgkmcnt(2)
    v_mfma_f32_32x32x16_bf16 v[68:83], v[96:99], v[60:63], v[68:83]
    ds_read_b128 v[96:99], v10 offset:12512
    v_exp_f32 v38, v38
    v_exp_f32 v39, v39
    v_exp_f32 v40, v40
    v_cvt_pk_bf16_f32 v36, v36, v37
    s_waitcnt lgkmcnt(2)
    v_mfma_f32_32x32x16_bf16 v[52:67], v[84:87], v[24:27], 0
    ds_read_b128 v[84:87], v8 offset:18944
    v_exp_f32 v41, v41
    v_exp_f32 v42, v42
    v_exp_f32 v43, v43
    v_cvt_pk_bf16_f32 v37, v38, v39
    v_cvt_pk_bf16_f32 v38, v40, v41
    v_mfma_f32_32x32x8_bf16 v[52:67], v[88:89], v[34:35], v[52:67]
    ds_read_b64 v[88:89], v9 offset:23040
    s_add_u32 s61, s41, 32768
    buffer_load_dwordx4 v[240:243], v1, s[4:7], s61 offen offset:0
    buffer_load_dwordx4 v[244:247], v1, s[4:7], s61 offen offset:1024
    s_setprio 2
    v_cvt_pk_bf16_f32 v39, v42, v43
    v_exp_f32 v44, v44
    v_exp_f32 v45, v45
    v_exp_f32 v46, v46
    v_exp_f32 v47, v47
    v_cvt_pk_bf16_f32 v44, v44, v45
    s_waitcnt lgkmcnt(2)
    v_mfma_f32_32x32x16_bf16 v[68:83], v[92:95], v[36:39], v[68:83]
    ds_read_b128 v[92:95], v10 offset:13120
    v_exp_f32 v48, v48
    v_exp_f32 v49, v49
    v_exp_f32 v50, v50
    v_exp_f32 v51, v51
    v_cvt_pk_bf16_f32 v45, v46, v47
    v_cvt_pk_bf16_f32 v46, v48, v49
    v_cvt_pk_bf16_f32 v47, v50, v51
    s_setprio 1
    v_exp_f32 v52, v52
    v_exp_f32 v53, v53
    s_waitcnt lgkmcnt(2)
    v_mfma_f32_32x32x16_bf16 v[68:83], v[96:99], v[44:47], v[68:83]
    ds_read_b128 v[96:99], v10 offset:13728
    v_exp_f32 v54, v54
    v_exp_f32 v55, v55
    v_exp_f32 v56, v56
    v_cvt_pk_bf16_f32 v52, v52, v53
    s_waitcnt lgkmcnt(2)
    v_mfma_f32_32x32x16_bf16 v[36:51], v[84:87], v[24:27], 0
    ds_read_b128 v[84:87], v8 offset:19968
    v_exp_f32 v57, v57
    v_exp_f32 v58, v58
    v_exp_f32 v59, v59
    v_cvt_pk_bf16_f32 v53, v54, v55
    v_cvt_pk_bf16_f32 v54, v56, v57
    v_mfma_f32_32x32x8_bf16 v[36:51], v[88:89], v[28:29], v[36:51]
    buffer_load_dwordx4 v[248:251], v1, s[4:7], s61 offen offset:2048
    buffer_load_dwordx4 v[252:255], v1, s[4:7], s61 offen offset:3072
    s_setprio 0
    v_cvt_pk_bf16_f32 v55, v58, v59
    v_exp_f32 v60, v60
    v_exp_f32 v61, v61
    v_exp_f32 v62, v62
    v_exp_f32 v63, v63
    v_cvt_pk_bf16_f32 v60, v60, v61
    s_waitcnt lgkmcnt(2)
    v_mfma_f32_32x32x16_bf16 v[68:83], v[92:95], v[52:55], v[68:83]
    ds_read_b128 v[92:95], v10 offset:18944
    v_exp_f32 v64, v64
    v_exp_f32 v65, v65
    v_exp_f32 v66, v66
    v_exp_f32 v67, v67
    v_cvt_pk_bf16_f32 v61, v62, v63
    v_cvt_pk_bf16_f32 v62, v64, v65
    v_cvt_pk_bf16_f32 v63, v66, v67
    s_setprio 3
    v_exp_f32 v36, v36
    v_exp_f32 v37, v37
    s_waitcnt lgkmcnt(2)
    v_mfma_f32_32x32x16_bf16 v[68:83], v[96:99], v[60:63], v[68:83]
    ds_read_b128 v[96:99], v10 offset:19552
    v_exp_f32 v38, v38
    v_exp_f32 v39, v39
    v_exp_f32 v40, v40
    v_cvt_pk_bf16_f32 v36, v36, v37
    s_waitcnt lgkmcnt(2)
    v_mfma_f32_32x32x16_bf16 v[52:67], v[84:87], v[24:27], 0
    ds_read_b128 v[84:87], v8 offset:20992
    v_exp_f32 v41, v41
    v_exp_f32 v42, v42
    v_exp_f32 v43, v43
    v_cvt_pk_bf16_f32 v37, v38, v39
    v_cvt_pk_bf16_f32 v38, v40, v41
    v_mfma_f32_32x32x8_bf16 v[52:67], v[88:89], v[30:31], v[52:67]
    s_setprio 2
    v_cvt_pk_bf16_f32 v39, v42, v43
    v_exp_f32 v44, v44
    v_exp_f32 v45, v45
    v_exp_f32 v46, v46
    v_exp_f32 v47, v47
    v_cvt_pk_bf16_f32 v44, v44, v45
    s_waitcnt lgkmcnt(2)
    v_mfma_f32_32x32x16_bf16 v[68:83], v[92:95], v[36:39], v[68:83]
    ds_read_b128 v[92:95], v10 offset:20160
    v_exp_f32 v48, v48
    v_exp_f32 v49, v49
    v_exp_f32 v50, v50
    v_exp_f32 v51, v51
    v_cvt_pk_bf16_f32 v45, v46, v47
    v_cvt_pk_bf16_f32 v46, v48, v49
    v_cvt_pk_bf16_f32 v47, v50, v51
    s_cmp_eq_u32 s3, 7
    s_cbranch_scc0 Lc_56
    s_call_b64 s[30:31], L_A_warm
Lc_56:
    s_setprio 1
    v_exp_f32 v52, v52
    v_exp_f32 v53, v53
    s_waitcnt lgkmcnt(2)
    v_mfma_f32_32x32x16_bf16 v[68:83], v[96:99], v[44:47], v[68:83]
    ds_read_b128 v[96:99], v10 offset:20768
    v_exp_f32 v54, v54
    v_exp_f32 v55, v55
    v_exp_f32 v56, v56
    v_cvt_pk_bf16_f32 v52, v52, v53
    s_waitcnt lgkmcnt(2)
    v_mfma_f32_32x32x16_bf16 v[36:51], v[84:87], v[24:27], 0
    ds_read_b128 v[84:87], v8 offset:22016
    v_exp_f32 v57, v57
    v_exp_f32 v58, v58
    v_exp_f32 v59, v59
    v_cvt_pk_bf16_f32 v53, v54, v55
    v_cvt_pk_bf16_f32 v54, v56, v57
    v_mfma_f32_32x32x8_bf16 v[36:51], v[88:89], v[32:33], v[36:51]
    s_setprio 0
    v_cvt_pk_bf16_f32 v55, v58, v59
    v_exp_f32 v60, v60
    v_exp_f32 v61, v61
    v_exp_f32 v62, v62
    v_exp_f32 v63, v63
    v_cvt_pk_bf16_f32 v60, v60, v61
    s_waitcnt lgkmcnt(2)
    v_mfma_f32_32x32x16_bf16 v[68:83], v[92:95], v[52:55], v[68:83]
    ds_read_b128 v[92:95], v10 offset:21376
    v_exp_f32 v64, v64
    v_exp_f32 v65, v65
    v_exp_f32 v66, v66
    v_exp_f32 v67, v67
    v_cvt_pk_bf16_f32 v61, v62, v63
    v_cvt_pk_bf16_f32 v62, v64, v65
    v_cvt_pk_bf16_f32 v63, v66, v67
    s_setprio 3
    v_exp_f32 v36, v36
    v_exp_f32 v37, v37
    s_waitcnt lgkmcnt(2)
    v_mfma_f32_32x32x16_bf16 v[68:83], v[96:99], v[60:63], v[68:83]
    ds_read_b128 v[96:99], v10 offset:21984
    v_exp_f32 v38, v38
    v_exp_f32 v39, v39
    v_exp_f32 v40, v40
    v_cvt_pk_bf16_f32 v36, v36, v37
    s_waitcnt lgkmcnt(2)
    v_mfma_f32_32x32x16_bf16 v[52:67], v[84:87], v[24:27], 0
    ds_read_b128 v[84:87], v8 offset:28416
    v_exp_f32 v41, v41
    v_exp_f32 v42, v42
    v_exp_f32 v43, v43
    v_cvt_pk_bf16_f32 v37, v38, v39
    v_cvt_pk_bf16_f32 v38, v40, v41
    v_mfma_f32_32x32x8_bf16 v[52:67], v[88:89], v[34:35], v[52:67]
    ds_read_b64 v[88:89], v9 offset:32512
    s_setprio 2
    v_cvt_pk_bf16_f32 v39, v42, v43
    v_exp_f32 v44, v44
    v_exp_f32 v45, v45
    v_exp_f32 v46, v46
    v_exp_f32 v47, v47
    v_cvt_pk_bf16_f32 v44, v44, v45
    s_waitcnt lgkmcnt(2)
    v_mfma_f32_32x32x16_bf16 v[68:83], v[92:95], v[36:39], v[68:83]
    ds_read_b128 v[92:95], v10 offset:22592
    v_exp_f32 v48, v48
    v_exp_f32 v49, v49
    v_exp_f32 v50, v50
    v_exp_f32 v51, v51
    v_cvt_pk_bf16_f32 v45, v46, v47
    v_cvt_pk_bf16_f32 v46, v48, v49
    v_cvt_pk_bf16_f32 v47, v50, v51
    s_setprio 1
    v_exp_f32 v52, v52
    v_exp_f32 v53, v53
    s_waitcnt lgkmcnt(2)
    v_mfma_f32_32x32x16_bf16 v[68:83], v[96:99], v[44:47], v[68:83]
    ds_read_b128 v[96:99], v10 offset:23200
    v_exp_f32 v54, v54
    v_exp_f32 v55, v55
    v_exp_f32 v56, v56
    v_cvt_pk_bf16_f32 v52, v52, v53
    s_waitcnt lgkmcnt(2)
    v_mfma_f32_32x32x16_bf16 v[36:51], v[84:87], v[24:27], 0
    ds_read_b128 v[84:87], v8 offset:29440
    v_exp_f32 v57, v57
    v_exp_f32 v58, v58
    v_exp_f32 v59, v59
    v_cvt_pk_bf16_f32 v53, v54, v55
    v_cvt_pk_bf16_f32 v54, v56, v57
    v_mfma_f32_32x32x8_bf16 v[36:51], v[88:89], v[28:29], v[36:51]
    s_setprio 0
    v_cvt_pk_bf16_f32 v55, v58, v59
    v_exp_f32 v60, v60
    v_exp_f32 v61, v61
    v_exp_f32 v62, v62
    v_exp_f32 v63, v63
    v_cvt_pk_bf16_f32 v60, v60, v61
    s_waitcnt lgkmcnt(2)
    v_mfma_f32_32x32x16_bf16 v[68:83], v[92:95], v[52:55], v[68:83]
    ds_read_b128 v[92:95], v10 offset:28416
    v_exp_f32 v64, v64
    v_exp_f32 v65, v65
    v_exp_f32 v66, v66
    v_exp_f32 v67, v67
    v_cvt_pk_bf16_f32 v61, v62, v63
    v_cvt_pk_bf16_f32 v62, v64, v65
    v_cvt_pk_bf16_f32 v63, v66, v67
    s_setprio 3
    v_exp_f32 v36, v36
    v_exp_f32 v37, v37
    s_waitcnt lgkmcnt(2)
    v_mfma_f32_32x32x16_bf16 v[68:83], v[96:99], v[60:63], v[68:83]
    ds_read_b128 v[96:99], v10 offset:29024
    v_exp_f32 v38, v38
    v_exp_f32 v39, v39
    v_exp_f32 v40, v40
    v_cvt_pk_bf16_f32 v36, v36, v37
    s_waitcnt lgkmcnt(2)
    v_mfma_f32_32x32x16_bf16 v[52:67], v[84:87], v[24:27], 0
    ds_read_b128 v[84:87], v8 offset:30464
    v_exp_f32 v41, v41
    v_exp_f32 v42, v42
    v_exp_f32 v43, v43
    v_cvt_pk_bf16_f32 v37, v38, v39
    v_cvt_pk_bf16_f32 v38, v40, v41
    v_mfma_f32_32x32x8_bf16 v[52:67], v[88:89], v[30:31], v[52:67]
    s_setprio 2
    v_cvt_pk_bf16_f32 v39, v42, v43
    v_exp_f32 v44, v44
    v_exp_f32 v45, v45
    v_exp_f32 v46, v46
    v_exp_f32 v47, v47
    v_cvt_pk_bf16_f32 v44, v44, v45
    s_waitcnt lgkmcnt(2)
    v_mfma_f32_32x32x16_bf16 v[68:83], v[92:95], v[36:39], v[68:83]
    ds_read_b128 v[92:95], v10 offset:29632
    v_exp_f32 v48, v48
    v_exp_f32 v49, v49
    v_exp_f32 v50, v50
    v_exp_f32 v51, v51
    v_cvt_pk_bf16_f32 v45, v46, v47
    v_cvt_pk_bf16_f32 v46, v48, v49
    v_cvt_pk_bf16_f32 v47, v50, v51
    s_setprio 1
    v_exp_f32 v52, v52
    v_exp_f32 v53, v53
    s_waitcnt lgkmcnt(2)
    v_mfma_f32_32x32x16_bf16 v[68:83], v[96:99], v[44:47], v[68:83]
    ds_read_b128 v[96:99], v10 offset:30240
    v_exp_f32 v54, v54
    v_exp_f32 v55, v55
    v_exp_f32 v56, v56
    v_cvt_pk_bf16_f32 v52, v52, v53
    s_waitcnt lgkmcnt(2)
    v_mfma_f32_32x32x16_bf16 v[36:51], v[84:87], v[24:27], 0
    ds_read_b128 v[84:87], v8 offset:31488
    v_exp_f32 v57, v57
    v_exp_f32 v58, v58
    v_exp_f32 v59, v59
    v_cvt_pk_bf16_f32 v53, v54, v55
    v_cvt_pk_bf16_f32 v54, v56, v57
    v_mfma_f32_32x32x8_bf16 v[36:51], v[88:89], v[32:33], v[36:51]
    s_setprio 0
    v_cvt_pk_bf16_f32 v55, v58, v59
    v_exp_f32 v60, v60
    v_exp_f32 v61, v61
    v_exp_f32 v62, v62
    v_exp_f32 v63, v63
    v_cvt_pk_bf16_f32 v60, v60, v61
    s_waitcnt lgkmcnt(2)
    v_mfma_f32_32x32x16_bf16 v[68:83], v[92:95], v[52:55], v[68:83]
    ds_read_b128 v[92:95], v10 offset:30848
    v_exp_f32 v64, v64
    v_exp_f32 v65, v65
    v_exp_f32 v66, v66
    v_exp_f32 v67, v67
    v_cvt_pk_bf16_f32 v61, v62, v63
    v_cvt_pk_bf16_f32 v62, v64, v65
    v_cvt_pk_bf16_f32 v63, v66, v67
    s_setprio 3
    v_exp_f32 v36, v36
    v_exp_f32 v37, v37
    s_waitcnt lgkmcnt(2)
    v_mfma_f32_32x32x16_bf16 v[68:83], v[96:99], v[60:63], v[68:83]
    ds_read_b128 v[96:99], v10 offset:31456
    v_exp_f32 v38, v38
    v_exp_f32 v39, v39
    v_exp_f32 v40, v40
    v_cvt_pk_bf16_f32 v36, v36, v37
    s_waitcnt lgkmcnt(2)
    v_mfma_f32_32x32x16_bf16 v[52:67], v[84:87], v[24:27], 0
    v_exp_f32 v41, v41
    v_exp_f32 v42, v42
    v_exp_f32 v43, v43
    v_cvt_pk_bf16_f32 v37, v38, v39
    v_cvt_pk_bf16_f32 v38, v40, v41
    v_mfma_f32_32x32x8_bf16 v[52:67], v[88:89], v[34:35], v[52:67]
    s_setprio 2
    v_cvt_pk_bf16_f32 v39, v42, v43
    v_exp_f32 v44, v44
    v_exp_f32 v45, v45
    v_exp_f32 v46, v46
    v_exp_f32 v47, v47
    v_cvt_pk_bf16_f32 v44, v44, v45
    s_waitcnt lgkmcnt(1)
    v_mfma_f32_32x32x16_bf16 v[68:83], v[92:95], v[36:39], v[68:83]
    ds_read_b128 v[92:95], v10 offset:32064
    v_exp_f32 v48, v48
    v_exp_f32 v49, v49
    v_exp_f32 v50, v50
    v_exp_f32 v51, v51
    v_cvt_pk_bf16_f32 v45, v46, v47
    v_cvt_pk_bf16_f32 v46, v48, v49
    v_cvt_pk_bf16_f32 v47, v50, v51
    s_setprio 1
    v_exp_f32 v52, v52
    v_exp_f32 v53, v53
    s_waitcnt lgkmcnt(1)
    v_mfma_f32_32x32x16_bf16 v[68:83], v[96:99], v[44:47], v[68:83]
    ds_read_b128 v[96:99], v10 offset:32672
    v_exp_f32 v54, v54
    v_exp_f32 v55, v55
    v_exp_f32 v56, v56
    v_cvt_pk_bf16_f32 v52, v52, v53
    v_exp_f32 v57, v57
    v_exp_f32 v58, v58
    v_exp_f32 v59, v59
    v_cvt_pk_bf16_f32 v53, v54, v55
    v_cvt_pk_bf16_f32 v54, v56, v57
    s_setprio 0
    v_cvt_pk_bf16_f32 v55, v58, v59
    v_exp_f32 v60, v60
    v_exp_f32 v61, v61
    v_exp_f32 v62, v62
    v_exp_f32 v63, v63
    v_cvt_pk_bf16_f32 v60, v60, v61
    s_waitcnt lgkmcnt(1)
    v_mfma_f32_32x32x16_bf16 v[68:83], v[92:95], v[52:55], v[68:83]
    v_exp_f32 v64, v64
    v_exp_f32 v65, v65
    v_exp_f32 v66, v66
    v_exp_f32 v67, v67
    v_cvt_pk_bf16_f32 v61, v62, v63
    v_cvt_pk_bf16_f32 v62, v64, v65
    v_cvt_pk_bf16_f32 v63, v66, v67
    s_waitcnt lgkmcnt(0)
    s_nop 0
    v_mfma_f32_32x32x16_bf16 v[68:83], v[96:99], v[60:63], v[68:83]
    s_setprio 0
    s_mul_i32 s24, s45, 36864
    s_add_u32 s24, s24, 0x840000
    s_lshl_b32 s27, s46, 10
    s_add_u32 s27, s27, s24
    s_lshr_b32 s25, s46, 2
    s_lshl_b32 s25, s25, 9
    s_and_b32 s26, s46, 3
    s_lshl_b32 s26, s26, 2
    s_add_u32 s25, s25, s26
    s_add_u32 s25, s25, s24
    s_add_u32 s25, s25, 32768
    v_cmp_eq_u32 vcc, 0, v3
    v_lshlrev_b32 v12, 30, v3
    v_lshl_add_u32 v12, v2, 4, v12
    v_mov_b32 v5, 0x5d800000
    v_cndmask_b32 v4, v80, v78, vcc
    v_cmp_le_f32 vcc, 0x21800000, v4
    v_cmp_le_f32 s[62:63], v4, v5
    s_and_b64 vcc, vcc, s[62:63]
    s_cmp_eq_u64 vcc, -1
    s_cbranch_scc0 L_A_slow
L_A_fin:
    v_rcp_f32 v4, v4
    s_nop 0
    v_mul_f32 v68, v4, v68
    v_mul_f32 v69, v4, v69
    v_mul_f32 v70, v4, v70
    v_mul_f32 v71, v4, v71
    v_mul_f32 v72, v4, v72
    v_mul_f32 v73, v4, v73
    v_mul_f32 v74, v4, v74
    v_mul_f32 v75, v4, v75
    v_mul_f32 v76, v4, v76
    v_mul_f32 v77, v4, v77
    v_cvt_pk_bf16_f32 v68, v68, v69
    v_cvt_pk_bf16_f32 v69, v70, v71
    v_cvt_pk_bf16_f32 v70, v72, v73
    v_cvt_pk_bf16_f32 v71, v74, v75
    v_cvt_pk_bf16_f32 v72, v76, v77
    s_cmp_eq_u32 s99, 1
    s_cbranch_scc1 Ls_57
    buffer_store_dwordx4 v[68:71], v1, s[4:7], s27 offen sc1
    buffer_store_dword v72, v12, s[4:7], s25 offen sc1
    s_branch Lse_58
Ls_57:
    buffer_store_dwordx4 v[68:71], v1, s[4:7], s27 offen
    buffer_store_dword v72, v12, s[4:7], s25 offen
Lse_58:
    s_waitcnt vmcnt(0)
    s_barrier
    s_cmp_lg_u32 s3, 0
    s_cbranch_scc1 L_A_end
    s_lshr_b32 s22, s45, 1
    s_lshl_b32 s22, s22, 10
    s_lshl_b32 s23, s46, 5
    s_add_u32 s22, s22, s23
    s_add_u32 s22, s22, 0x510004
    s_mov_b64 exec, 1
    s_cmp_eq_u32 s99, 1
    s_cbranch_scc1 Ls_59
    buffer_store_dword v14, off, s[16:19], s22 sc1
    s_branch Lse_60
Ls_59:
    buffer_store_dword v14, off, s[16:19], s22
Lse_60:
    s_mov_b64 exec, -1
L_A_end:
    s_cmp_lt_u32 s3, s44
    s_cbranch_scc1 L_OA_c
    s_cmp_eq_u32 s3, 7
    s_cbranch_scc1 L_OA_ld
    s_cmp_eq_u32 s3, 4
    s_cbranch_scc1 L_OA_idle
    s_sub_u32 s22, s3, 5
    s_mul_i32 s23, s22, 36864
    s_add_u32 s23, s23, 40960
    v_add_u32 v4, s23, v1
    ds_write_b128 v4, v[112:115] offset:0
    ds_write_b128 v4, v[116:119] offset:1024
    ds_write_b128 v4, v[120:123] offset:2048
    ds_write_b128 v4, v[124:127] offset:3072
    ds_write_b128 v4, v[128:131] offset:4096
    ds_write_b128 v4, v[132:135] offset:5120
    ds_write_b128 v4, v[136:139] offset:6144
    ds_write_b128 v4, v[140:143] offset:7168
    ds_write_b128 v4, v[144:147] offset:8192
    ds_write_b128 v4, v[148:151] offset:9216
    ds_write_b128 v4, v[152:155] offset:10240
    ds_write_b128 v4, v[156:159] offset:11264
    ds_write_b128 v4, v[160:163] offset:12288
    ds_write_b128 v4, v[164:167] offset:13312
    ds_write_b128 v4, v[168:171] offset:14336
    ds_write_b128 v4, v[172:175] offset:15360
    ds_write_b128 v4, v[176:179] offset:16384
    ds_write_b128 v4, v[180:183] offset:17408
    ds_write_b128 v4, v[184:187] offset:18432
    ds_write_b128 v4, v[188:191] offset:19456
    ds_write_b128 v4, v[192:195] offset:20480
    ds_write_b128 v4, v[196:199] offset:21504
    ds_write_b128 v4, v[200:203] offset:22528
    ds_write_b128 v4, v[204:207] offset:23552
    ds_write_b128 v4, v[208:211] offset:24576
    ds_write_b128 v4, v[212:215] offset:25600
    ds_write_b128 v4, v[216:219] offset:26624
    ds_write_b128 v4, v[220:223] offset:27648
    ds_write_b128 v4, v[224:227] offset:28672
    ds_write_b128 v4, v[228:231] offset:29696
    ds_write_b128 v4, v[232:235] offset:30720
    ds_write_b128 v4, v[236:239] offset:31744
    ds_write_b128 v4, v[240:243] offset:32768
    ds_write_b128 v4, v[244:247] offset:33792
    ds_write_b128 v4, v[248:251] offset:34816
    ds_write_b128 v4, v[252:255] offset:35840
    s_barrier
    s_barrier
    s_barrier
    s_cmp_eq_u32 s15, 0
    s_cbranch_scc0 L_OA_cs
    v_dot2_f32_bf16 v106, v112, s60, 0
    v_dot2_f32_bf16 v107, v113, s60, 0
    v_dot2_f32_bf16 v108, v114, s60, 0
    v_dot2_f32_bf16 v109, v115, s60, 0
    v_dot2_f32_bf16 v106, v116, s60, v106
    v_dot2_f32_bf16 v107, v117, s60, v107
    v_dot2_f32_bf16 v108, v118, s60, v108
    v_dot2_f32_bf16 v109, v119, s60, v109
    v_dot2_f32_bf16 v106, v120, s60, v106
    v_dot2_f32_bf16 v107, v121, s60, v107
    v_dot2_f32_bf16 v108, v122, s60, v108
    v_dot2_f32_bf16 v109, v123, s60, v109
    v_dot2_f32_bf16 v106, v124, s60, v106
    v_dot2_f32_bf16 v107, v125, s60, v107
    v_dot2_f32_bf16 v108, v126, s60, v108
    v_dot2_f32_bf16 v109, v127, s60, v109
    v_dot2_f32_bf16 v106, v128, s60, v106
    v_dot2_f32_bf16 v107, v129, s60, v107
    v_dot2_f32_bf16 v108, v130, s60, v108
    v_dot2_f32_bf16 v109, v131, s60, v109
    v_dot2_f32_bf16 v106, v132, s60, v106
    v_dot2_f32_bf16 v107, v133, s60, v107
    v_dot2_f32_bf16 v108, v134, s60, v108
    v_dot2_f32_bf16 v109, v135, s60, v109
    v_dot2_f32_bf16 v106, v136, s60, v106
    v_dot2_f32_bf16 v107, v137, s60, v107
    v_dot2_f32_bf16 v108, v138, s60, v108
    v_dot2_f32_bf16 v109, v139, s60, v109
    v_dot2_f32_bf16 v106, v140, s60, v106
    v_dot2_f32_bf16 v107, v141, s60, v107
    v_dot2_f32_bf16 v108, v142, s60, v108
    v_dot2_f32_bf16 v109, v143, s60, v109
    v_dot2_f32_bf16 v106, v144, s60, v106
    v_dot2_f32_bf16 v107, v145, s60, v107
    v_dot2_f32_bf16 v108, v146, s60, v108
    v_dot2_f32_bf16 v109, v147, s60, v109
    v_dot2_f32_bf16 v106, v148, s60, v106
    v_dot2_f32_bf16 v107, v149, s60, v107
    v_dot2_f32_bf16 v108, v150, s60, v108
    v_dot2_f32_bf16 v109, v151, s60, v109
    v_dot2_f32_bf16 v106, v152, s60, v106
    v_dot2_f32_bf16 v107, v153, s60, v107
    v_dot2_f32_bf16 v108, v154, s60, v108
    v_dot2_f32_bf16 v109, v155, s60, v109
    v_dot2_f32_bf16 v106, v156, s60, v106
    v_dot2_f32_bf16 v107, v157, s60, v107
    v_dot2_f32_bf16 v108, v158, s60, v108
    v_dot2_f32_bf16 v109, v159, s60, v109
    v_dot2_f32_bf16 v106, v160, s60, v106
    v_dot2_f32_bf16 v107, v161, s60, v107
    v_dot2_f32_bf16 v108, v162, s60, v108
    v_dot2_f32_bf16 v109, v163, s60, v109
    v_dot2_f32_bf16 v106, v164, s60, v106
    v_dot2_f32_bf16 v107, v165, s60, v107
    v_dot2_f32_bf16 v108, v166, s60, v108
    v_dot2_f32_bf16 v109, v167, s60, v109
    v_dot2_f32_bf16 v106, v168, s60, v106
    v_dot2_f32_bf16 v107, v169, s60, v107
    v_dot2_f32_bf16 v108, v170, s60, v108
    v_dot2_f32_bf16 v109, v171, s60, v109
    v_dot2_f32_bf16 v106, v172, s60, v106
    v_dot2_f32_bf16 v107, v173, s60, v107
    v_dot2_f32_bf16 v108, v174, s60, v108
    v_dot2_f32_bf16 v109, v175, s60, v109
    v_dot2_f32_bf16 v106, v176, s60, v106
    v_dot2_f32_bf16 v107, v177, s60, v107
    v_dot2_f32_bf16 v108, v178, s60, v108
    v_dot2_f32_bf16 v109, v179, s60, v109
    v_dot2_f32_bf16 v106, v180, s60, v106
    v_dot2_f32_bf16 v107, v181, s60, v107
    v_dot2_f32_bf16 v108, v182, s60, v108
    v_dot2_f32_bf16 v109, v183, s60, v109
    v_dot2_f32_bf16 v106, v184, s60, v106
    v_dot2_f32_bf16 v107, v185, s60, v107
    v_dot2_f32_bf16 v108, v186, s60, v108
    v_dot2_f32_bf16 v109, v187, s60, v109
    v_dot2_f32_bf16 v106, v188, s60, v106
    v_dot2_f32_bf16 v107, v189, s60, v107
    v_dot2_f32_bf16 v108, v190, s60, v108
    v_dot2_f32_bf16 v109, v191, s60, v109
    v_dot2_f32_bf16 v106, v192, s60, v106
    v_dot2_f32_bf16 v107, v193, s60, v107
    v_dot2_f32_bf16 v108, v194, s60, v108
    v_dot2_f32_bf16 v109, v195, s60, v109
    v_dot2_f32_bf16 v106, v196, s60, v106
    v_dot2_f32_bf16 v107, v197, s60, v107
    v_dot2_f32_bf16 v108, v198, s60, v108
    v_dot2_f32_bf16 v109, v199, s60, v109
    v_dot2_f32_bf16 v106, v200, s60, v106
    v_dot2_f32_bf16 v107, v201, s60, v107
    v_dot2_f32_bf16 v108, v202, s60, v108
    v_dot2_f32_bf16 v109, v203, s60, v109
    v_dot2_f32_bf16 v106, v204, s60, v106
    v_dot2_f32_bf16 v107, v205, s60, v107
    v_dot2_f32_bf16 v108, v206, s60, v108
    v_dot2_f32_bf16 v109, v207, s60, v109
    v_dot2_f32_bf16 v106, v208, s60, v106
    v_dot2_f32_bf16 v107, v209, s60, v107
    v_dot2_f32_bf16 v108, v210, s60, v108
    v_dot2_f32_bf16 v109, v211, s60, v109
    v_dot2_f32_bf16 v106, v212, s60, v106
    v_dot2_f32_bf16 v107, v213, s60, v107
    v_dot2_f32_bf16 v108, v214, s60, v108
    v_dot2_f32_bf16 v109, v215, s60, v109
    v_dot2_f32_bf16 v106, v216, s60, v106
    v_dot2_f32_bf16 v107, v217, s60, v107
    v_dot2_f32_bf16 v108, v218, s60, v108
    v_dot2_f32_bf16 v109, v219, s60, v109
    v_dot2_f32_bf16 v106, v220, s60, v106
    v_dot2_f32_bf16 v107, v221, s60, v107
    v_dot2_f32_bf16 v108, v222, s60, v108
    v_dot2_f32_bf16 v109, v223, s60, v109
    v_dot2_f32_bf16 v106, v224, s60, v106
    v_dot2_f32_bf16 v107, v225, s60, v107
    v_dot2_f32_bf16 v108, v226, s60, v108
    v_dot2_f32_bf16 v109, v227, s60, v109
    v_dot2_f32_bf16 v106, v228, s60, v106
    v_dot2_f32_bf16 v107, v229, s60, v107
    v_dot2_f32_bf16 v108, v230, s60, v108
    v_dot2_f32_bf16 v109, v231, s60, v109
    v_dot2_f32_bf16 v106, v232, s60, v106
    v_dot2_f32_bf16 v107, v233, s60, v107
    v_dot2_f32_bf16 v108, v234, s60, v108
    v_dot2_f32_bf16 v109, v235, s60, v109
    v_dot2_f32_bf16 v106, v236, s60, v106
    v_dot2_f32_bf16 v107, v237, s60, v107
    v_dot2_f32_bf16 v108, v238, s60, v108
    v_dot2_f32_bf16 v109, v239, s60, v109
    v_dot2_f32_bf16 v106, v240, s60, v106
    v_dot2_f32_bf16 v107, v241, s60, v107
    v_dot2_f32_bf16 v108, v242, s60, v108
    v_dot2_f32_bf16 v109, v243, s60, v109
    v_dot2_f32_bf16 v106, v244, s60, v106
    v_dot2_f32_bf16 v107, v245, s60, v107
    v_dot2_f32_bf16 v108, v246, s60, v108
    v_dot2_f32_bf16 v109, v247, s60, v109
    v_dot2_f32_bf16 v106, v248, s60, v106
    v_dot2_f32_bf16 v107, v249, s60, v107
    v_dot2_f32_bf16 v108, v250, s60, v108
    v_dot2_f32_bf16 v109, v251, s60, v109
    v_dot2_f32_bf16 v106, v252, s60, v106
    v_dot2_f32_bf16 v107, v253, s60, v107
    v_dot2_f32_bf16 v108, v254, s60, v108
    v_dot2_f32_bf16 v109, v255, s60, v109
    s_nop 2
    v_add_f32 v106, v106, v107
    v_add_f32 v108, v108, v109
    v_add_f32 v106, v106, v108
    v_cvt_pk_bf16_f32 v16, v106, v106
    v_lshlrev_b32 v16, 16, v16
    v_sub_f32 v106, v106, v16
    v_cvt_pk_bf16_f32 v16, v16, v106
L_OA_cs:
    s_lshl_b32 s22, s22, 8
    s_add_u32 s22, s22, 114688
    v_lshrrev_b32 v4, 2, v1
    v_add_u32 v4, s22, v4
    ds_write_b32 v4, v16
    v_mov_b32 v4, 162832
    v_mov_b32 v8, 0
    v_mov_b32 v9, 0
    v_mov_b32 v10, 0
    v_mov_b32 v11, 0
    ds_write_b128 v4, v[8:11]
    ds_write_b128 v4, v[8:11] offset:16
    s_waitcnt lgkmcnt(0)
    s_branch L_OA_e
L_OA_idle:
    s_barrier
    s_barrier
    s_barrier
    s_branch L_OA_e
L_OA_ld:
    s_lshr_b32 s23, s42, 1
    s_lshl_b32 s23, s23, 10
    s_add_u32 s23, s23, 0x510004
    v_lshlrev_b32 v5, 3, v1
    s_mov_b32 exec_lo, 0xff
    s_mov_b32 exec_hi, 0x0
    s_mov_b32 s21, 0
Lp_61:
    buffer_load_dword v4, v5, s[16:19], s23 offen sc1
    s_add_u32 s21, s21, 1
    s_cmp_gt_u32 s21, s20
    s_cselect_b32 s20, 0, s20
    s_waitcnt vmcnt(0)
    s_cbranch_scc1 Lpd_62
    v_cmp_ne_u32 vcc, s14, v4
    s_cbranch_vccnz Lp_61
Lpd_62:
    s_mov_b64 exec, -1
    s_mul_i32 s22, s42, 36864
    s_add_u32 s22, s22, 0x840000
    s_mov_b32 m0, 0
    s_nop 0
    buffer_load_dwordx4 v1, s[4:7], s22 offen sc1 lds
    s_add_u32 m0, m0, 1024
    s_add_u32 s22, s22, 1024
    s_nop 0
    buffer_load_dwordx4 v1, s[4:7], s22 offen sc1 lds
    s_add_u32 m0, m0, 1024
    s_add_u32 s22, s22, 1024
    s_nop 0
    buffer_load_dwordx4 v1, s[4:7], s22 offen sc1 lds
    s_add_u32 m0, m0, 1024
    s_add_u32 s22, s22, 1024
    s_nop 0
    buffer_load_dwordx4 v1, s[4:7], s22 offen sc1 lds
    s_add_u32 m0, m0, 1024
    s_add_u32 s22, s22, 1024
    s_nop 0
    buffer_load_dwordx4 v1, s[4:7], s22 offen sc1 lds
    s_add_u32 m0, m0, 1024
    s_add_u32 s22, s22, 1024
    s_nop 0
    buffer_load_dwordx4 v1, s[4:7], s22 offen sc1 lds
    s_add_u32 m0, m0, 1024
    s_add_u32 s22, s22, 1024
    s_nop 0
    buffer_load_dwordx4 v1, s[4:7], s22 offen sc1 lds
    s_add_u32 m0, m0, 1024
    s_add_u32 s22, s22, 1024
    s_nop 0
    buffer_load_dwordx4 v1, s[4:7], s22 offen sc1 lds
    s_add_u32 m0, m0, 1024
    s_add_u32 s22, s22, 1024
    s_nop 0
    buffer_load_dwordx4 v1, s[4:7], s22 offen sc1 lds
    s_add_u32 m0, m0, 1024
    s_add_u32 s22, s22, 1024
    s_nop 0
    buffer_load_dwordx4 v1, s[4:7], s22 offen sc1 lds
    s_add_u32 m0, m0, 1024
    s_add_u32 s22, s22, 1024
    s_nop 0
    buffer_load_dwordx4 v1, s[4:7], s22 offen sc1 lds
    s_add_u32 m0, m0, 1024
    s_add_u32 s22, s22, 1024
    s_nop 0
    buffer_load_dwordx4 v1, s[4:7], s22 offen sc1 lds
    s_add_u32 m0, m0, 1024
    s_add_u32 s22, s22, 1024
    s_nop 0
    buffer_load_dwordx4 v1, s[4:7], s22 offen sc1 lds
    s_add_u32 m0, m0, 1024
    s_add_u32 s22, s22, 1024
    s_nop 0
    buffer_load_dwordx4 v1, s[4:7], s22 offen sc1 lds
    s_add_u32 m0, m0, 1024
    s_add_u32 s22, s22, 1024
    s_nop 0
    buffer_load_dwordx4 v1, s[4:7], s22 offen sc1 lds
    s_add_u32 m0, m0, 1024
    s_add_u32 s22, s22, 1024
    s_nop 0
    buffer_load_dwordx4 v1, s[4:7], s22 offen sc1 lds
    s_add_u32 m0, m0, 1024
    s_add_u32 s22, s22, 1024
    s_nop 0
    buffer_load_dwordx4 v1, s[4:7], s22 offen sc1 lds
    s_add_u32 m0, m0, 1024
    s_add_u32 s22, s22, 1024
    s_nop 0
    buffer_load_dwordx4 v1, s[4:7], s22 offen sc1 lds
    s_add_u32 m0, m0, 1024
    s_add_u32 s22, s22, 1024
    s_nop 0
    buffer_load_dwordx4 v1, s[4:7], s22 offen sc1 lds
    s_add_u32 m0, m0, 1024
    s_add_u32 s22, s22, 1024
    s_nop 0
    buffer_load_dwordx4 v1, s[4:7], s22 offen sc1 lds
    s_add_u32 m0, m0, 1024
    s_add_u32 s22, s22, 1024
    s_nop 0
    buffer_load_dwordx4 v1, s[4:7], s22 offen sc1 lds
    s_add_u32 m0, m0, 1024
    s_add_u32 s22, s22, 1024
    s_nop 0
    buffer_load_dwordx4 v1, s[4:7], s22 offen sc1 lds
    s_add_u32 m0, m0, 1024
    s_add_u32 s22, s22, 1024
    s_nop 0
    buffer_load_dwordx4 v1, s[4:7], s22 offen sc1 lds
    s_add_u32 m0, m0, 1024
    s_add_u32 s22, s22, 1024
    s_nop 0
    buffer_load_dwordx4 v1, s[4:7], s22 offen sc1 lds
    s_add_u32 m0, m0, 1024
    s_add_u32 s22, s22, 1024
    s_nop 0
    buffer_load_dwordx4 v1, s[4:7], s22 offen sc1 lds
    s_add_u32 m0, m0, 1024
    s_add_u32 s22, s22, 1024
    s_nop 0
    buffer_load_dwordx4 v1, s[4:7], s22 offen sc1 lds
    s_add_u32 m0, m0, 1024
    s_add_u32 s22, s22, 1024
    s_nop 0
    buffer_load_dwordx4 v1, s[4:7], s22 offen sc1 lds
    s_add_u32 m0, m0, 1024
    s_add_u32 s22, s22, 1024
    s_nop 0
    buffer_load_dwordx4 v1, s[4:7], s22 offen sc1 lds
    s_add_u32 m0, m0, 1024
    s_add_u32 s22, s22, 1024
    s_nop 0
    buffer_load_dwordx4 v1, s[4:7], s22 offen sc1 lds
    s_add_u32 m0, m0, 1024
    s_add_u32 s22, s22, 1024
    s_nop 0
    buffer_load_dwordx4 v1, s[4:7], s22 offen sc1 lds
    s_add_u32 m0, m0, 1024
    s_add_u32 s22, s22, 1024
    s_nop 0
    buffer_load_dwordx4 v1, s[4:7], s22 offen sc1 lds
    s_add_u32 m0, m0, 1024
    s_add_u32 s22, s22, 1024
    s_nop 0
    buffer_load_dwordx4 v1, s[4:7], s22 offen sc1 lds
    s_add_u32 m0, m0, 1024
    s_add_u32 s22, s22, 1024
    s_nop 0
    buffer_load_dwordx4 v1, s[4:7], s22 offen sc1 lds
    s_add_u32 m0, m0, 1024
    s_add_u32 s22, s22, 1024
    s_nop 0
    buffer_load_dwordx4 v1, s[4:7], s22 offen sc1 lds
    s_add_u32 m0, m0, 1024
    s_add_u32 s22, s22, 1024
    s_nop 0
    buffer_load_dwordx4 v1, s[4:7], s22 offen sc1 lds
    s_add_u32 m0, m0, 1024
    s_add_u32 s22, s22, 1024
    s_nop 0
    buffer_load_dwordx4 v1, s[4:7], s22 offen sc1 lds
    s_waitcnt vmcnt(24)
    s_barrier
    s_waitcnt vmcnt(12)
    s_barrier
    s_waitcnt vmcnt(0)
    s_barrier
    s_branch L_OA_e
L_OA_c:
    v_lshlrev_b32 v24, 16, v16
    v_and_b32 v25, 0xffff0000, v16
    v_lshlrev_b32 v26, 16, v17
    v_and_b32 v27, 0xffff0000, v17
    v_lshlrev_b32 v28, 16, v18
    v_and_b32 v29, 0xffff0000, v18
    v_lshlrev_b32 v30, 16, v19
    v_and_b32 v31, 0xffff0000, v19
    v_lshlrev_b32 v32, 16, v20
    v_and_b32 v33, 0xffff0000, v20
    v_lshlrev_b32 v34, 16, v21
    v_and_b32 v35, 0xffff0000, v21
    v_lshlrev_b32 v36, 16, v22
    v_and_b32 v37, 0xffff0000, v22
    v_lshlrev_b32 v38, 16, v23
    v_and_b32 v39, 0xffff0000, v23
    s_barrier
    ds_read_b128 v[56:59], v1 offset:0
    ds_read_b128 v[60:63], v1 offset:1024
    ds_read_b128 v[64:67], v1 offset:2048
    ds_read_b128 v[68:71], v1 offset:3072
    ds_read_b128 v[72:75], v1 offset:4096
    ds_read_b128 v[76:79], v1 offset:5120
    ds_read_b128 v[80:83], v1 offset:6144
    ds_read_b128 v[84:87], v1 offset:7168
    s_waitcnt lgkmcnt(7)
    v_mfma_f32_32x32x16_bf16 v[24:39], v[112:115], v[56:59], v[24:39]
    ds_read_b128 v[56:59], v1 offset:8192
    s_waitcnt lgkmcnt(7)
    v_mfma_f32_32x32x16_bf16 v[24:39], v[116:119], v[60:63], v[24:39]
    ds_read_b128 v[60:63], v1 offset:9216
    s_waitcnt lgkmcnt(7)
    v_mfma_f32_32x32x16_bf16 v[24:39], v[120:123], v[64:67], v[24:39]
    ds_read_b128 v[64:67], v1 offset:10240
    s_waitcnt lgkmcnt(7)
    v_mfma_f32_32x32x16_bf16 v[24:39], v[124:127], v[68:71], v[24:39]
    ds_read_b128 v[68:71], v1 offset:11264
    s_waitcnt lgkmcnt(7)
    v_mfma_f32_32x32x16_bf16 v[24:39], v[128:131], v[72:75], v[24:39]
    s_barrier
    ds_read_b128 v[72:75], v1 offset:12288
    s_waitcnt lgkmcnt(7)
    v_mfma_f32_32x32x16_bf16 v[24:39], v[132:135], v[76:79], v[24:39]
    ds_read_b128 v[76:79], v1 offset:13312
    s_waitcnt lgkmcnt(7)
    v_mfma_f32_32x32x16_bf16 v[24:39], v[136:139], v[80:83], v[24:39]
    ds_read_b128 v[80:83], v1 offset:14336
    s_waitcnt lgkmcnt(7)
    v_mfma_f32_32x32x16_bf16 v[24:39], v[140:143], v[84:87], v[24:39]
    ds_read_b128 v[84:87], v1 offset:15360
    s_waitcnt lgkmcnt(7)
    v_mfma_f32_32x32x16_bf16 v[24:39], v[144:147], v[56:59], v[24:39]
    ds_read_b128 v[56:59], v1 offset:16384
    s_waitcnt lgkmcnt(7)
    v_mfma_f32_32x32x16_bf16 v[24:39], v[148:151], v[60:63], v[24:39]
    ds_read_b128 v[60:63], v1 offset:17408
    s_waitcnt lgkmcnt(7)
    v_mfma_f32_32x32x16_bf16 v[24:39], v[152:155], v[64:67], v[24:39]
    ds_read_b128 v[64:67], v1 offset:18432
    s_waitcnt lgkmcnt(7)
    v_mfma_f32_32x32x16_bf16 v[24:39], v[156:159], v[68:71], v[24:39]
    ds_read_b128 v[68:71], v1 offset:19456
    s_waitcnt lgkmcnt(7)
    v_mfma_f32_32x32x16_bf16 v[24:39], v[160:163], v[72:75], v[24:39]
    ds_read_b128 v[72:75], v1 offset:20480
    s_waitcnt lgkmcnt(7)
    v_mfma_f32_32x32x16_bf16 v[24:39], v[164:167], v[76:79], v[24:39]
    ds_read_b128 v[76:79], v1 offset:21504
    s_waitcnt lgkmcnt(7)
    v_mfma_f32_32x32x16_bf16 v[24:39], v[168:171], v[80:83], v[24:39]
    ds_read_b128 v[80:83], v1 offset:22528
    s_waitcnt lgkmcnt(7)
    v_mfma_f32_32x32x16_bf16 v[24:39], v[172:175], v[84:87], v[24:39]
    ds_read_b128 v[84:87], v1 offset:23552
    s_waitcnt lgkmcnt(7)
    v_mfma_f32_32x32x16_bf16 v[24:39], v[176:179], v[56:59], v[24:39]
    s_barrier
    ds_read_b128 v[56:59], v1 offset:24576
    s_waitcnt lgkmcnt(7)
    v_mfma_f32_32x32x16_bf16 v[24:39], v[180:183], v[60:63], v[24:39]
    ds_read_b128 v[60:63], v1 offset:25600
    s_waitcnt lgkmcnt(7)
    v_mfma_f32_32x32x16_bf16 v[24:39], v[184:187], v[64:67], v[24:39]
    ds_read_b128 v[64:67], v1 offset:26624
    s_waitcnt lgkmcnt(7)
    v_mfma_f32_32x32x16_bf16 v[24:39], v[188:191], v[68:71], v[24:39]
    ds_read_b128 v[68:71], v1 offset:27648
    s_waitcnt lgkmcnt(7)
    v_mfma_f32_32x32x16_bf16 v[24:39], v[192:195], v[72:75], v[24:39]
    ds_read_b128 v[72:75], v1 offset:28672
    s_waitcnt lgkmcnt(7)
    v_mfma_f32_32x32x16_bf16 v[24:39], v[196:199], v[76:79], v[24:39]
    ds_read_b128 v[76:79], v1 offset:29696
    s_waitcnt lgkmcnt(7)
    v_mfma_f32_32x32x16_bf16 v[24:39], v[200:203], v[80:83], v[24:39]
    s_waitcnt vmcnt(0)
    ds_read_b128 v[80:83], v1 offset:30720
    s_waitcnt lgkmcnt(7)
    v_mfma_f32_32x32x16_bf16 v[24:39], v[204:207], v[84:87], v[24:39]
    ds_read_b128 v[84:87], v1 offset:31744
    s_waitcnt lgkmcnt(7)
    v_mfma_f32_32x32x16_bf16 v[24:39], v[208:211], v[56:59], v[24:39]
    ds_read_b128 v[56:59], v1 offset:32768
    s_waitcnt lgkmcnt(7)
    v_mfma_f32_32x32x16_bf16 v[24:39], v[212:215], v[60:63], v[24:39]
    ds_read_b128 v[60:63], v1 offset:33792
    s_waitcnt lgkmcnt(7)
    v_mfma_f32_32x32x16_bf16 v[24:39], v[216:219], v[64:67], v[24:39]
    ds_read_b128 v[64:67], v1 offset:34816
    s_waitcnt lgkmcnt(7)
    v_mfma_f32_32x32x16_bf16 v[24:39], v[220:223], v[68:71], v[24:39]
    ds_read_b128 v[68:71], v1 offset:35840
    s_waitcnt lgkmcnt(7)
    v_mfma_f32_32x32x16_bf16 v[24:39], v[224:227], v[72:75], v[24:39]
    s_waitcnt lgkmcnt(6)
    v_mfma_f32_32x32x16_bf16 v[24:39], v[228:231], v[76:79], v[24:39]
    s_waitcnt lgkmcnt(5)
    v_mfma_f32_32x32x16_bf16 v[24:39], v[232:235], v[80:83], v[24:39]
    s_waitcnt lgkmcnt(4)
    v_mfma_f32_32x32x16_bf16 v[24:39], v[236:239], v[84:87], v[24:39]
    s_waitcnt lgkmcnt(3)
    v_mfma_f32_32x32x16_bf16 v[24:39], v[240:243], v[56:59], v[24:39]
    s_waitcnt lgkmcnt(2)
    v_mfma_f32_32x32x16_bf16 v[24:39], v[244:247], v[60:63], v[24:39]
    s_waitcnt lgkmcnt(1)
    v_mfma_f32_32x32x16_bf16 v[24:39], v[248:251], v[64:67], v[24:39]
    s_waitcnt lgkmcnt(0)
    v_mfma_f32_32x32x16_bf16 v[24:39], v[252:255], v[68:71], v[24:39]
    s_mul_i32 s26, s42, 36864
    s_lshl_b32 s27, s43, 11
    s_add_u32 s26, s26, s27
    s_add_u32 s26, s26, 0x600000
    s_mul_i32 s27, s42, 4608
    s_lshl_b32 s28, s43, 8
    s_add_u32 s27, s27, s28
    s_add_u32 s27, s27, 0xa80000
    v_lshrrev_b32 v8, 2, v1
    s_nop 3
    v_cvt_pk_bf16_f32 v16, v24, v25
    v_cvt_pk_bf16_f32 v17, v26, v27
    v_cvt_pk_bf16_f32 v18, v28, v29
    v_cvt_pk_bf16_f32 v19, v30, v31
    v_cvt_pk_bf16_f32 v20, v32, v33
    v_cvt_pk_bf16_f32 v21, v34, v35
    v_cvt_pk_bf16_f32 v22, v36, v37
    v_cvt_pk_bf16_f32 v23, v38, v39
    s_cmp_eq_u32 s99, 1
    s_cbranch_scc1 Ls_63
    buffer_store_dwordx4 v[16:19], v1, s[4:7], s26 offen sc1
    buffer_store_dwordx4 v[20:23], v1, s[4:7], s26 offen offset:1024 sc1
    s_branch Lse_64
Ls_63:
    buffer_store_dwordx4 v[16:19], v1, s[4:7], s26 offen
    buffer_store_dwordx4 v[20:23], v1, s[4:7], s26 offen offset:1024
Lse_64:
    v_dot2_f32_bf16 v4, v16, s60, 0
    v_dot2_f32_bf16 v5, v16, v16, 0
    v_dot2_f32_bf16 v6, v17, s60, 0
    v_dot2_f32_bf16 v7, v17, v17, 0
    v_dot2_f32_bf16 v4, v18, s60, v4
    v_dot2_f32_bf16 v5, v18, v18, v5
    v_dot2_f32_bf16 v6, v19, s60, v6
    v_dot2_f32_bf16 v7, v19, v19, v7
    v_dot2_f32_bf16 v4, v20, s60, v4
    v_dot2_f32_bf16 v5, v20, v20, v5
    v_dot2_f32_bf16 v6, v21, s60, v6
    v_dot2_f32_bf16 v7, v21, v21, v7
    v_dot2_f32_bf16 v4, v22, s60, v4
    v_dot2_f32_bf16 v5, v22, v22, v5
    v_dot2_f32_bf16 v6, v23, s60, v6
    v_dot2_f32_bf16 v7, v23, v23, v7
    s_nop 2
    v_add_f32 v4, v4, v6
    v_add_f32 v5, v5, v7
    s_nop 1
    v_permlane32_swap_b32 v4, v5
    s_nop 1
    v_add_f32 v4, v4, v5
    s_cmp_eq_u32 s99, 1
    s_cbranch_scc1 Ls_65
    buffer_store_dword v4, v8, s[4:7], s27 offen sc1
    s_branch Lse_66
Ls_65:
    buffer_store_dword v4, v8, s[4:7], s27 offen
Lse_66:
    s_waitcnt vmcnt(0)
L_OA_e:
    s_barrier
    s_cmp_lg_u32 s3, 0
    s_cbranch_scc1 L_OA_nf
    s_lshl_b32 s22, s42, 9
    s_lshr_b32 s23, s13, 3
    s_lshl_b32 s23, s23, 7
    s_add_u32 s22, s22, s23
    s_add_u32 s22, s22, 0x510008
    s_mov_b64 exec, 1
    s_cmp_eq_u32 s99, 1
    s_cbranch_scc1 Ls_67
    buffer_store_dword v14, off, s[16:19], s22 sc1
    s_branch Lse_68
Ls_67:
    buffer_store_dword v14, off, s[16:19], s22
Lse_68:
    s_mov_b64 exec, -1
L_OA_nf:
    s_add_u32 s48, s3, 4
    s_sub_u32 s22, 7, s3
    s_cmp_lt_u32 s3, 4
    s_cselect_b32 s48, s48, s22
    s_lshl_b32 s45, s12, 3
    s_add_u32 s45, s45, s48
    s_mov_b32 s46, s13
    s_setprio 1
    s_cmp_lt_u32 s3, 4
    s_cbranch_scc0 L_B_pr
    s_setprio 2
L_B_pr:
    s_add_u32 s28, s48, 8
    s_mul_i32 s28, s28, 2368
    s_add_u32 s28, s28, 118784
    s_lshl_b32 s49, s46, 6
    s_add_u32 s49, s49, s45
    s_mul_i32 s29, s49, 2368
    s_add_u32 s29, s29, 0x60000
    s_lshl_b32 s49, s49, 7
    s_add_u32 s49, s49, 0x520000
    s_lshl_b32 s27, s3, 8
    s_add_u32 s27, s27, 160768
    s_add_u32 s47, s48, 1
    s_cmp_eq_u32 s12, 0
    s_cselect_b32 s47, s47, 9
    s_mul_i32 s41, s43, 36864
    s_add_u32 s41, s41, 0x1000000
    s_cmp_lt_u32 s3, s44
    s_cselect_b32 s41, s41, 0x40000000
    v_lshrrev_b32 v5, 2, v1
    v_add_u32 v4, 114688, v5
    ds_read_b32 v106, v4
    ds_read_b32 v108, v4 offset:256
    v_mov_b32 v107, 0
    v_mov_b32 v109, 0
    s_sub_u32 s24, s28, 18944
    v_add_u32 v8, s24, v1
    v_lshl_add_u32 v9, v2, 2, s24
    s_add_u32 s24, s24, 1152
    v_mul_u32_u24 v10, 304, v3
    v_min_u32 v4, 18, v2
    v_lshl_add_u32 v10, v4, 4, v10
    v_add_u32 v10, s24, v10
    v_cmp_ge_u32 vcc, 18, v2
    v_cmp_eq_u32 s[62:63], 28, v2
    s_or_b64 vcc, vcc, s[62:63]
    v_mov_b32 v4, 0x40000
    s_nop 0
    v_cndmask_b32 v10, v4, v10, vcc
    v_mov_b32 v11, 0xf149f2ca
    v_cndmask_b32 v72, v11, 0, s[64:65]
    v_cndmask_b32 v73, v11, 0, s[66:67]
    v_cndmask_b32 v74, v11, 0, s[68:69]
    v_cndmask_b32 v75, v11, 0, s[70:71]
    v_cndmask_b32 v76, v11, 0, s[72:73]
    v_cndmask_b32 v77, v11, 0, s[74:75]
    v_cndmask_b32 v78, v11, 0, s[76:77]
    v_cndmask_b32 v79, v11, 0, s[78:79]
    v_cndmask_b32 v80, v11, 0, s[80:81]
    v_cndmask_b32 v81, v11, 0, s[82:83]
    v_cndmask_b32 v82, v11, 0, s[84:85]
    v_cndmask_b32 v83, v11, 0, s[86:87]
    v_cndmask_b32 v84, v11, 0, s[88:89]
    v_cndmask_b32 v85, v11, 0, s[90:91]
    v_cndmask_b32 v86, v11, 0, s[92:93]
    v_cndmask_b32 v87, v11, 0, s[94:95]
    s_lshl_b32 s23, s45, 9
    s_add_u32 s23, s23, 0x510008
    v_lshlrev_b32 v5, 3, v1
    s_mov_b64 exec, 15
    s_mov_b32 s21, 0
Lp_69:
    buffer_load_dword v4, v5, s[16:19], s23 offen sc1
    s_add_u32 s21, s21, 1
    s_cmp_gt_u32 s21, s20
    s_cselect_b32 s20, 0, s20
    s_waitcnt vmcnt(0)
    s_cbranch_scc1 Lpd_70
    v_cmp_ne_u32 vcc, s14, v4
    s_cbranch_vccnz Lp_69
Lpd_70:
    s_mov_b64 exec, -1
    s_and_b32 s24, s3, 3
    s_lshl_b32 s24, s24, 2
    s_add_u32 s50, s24, 162848
    s_cmp_lt_u32 s3, 4
    s_cbranch_scc1 L_B_x
    s_mov_b32 s51, 1
    s_call_b64 s[30:31], L_B_wait
L_B_x:
    v_lshrrev_b32 v4, 2, v1
    s_mul_i32 s40, s45, 4608
    s_add_u32 s40, s40, 0xa80000
    buffer_load_dword v88, v4, s[4:7], s40 offen offset:0 sc1
    buffer_load_dword v89, v4, s[4:7], s40 offen offset:256 sc1
    buffer_load_dword v90, v4, s[4:7], s40 offen offset:512 sc1
    buffer_load_dword v91, v4, s[4:7], s40 offen offset:768 sc1
    buffer_load_dword v92, v4, s[4:7], s40 offen offset:1024 sc1
    buffer_load_dword v93, v4, s[4:7], s40 offen offset:1280 sc1
    buffer_load_dword v94, v4, s[4:7], s40 offen offset:1536 sc1
    buffer_load_dword v95, v4, s[4:7], s40 offen offset:1792 sc1
    buffer_load_dword v96, v4, s[4:7], s40 offen offset:2048 sc1
    buffer_load_dword v97, v4, s[4:7], s40 offen offset:2304 sc1
    buffer_load_dword v98, v4, s[4:7], s40 offen offset:2560 sc1
    buffer_load_dword v99, v4, s[4:7], s40 offen offset:2816 sc1
    buffer_load_dword v100, v4, s[4:7], s40 offen offset:3072 sc1
    buffer_load_dword v101, v4, s[4:7], s40 offen offset:3328 sc1
    buffer_load_dword v102, v4, s[4:7], s40 offen offset:3584 sc1
    buffer_load_dword v103, v4, s[4:7], s40 offen offset:3840 sc1
    s_add_u32 s40, s40, 4096
    buffer_load_dword v104, v4, s[4:7], s40 offen offset:0 sc1
    buffer_load_dword v105, v4, s[4:7], s40 offen offset:256 sc1
    s_mul_i32 s22, s45, 36864
    s_add_u32 s22, s22, 0x600000
    s_add_u32 s61, s22, 0
    buffer_load_dwordx4 v[112:115], v1, s[4:7], s61 offen offset:0 sc1
    buffer_load_dwordx4 v[116:119], v1, s[4:7], s61 offen offset:1024 sc1
    buffer_load_dwordx4 v[120:123], v1, s[4:7], s61 offen offset:2048 sc1
    buffer_load_dwordx4 v[124:127], v1, s[4:7], s61 offen offset:3072 sc1
    s_add_u32 s61, s22, 4096
    buffer_load_dwordx4 v[128:131], v1, s[4:7], s61 offen offset:0 sc1
    buffer_load_dwordx4 v[132:135], v1, s[4:7], s61 offen offset:1024 sc1
    buffer_load_dwordx4 v[136:139], v1, s[4:7], s61 offen offset:2048 sc1
    buffer_load_dwordx4 v[140:143], v1, s[4:7], s61 offen offset:3072 sc1
    s_add_u32 s61, s22, 8192
    buffer_load_dwordx4 v[144:147], v1, s[4:7], s61 offen offset:0 sc1
    buffer_load_dwordx4 v[148:151], v1, s[4:7], s61 offen offset:1024 sc1
    buffer_load_dwordx4 v[152:155], v1, s[4:7], s61 offen offset:2048 sc1
    buffer_load_dwordx4 v[156:159], v1, s[4:7], s61 offen offset:3072 sc1
    v_add_u32 v6, 40960, v1
    v_add_u32 v7, 77824, v1
    s_waitcnt lgkmcnt(0)
    ds_read_b128 v[56:59], v6 offset:0
    ds_read_b128 v[60:63], v7 offset:0
    ds_read_b128 v[64:67], v6 offset:1024
    ds_read_b128 v[68:71], v7 offset:1024
    s_waitcnt vmcnt(11) lgkmcnt(3)
    v_mfma_f32_32x32x16_bf16 v[24:39], v[56:59], v[112:115], 0
    s_add_u32 s61, s22, 12288
    buffer_load_dwordx4 v[160:163], v1, s[4:7], s61 offen offset:0 sc1
    ds_read_b128 v[56:59], v6 offset:2048
    s_waitcnt lgkmcnt(3)
    v_mfma_f32_32x32x16_bf16 v[40:55], v[112:115], v[60:63], 0
    ds_read_b128 v[60:63], v7 offset:2048
    s_waitcnt vmcnt(11) lgkmcnt(3)
    v_mfma_f32_32x32x16_bf16 v[24:39], v[64:67], v[116:119], v[24:39]
    s_add_u32 s61, s22, 12288
    buffer_load_dwordx4 v[164:167], v1, s[4:7], s61 offen offset:1024 sc1
    v_add_f32 v88, v88, v97
    v_add_f32 v89, v89, v98
    v_add_f32 v90, v90, v99
    v_add_f32 v91, v91, v100
    ds_read_b128 v[64:67], v6 offset:3072
    s_waitcnt lgkmcnt(3)
    v_mfma_f32_32x32x16_bf16 v[40:55], v[116:119], v[68:71], v[40:55]
    v_add_f32 v92, v92, v101
    v_add_f32 v93, v93, v102
    v_add_f32 v94, v94, v103
    v_add_f32 v95, v95, v104
    ds_read_b128 v[68:71], v7 offset:3072
    s_waitcnt vmcnt(11) lgkmcnt(3)
    v_mfma_f32_32x32x16_bf16 v[24:39], v[56:59], v[120:123], v[24:39]
    s_add_u32 s61, s22, 12288
    buffer_load_dwordx4 v[168:171], v1, s[4:7], s61 offen offset:2048 sc1
    v_add_f32 v96, v96, v105
    v_add_f32 v88, v88, v89
    v_add_f32 v90, v90, v91
    v_add_f32 v92, v92, v93
    ds_read_b128 v[56:59], v6 offset:4096
    s_waitcnt lgkmcnt(3)
    v_mfma_f32_32x32x16_bf16 v[40:55], v[120:123], v[60:63], v[40:55]
    v_add_f32 v94, v94, v95
    v_add_f32 v88, v88, v90
    v_add_f32 v92, v92, v94
    v_add_f32 v88, v88, v92
    ds_read_b128 v[60:63], v7 offset:4096
    s_waitcnt vmcnt(11) lgkmcnt(3)
    v_mfma_f32_32x32x16_bf16 v[24:39], v[64:67], v[124:127], v[24:39]
    s_add_u32 s61, s22, 12288
    buffer_load_dwordx4 v[172:175], v1, s[4:7], s61 offen offset:3072 sc1
    v_add_f32 v88, v88, v96
    v_mov_b32 v89, v88
    s_nop 1
    v_permlane32_swap_b32 v88, v89
    ds_read_b128 v[64:67], v6 offset:5120
    s_waitcnt lgkmcnt(3)
    v_mfma_f32_32x32x16_bf16 v[40:55], v[124:127], v[68:71], v[40:55]
    s_nop 1
    v_mul_f32 v88, 0x3ae38e39, v88
    v_mul_f32 v89, 0x3ae38e39, v89
    v_fma_f32 v89, -v88, v88, v89
    ds_read_b128 v[68:71], v7 offset:5120
    s_waitcnt vmcnt(11) lgkmcnt(3)
    v_mfma_f32_32x32x16_bf16 v[24:39], v[56:59], v[128:131], v[24:39]
    s_add_u32 s61, s22, 16384
    buffer_load_dwordx4 v[176:179], v1, s[4:7], s61 offen offset:0 sc1
    v_max_f32 v89, 0, v89
    v_cvt_pk_bf16_f32 v104, -v88, -v88
    v_mov_b32 v105, 0
    v_cvt_pk_bf16_f32 v89, v89, v89
    ds_read_b128 v[56:59], v6 offset:6144
    s_waitcnt lgkmcnt(3)
    v_mfma_f32_32x32x16_bf16 v[40:55], v[128:131], v[60:63], v[40:55]
    v_lshlrev_b32 v89, 16, v89
    v_add_f32 v89, 0x3727c5ac, v89
    v_cvt_pk_bf16_f32 v89, v89, v89
    v_lshlrev_b32 v89, 16, v89
    ds_read_b128 v[60:63], v7 offset:6144
    s_waitcnt vmcnt(11) lgkmcnt(3)
    v_mfma_f32_32x32x16_bf16 v[24:39], v[64:67], v[132:135], v[24:39]
    s_add_u32 s61, s22, 16384
    buffer_load_dwordx4 v[180:183], v1, s[4:7], s61 offen offset:1024 sc1
    v_sqrt_f32 v89, v89
    s_nop 0
    v_cvt_pk_bf16_f32 v89, v89, v89
    v_lshlrev_b32 v89, 16, v89
    ds_read_b128 v[64:67], v6 offset:7168
    s_waitcnt lgkmcnt(3)
    v_mfma_f32_32x32x16_bf16 v[40:55], v[132:135], v[68:71], v[40:55]
    v_rcp_f32 v12, v89
    s_nop 0
    s_waitcnt lgkmcnt(0)
    v_lshl_add_u32 v4, v2, 2, s27
    ds_read_b128 v[68:71], v7 offset:7168
    s_waitcnt vmcnt(11) lgkmcnt(3)
    v_mfma_f32_32x32x16_bf16 v[24:39], v[56:59], v[136:139], v[24:39]
    s_add_u32 s61, s22, 16384
    buffer_load_dwordx4 v[184:187], v1, s[4:7], s61 offen offset:2048 sc1
    ds_write_b32 v4, v12
    v_lshl_add_u32 v4, v3, 4, s27
    s_waitcnt lgkmcnt(0)
    ds_read_b128 v[88:91], v4 offset:0
    v_mov_b32 v15, s50
    ds_write_b32 v15, v14
    ds_read_b128 v[56:59], v6 offset:8192
    s_waitcnt lgkmcnt(3)
    v_mfma_f32_32x32x16_bf16 v[40:55], v[136:139], v[60:63], v[40:55]
    ds_read_b128 v[92:95], v4 offset:32
    ds_read_b128 v[96:99], v4 offset:64
    ds_read_b128 v[100:103], v4 offset:96
    v_mul_u32_u24 v4, 304, v3
    ds_read_b128 v[60:63], v7 offset:8192
    s_waitcnt vmcnt(11) lgkmcnt(3)
    v_mfma_f32_32x32x16_bf16 v[24:39], v[64:67], v[140:143], v[24:39]
    s_add_u32 s61, s22, 16384
    buffer_load_dwordx4 v[188:191], v1, s[4:7], s61 offen offset:3072 sc1
    v_lshl_add_u32 v4, v2, 4, v4
    v_add_u32 v5, s28, v4
    v_cmp_ge_u32 vcc, 18, v2
    v_mov_b32 v11, 0x40000000
    ds_read_b128 v[64:67], v6 offset:9216
    s_waitcnt lgkmcnt(3)
    v_mfma_f32_32x32x16_bf16 v[40:55], v[140:143], v[68:71], v[40:55]
    v_lshrrev_b32 v13, 1, v2
    v_cndmask_b32 v4, v11, v4, vcc
    v_mov_b32 v11, 0x40000
    v_cndmask_b32 v5, v11, v5, vcc
    ds_read_b128 v[68:71], v7 offset:9216
    s_waitcnt vmcnt(11) lgkmcnt(3)
    v_mfma_f32_32x32x16_bf16 v[24:39], v[56:59], v[144:147], v[24:39]
    s_add_u32 s61, s22, 20480
    buffer_load_dwordx4 v[192:195], v1, s[4:7], s61 offen offset:0 sc1
    v_cmp_eq_u32 vcc, 12, v13
    v_cmp_eq_u32 s[62:63], 13, v13
    s_add_u32 s24, s27, 128
    s_add_u32 s25, s28, 1024
    ds_read_b128 v[56:59], v6 offset:10240
    s_waitcnt lgkmcnt(3)
    v_mfma_f32_32x32x16_bf16 v[40:55], v[144:147], v[60:63], v[40:55]
    v_mov_b32 v13, s24
    v_cndmask_b32 v11, v11, v13, vcc
    v_mov_b32 v13, s25
    v_cndmask_b32 v11, v11, v13, s[62:63]
    ds_read_b128 v[60:63], v7 offset:10240
    s_waitcnt vmcnt(11) lgkmcnt(3)
    v_mfma_f32_32x32x16_bf16 v[24:39], v[64:67], v[148:151], v[24:39]
    s_add_u32 s61, s22, 20480
    buffer_load_dwordx4 v[196:199], v1, s[4:7], s61 offen offset:1024 sc1
    v_and_b32 v13, 1, v2
    v_lshl_add_u32 v11, v13, 1, v11
    v_lshl_add_u32 v11, v3, 4, v11
    v_mov_b32 v13, 0x3eae1a93
    ds_read_b128 v[64:67], v6 offset:11264
    s_waitcnt lgkmcnt(3)
    v_mfma_f32_32x32x16_bf16 v[40:55], v[148:151], v[68:71], v[40:55]
    v_cndmask_b32 v13, 1.0, v13, vcc
    s_waitcnt lgkmcnt(0)
    v_mul_f32 v88, v13, v88
    v_mul_f32 v89, v13, v89
    ds_read_b128 v[68:71], v7 offset:11264
    s_waitcnt vmcnt(11) lgkmcnt(3)
    v_mfma_f32_32x32x16_bf16 v[24:39], v[56:59], v[152:155], v[24:39]
    s_add_u32 s61, s22, 20480
    buffer_load_dwordx4 v[200:203], v1, s[4:7], s61 offen offset:2048 sc1
    v_mul_f32 v90, v13, v90
    v_mul_f32 v91, v13, v91
    v_mul_f32 v92, v13, v92
    v_mul_f32 v93, v13, v93
    ds_read_b128 v[56:59], v6 offset:12288
    s_waitcnt lgkmcnt(3)
    v_mfma_f32_32x32x16_bf16 v[40:55], v[152:155], v[60:63], v[40:55]
    v_mul_f32 v94, v13, v94
    v_mul_f32 v95, v13, v95
    v_mul_f32 v96, v13, v96
    v_mul_f32 v97, v13, v97
    ds_read_b128 v[60:63], v7 offset:12288
    s_waitcnt vmcnt(11) lgkmcnt(3)
    v_mfma_f32_32x32x16_bf16 v[24:39], v[64:67], v[156:159], v[24:39]
    s_add_u32 s61, s22, 20480
    buffer_load_dwordx4 v[204:207], v1, s[4:7], s61 offen offset:3072 sc1
    v_mul_f32 v98, v13, v98
    v_mul_f32 v99, v13, v99
    v_mul_f32 v100, v13, v100
    v_mul_f32 v101, v13, v101
    ds_read_b128 v[64:67], v6 offset:13312
    s_waitcnt lgkmcnt(3)
    v_mfma_f32_32x32x16_bf16 v[40:55], v[156:159], v[68:71], v[40:55]
    v_mul_f32 v102, v13, v102
    v_mul_f32 v103, v13, v103
    v_mul_f32 v13, 0x3eae1a93, v12
    v_mfma_f32_32x32x8_bf16 v[24:39], v[106:107], v[104:105], v[24:39]
    ds_read_b128 v[68:71], v7 offset:13312
    s_waitcnt vmcnt(11) lgkmcnt(3)
    v_mfma_f32_32x32x16_bf16 v[24:39], v[56:59], v[160:163], v[24:39]
    s_add_u32 s61, s22, 24576
    buffer_load_dwordx4 v[208:211], v1, s[4:7], s61 offen offset:0 sc1
    v_mfma_f32_32x32x8_bf16 v[40:55], v[104:105], v[108:109], v[40:55]
    ds_read_b128 v[56:59], v6 offset:14336
    s_waitcnt lgkmcnt(3)
    v_mfma_f32_32x32x16_bf16 v[40:55], v[160:163], v[60:63], v[40:55]
    ds_read_b128 v[60:63], v7 offset:14336
    s_waitcnt vmcnt(11) lgkmcnt(3)
    v_mfma_f32_32x32x16_bf16 v[24:39], v[64:67], v[164:167], v[24:39]
    s_add_u32 s61, s22, 24576
    buffer_load_dwordx4 v[212:215], v1, s[4:7], s61 offen offset:1024 sc1
    ds_read_b128 v[64:67], v6 offset:15360
    s_waitcnt lgkmcnt(3)
    v_mfma_f32_32x32x16_bf16 v[40:55], v[164:167], v[68:71], v[40:55]
    ds_read_b128 v[68:71], v7 offset:15360
    s_waitcnt vmcnt(11) lgkmcnt(3)
    v_mfma_f32_32x32x16_bf16 v[24:39], v[56:59], v[168:171], v[24:39]
    s_add_u32 s61, s22, 24576
    buffer_load_dwordx4 v[216:219], v1, s[4:7], s61 offen offset:2048 sc1
    ds_read_b128 v[56:59], v6 offset:16384
    s_waitcnt lgkmcnt(3)
    v_mfma_f32_32x32x16_bf16 v[40:55], v[168:171], v[60:63], v[40:55]
    ds_read_b128 v[60:63], v7 offset:16384
    s_waitcnt vmcnt(11) lgkmcnt(3)
    v_mfma_f32_32x32x16_bf16 v[24:39], v[64:67], v[172:175], v[24:39]
    s_add_u32 s61, s22, 24576
    buffer_load_dwordx4 v[220:223], v1, s[4:7], s61 offen offset:3072 sc1
    ds_read_b128 v[64:67], v6 offset:17408
    s_waitcnt lgkmcnt(3)
    v_mfma_f32_32x32x16_bf16 v[40:55], v[172:175], v[68:71], v[40:55]
    ds_read_b128 v[68:71], v7 offset:17408
    s_waitcnt vmcnt(11) lgkmcnt(3)
    v_mfma_f32_32x32x16_bf16 v[24:39], v[56:59], v[176:179], v[24:39]
    s_add_u32 s61, s22, 28672
    buffer_load_dwordx4 v[224:227], v1, s[4:7], s61 offen offset:0 sc1
    ds_read_b128 v[56:59], v6 offset:18432
    s_waitcnt lgkmcnt(3)
    v_mfma_f32_32x32x16_bf16 v[40:55], v[176:179], v[60:63], v[40:55]
    ds_read_b128 v[60:63], v7 offset:18432
    s_waitcnt vmcnt(11) lgkmcnt(3)
    v_mfma_f32_32x32x16_bf16 v[24:39], v[64:67], v[180:183], v[24:39]
    s_add_u32 s61, s22, 28672
    buffer_load_dwordx4 v[228:231], v1, s[4:7], s61 offen offset:1024 sc1
    ds_read_b128 v[64:67], v6 offset:19456
    s_waitcnt lgkmcnt(3)
    v_mfma_f32_32x32x16_bf16 v[40:55], v[180:183], v[68:71], v[40:55]
    ds_read_b128 v[68:71], v7 offset:19456
    s_waitcnt vmcnt(11) lgkmcnt(3)
    v_mfma_f32_32x32x16_bf16 v[24:39], v[56:59], v[184:187], v[24:39]
    s_add_u32 s61, s22, 28672
    buffer_load_dwordx4 v[232:235], v1, s[4:7], s61 offen offset:2048 sc1
    ds_read_b128 v[56:59], v6 offset:20480
    s_waitcnt lgkmcnt(3)
    v_mfma_f32_32x32x16_bf16 v[40:55], v[184:187], v[60:63], v[40:55]
    ds_read_b128 v[60:63], v7 offset:20480
    s_waitcnt vmcnt(11) lgkmcnt(3)
    v_mfma_f32_32x32x16_bf16 v[24:39], v[64:67], v[188:191], v[24:39]
    s_add_u32 s61, s22, 28672
    buffer_load_dwordx4 v[236:239], v1, s[4:7], s61 offen offset:3072 sc1
    ds_read_b128 v[64:67], v6 offset:21504
    s_waitcnt lgkmcnt(3)
    v_mfma_f32_32x32x16_bf16 v[40:55], v[188:191], v[68:71], v[40:55]
    ds_read_b128 v[68:71], v7 offset:21504
    s_waitcnt vmcnt(11) lgkmcnt(3)
    v_mfma_f32_32x32x16_bf16 v[24:39], v[56:59], v[192:195], v[24:39]
    s_add_u32 s61, s22, 32768
    buffer_load_dwordx4 v[240:243], v1, s[4:7], s61 offen offset:0 sc1
    ds_read_b128 v[56:59], v6 offset:22528
    s_waitcnt lgkmcnt(3)
    v_mfma_f32_32x32x16_bf16 v[40:55], v[192:195], v[60:63], v[40:55]
    ds_read_b128 v[60:63], v7 offset:22528
    s_waitcnt vmcnt(11) lgkmcnt(3)
    v_mfma_f32_32x32x16_bf16 v[24:39], v[64:67], v[196:199], v[24:39]
    s_add_u32 s61, s22, 32768
    buffer_load_dwordx4 v[244:247], v1, s[4:7], s61 offen offset:1024 sc1
    ds_read_b128 v[64:67], v6 offset:23552
    s_waitcnt lgkmcnt(3)
    v_mfma_f32_32x32x16_bf16 v[40:55], v[196:199], v[68:71], v[40:55]
    ds_read_b128 v[68:71], v7 offset:23552
    s_waitcnt vmcnt(11) lgkmcnt(3)
    v_mfma_f32_32x32x16_bf16 v[24:39], v[56:59], v[200:203], v[24:39]
    s_add_u32 s61, s22, 32768
    buffer_load_dwordx4 v[248:251], v1, s[4:7], s61 offen offset:2048 sc1
    ds_read_b128 v[56:59], v6 offset:24576
    s_waitcnt lgkmcnt(3)
    v_mfma_f32_32x32x16_bf16 v[40:55], v[200:203], v[60:63], v[40:55]
    ds_read_b128 v[60:63], v7 offset:24576
    s_waitcnt vmcnt(11) lgkmcnt(3)
    v_mfma_f32_32x32x16_bf16 v[24:39], v[64:67], v[204:207], v[24:39]
    s_add_u32 s61, s22, 32768
    buffer_load_dwordx4 v[252:255], v1, s[4:7], s61 offen offset:3072 sc1
    ds_read_b128 v[64:67], v6 offset:25600
    s_waitcnt lgkmcnt(3)
    v_mfma_f32_32x32x16_bf16 v[40:55], v[204:207], v[68:71], v[40:55]
    ds_read_b128 v[68:71], v7 offset:25600
    s_waitcnt vmcnt(11) lgkmcnt(3)
    v_mfma_f32_32x32x16_bf16 v[24:39], v[56:59], v[208:211], v[24:39]
    ds_read_b128 v[56:59], v6 offset:26624
    s_waitcnt lgkmcnt(3)
    v_mfma_f32_32x32x16_bf16 v[40:55], v[208:211], v[60:63], v[40:55]
    ds_read_b128 v[60:63], v7 offset:26624
    s_waitcnt vmcnt(10) lgkmcnt(3)
    v_mfma_f32_32x32x16_bf16 v[24:39], v[64:67], v[212:215], v[24:39]
    ds_read_b128 v[64:67], v6 offset:27648
    s_waitcnt lgkmcnt(3)
    v_mfma_f32_32x32x16_bf16 v[40:55], v[212:215], v[68:71], v[40:55]
    ds_read_b128 v[68:71], v7 offset:27648
    s_waitcnt vmcnt(9) lgkmcnt(3)
    v_mfma_f32_32x32x16_bf16 v[24:39], v[56:59], v[216:219], v[24:39]
    ds_read_b128 v[56:59], v6 offset:28672
    s_waitcnt lgkmcnt(3)
    v_mfma_f32_32x32x16_bf16 v[40:55], v[216:219], v[60:63], v[40:55]
    ds_read_b128 v[60:63], v7 offset:28672
    s_waitcnt vmcnt(8) lgkmcnt(3)
    v_mfma_f32_32x32x16_bf16 v[24:39], v[64:67], v[220:223], v[24:39]
    ds_read_b128 v[64:67], v6 offset:29696
    s_waitcnt lgkmcnt(3)
    v_mfma_f32_32x32x16_bf16 v[40:55], v[220:223], v[68:71], v[40:55]
    ds_read_b128 v[68:71], v7 offset:29696
    s_waitcnt vmcnt(7) lgkmcnt(3)
    v_mfma_f32_32x32x16_bf16 v[24:39], v[56:59], v[224:227], v[24:39]
    ds_read_b128 v[56:59], v6 offset:30720
    s_waitcnt lgkmcnt(3)
    v_mfma_f32_32x32x16_bf16 v[40:55], v[224:227], v[60:63], v[40:55]
    ds_read_b128 v[60:63], v7 offset:30720
    s_waitcnt vmcnt(6) lgkmcnt(3)
    v_mfma_f32_32x32x16_bf16 v[24:39], v[64:67], v[228:231], v[24:39]
    ds_read_b128 v[64:67], v6 offset:31744
    s_waitcnt lgkmcnt(3)
    v_mfma_f32_32x32x16_bf16 v[40:55], v[228:231], v[68:71], v[40:55]
    ds_read_b128 v[68:71], v7 offset:31744
    s_waitcnt vmcnt(5) lgkmcnt(3)
    v_mfma_f32_32x32x16_bf16 v[24:39], v[56:59], v[232:235], v[24:39]
    ds_read_b128 v[56:59], v6 offset:32768
    s_waitcnt lgkmcnt(3)
    v_mfma_f32_32x32x16_bf16 v[40:55], v[232:235], v[60:63], v[40:55]
    ds_read_b128 v[60:63], v7 offset:32768
    s_waitcnt vmcnt(4) lgkmcnt(3)
    v_mfma_f32_32x32x16_bf16 v[24:39], v[64:67], v[236:239], v[24:39]
    ds_read_b128 v[64:67], v6 offset:33792
    s_waitcnt lgkmcnt(3)
    v_mfma_f32_32x32x16_bf16 v[40:55], v[236:239], v[68:71], v[40:55]
    ds_read_b128 v[68:71], v7 offset:33792
    s_waitcnt vmcnt(3) lgkmcnt(3)
    v_mfma_f32_32x32x16_bf16 v[24:39], v[56:59], v[240:243], v[24:39]
    ds_read_b128 v[56:59], v6 offset:34816
    s_waitcnt lgkmcnt(3)
    v_mfma_f32_32x32x16_bf16 v[40:55], v[240:243], v[60:63], v[40:55]
    ds_read_b128 v[60:63], v7 offset:34816
    s_waitcnt vmcnt(2) lgkmcnt(3)
    v_mfma_f32_32x32x16_bf16 v[24:39], v[64:67], v[244:247], v[24:39]
    ds_read_b128 v[64:67], v6 offset:35840
    s_waitcnt lgkmcnt(3)
    v_mfma_f32_32x32x16_bf16 v[40:55], v[244:247], v[68:71], v[40:55]
    ds_read_b128 v[68:71], v7 offset:35840
    s_waitcnt vmcnt(1) lgkmcnt(3)
    v_mfma_f32_32x32x16_bf16 v[24:39], v[56:59], v[248:251], v[24:39]
    s_waitcnt lgkmcnt(2)
    v_mfma_f32_32x32x16_bf16 v[40:55], v[248:251], v[60:63], v[40:55]
    s_waitcnt vmcnt(0) lgkmcnt(1)
    v_mfma_f32_32x32x16_bf16 v[24:39], v[64:67], v[252:255], v[24:39]
    s_waitcnt lgkmcnt(0)
    v_mfma_f32_32x32x16_bf16 v[40:55], v[252:255], v[68:71], v[40:55]
    v_add_u32 v6, s28, v1
    v_lshlrev_b32 v7, 30, v3
    v_lshl_add_u32 v7, v2, 2, v7
    v_lshl_add_u32 v56, v2, 2, s24
    v_lshl_add_u32 v57, v2, 2, s25
    s_and_b32 s24, s3, 4
    s_add_u32 s24, s24, 162832
    v_mov_b32 v58, s24
    v_mov_b32 v59, 1
    s_mov_b32 s24, 0x40000
    s_mov_b32 s25, 0x40000
    s_nop 0
    v_mul_f32 v32, v12, v32
    v_mul_f32 v33, v12, v33
    v_mul_f32 v34, v12, v34
    v_mul_f32 v35, v12, v35
    v_mul_f32 v36, v12, v36
    v_mul_f32 v37, v12, v37
    v_mul_f32 v38, v12, v38
    v_mul_f32 v39, v12, v39
    v_cvt_pk_bf16_f32 v60, v32, v33
    v_cvt_pk_bf16_f32 v61, v34, v35
    v_cvt_pk_bf16_f32 v62, v36, v37
    v_cvt_pk_bf16_f32 v63, v38, v39
    ds_write_b128 v6, v[60:63]
    buffer_store_dwordx4 v[60:63], v1, s[16:19], s29 offen sc1
    v_mul_f32 v40, v88, v40
    v_mul_f32 v41, v89, v41
    v_cvt_pk_bf16_f32 v40, v40, v41
    v_mul_f32 v42, v90, v42
    v_mul_f32 v43, v91, v43
    v_cvt_pk_bf16_f32 v41, v42, v43
    v_mul_f32 v44, v92, v44
    v_mul_f32 v45, v93, v45
    v_cvt_pk_bf16_f32 v42, v44, v45
    v_mul_f32 v46, v94, v46
    v_mul_f32 v47, v95, v47
    v_cvt_pk_bf16_f32 v43, v46, v47
    v_mul_f32 v48, v96, v48
    v_mul_f32 v49, v97, v49
    v_cvt_pk_bf16_f32 v44, v48, v49
    v_mul_f32 v50, v98, v50
    v_mul_f32 v51, v99, v51
    v_cvt_pk_bf16_f32 v45, v50, v51
    v_mul_f32 v52, v100, v52
    v_mul_f32 v53, v101, v53
    v_cvt_pk_bf16_f32 v46, v52, v53
    v_mul_f32 v54, v102, v54
    v_mul_f32 v55, v103, v55
    v_cvt_pk_bf16_f32 v47, v54, v55
    ds_write_b16 v11, v40 offset:0
    ds_write_b16_d16_hi v11, v40 offset:4
    ds_write_b16 v11, v41 offset:8
    ds_write_b16_d16_hi v11, v41 offset:12
    ds_write_b16 v11, v42 offset:32
    ds_write_b16_d16_hi v11, v42 offset:36
    ds_write_b16 v11, v43 offset:40
    ds_write_b16_d16_hi v11, v43 offset:44
    ds_write_b16 v11, v44 offset:64
    ds_write_b16_d16_hi v11, v44 offset:68
    ds_write_b16 v11, v45 offset:72
    ds_write_b16_d16_hi v11, v45 offset:76
    ds_write_b16 v11, v46 offset:96
    ds_write_b16_d16_hi v11, v46 offset:100
    ds_write_b16 v11, v47 offset:104
    ds_write_b16_d16_hi v11, v47 offset:108
    s_mov_b64 exec, s[24:25]
    v_mov_b32 v40, s60
    v_mov_b32 v41, s60
    v_mov_b32 v42, s60
    v_mov_b32 v43, s60
    v_mov_b32 v44, s60
    v_mov_b32 v45, s60
    v_mov_b32 v46, s60
    v_mov_b32 v47, s60
    s_mov_b64 exec, -1
    ds_read_b32 v64, v57
    ds_read_b32 v65, v56
    ds_write_b128 v5, v[40:43] offset:1152
    ds_write_b128 v5, v[44:47] offset:1760
    buffer_store_dwordx4 v[40:43], v4, s[16:19], s29 offen offset:1152 sc1
    buffer_store_dwordx4 v[44:47], v4, s[16:19], s29 offen offset:1760 sc1
    v_mul_f32 v24, v13, v24
    v_mul_f32 v25, v13, v25
    v_mul_f32 v26, v13, v26
    v_mul_f32 v27, v13, v27
    v_mul_f32 v28, v13, v28
    v_mul_f32 v29, v13, v29
    v_mul_f32 v30, v13, v30
    v_mul_f32 v31, v13, v31
    v_cvt_pk_bf16_f32 v24, v24, v25
    v_cvt_pk_bf16_f32 v25, v26, v27
    v_cvt_pk_bf16_f32 v26, v28, v29
    v_cvt_pk_bf16_f32 v27, v30, v31
    v_cmp_eq_u32 vcc, 0, v3
    v_mov_b32 v29, 0
    v_mov_b32 v89, 0
    v_mov_b32 v11, 0xf149f2ca
    s_waitcnt lgkmcnt(0)
    buffer_store_dword v64, v7, s[16:19], s29 offen offset:1024 sc1
    v_lshlrev_b32 v66, 3, v1
    v_mov_b32 v109, v14
    s_sub_u32 s22, s49, 1024
    s_mov_b64 exec, 15
    buffer_load_dword v109, v66, s[16:19], s22 offen sc1
    s_mov_b32 s36, 0
    s_mov_b64 exec, 1
    ds_add_u32 v58, v59
    s_mov_b64 exec, -1
    v_cndmask_b32 v28, 0, v65, vcc
    v_mov_b32 v88, v64
    v_mfma_f32_32x32x16_bf16 v[36:51], v[60:63], v[24:27], v[72:87]
    s_nop 0
    v_mfma_f32_32x32x8_bf16 v[36:51], v[88:89], v[28:29], v[36:51]
    s_cmp_eq_u32 s12, 0
    s_cbranch_scc1 L_B_pub
    s_cmp_ge_u32 s3, 4
    s_cbranch_scc1 L_B_L
L_B_pub:
    s_waitcnt vmcnt(0)
    s_mov_b64 exec, 1
    buffer_store_dword v14, off, s[16:19], s49 sc1
    s_mov_b64 exec, -1
    s_cmp_eq_u32 s12, 0
    s_cbranch_scc1 L_B_L0
    s_setprio 0
    s_cmp_ge_u32 s48, 5
    s_mov_b32 s22, 7104
    s_cselect_b32 s22, 16576, s22
    v_add_u32 v100, s22, v8
    v_add_u32 v101, s22, v9
    v_add_u32 v102, s22, v10
    s_cmp_ge_u32 s48, 6
    s_mov_b32 s22, 4736
    s_cselect_b32 s22, 14208, s22
    v_add_u32 v103, s22, v8
    v_add_u32 v104, s22, v9
    v_add_u32 v105, s22, v10
    s_cmp_ge_u32 s48, 7
    s_mov_b32 s22, 2368
    s_cselect_b32 s22, 11840, s22
    v_add_u32 v106, s22, v8
    v_add_u32 v107, s22, v9
    v_add_u32 v108, s22, v10
    s_cmp_eq_u32 s3, 0
    s_cbranch_scc0 L_B_E1
    s_mov_b32 s50, 2
    s_call_b64 s[30:31], L_B_fetch
    s_call_b64 s[30:31], L_B_fetched
L_B_E1:
    s_mov_b32 s50, 162832
    s_mov_b32 s51, 4
    s_call_b64 s[30:31], L_B_wait
    ds_read_b128 v[84:87], v100 offset:0
    ds_read_b32 v88, v101 offset:1024
    ds_read_b128 v[92:95], v10 offset:18944
    s_cmp_eq_u32 s48, 5
    s_cbranch_scc0 Lw_71
    s_mov_b32 s50, 162840
    s_mov_b32 s51, 1
    s_call_b64 s[30:31], L_B_wait
Lw_71:
    v_exp_f32 v36, v36
    v_exp_f32 v37, v37
    ds_read_b128 v[96:99], v10 offset:19552
    v_exp_f32 v38, v38
    v_exp_f32 v39, v39
    v_exp_f32 v40, v40
    v_cvt_pk_bf16_f32 v36, v36, v37
    s_waitcnt lgkmcnt(2)
    v_mfma_f32_32x32x16_bf16 v[52:67], v[84:87], v[24:27], 0
    ds_read_b128 v[84:87], v103 offset:0
    v_exp_f32 v41, v41
    v_exp_f32 v42, v42
    v_exp_f32 v43, v43
    v_cvt_pk_bf16_f32 v37, v38, v39
    v_cvt_pk_bf16_f32 v38, v40, v41
    v_mfma_f32_32x32x8_bf16 v[52:67], v[88:89], v[28:29], v[52:67]
    ds_read_b32 v88, v104 offset:1024
    s_add_u32 s61, s41, 0
    buffer_load_dwordx4 v[112:115], v1, s[4:7], s61 offen offset:0
    buffer_load_dwordx4 v[116:119], v1, s[4:7], s61 offen offset:1024
    buffer_load_dwordx4 v[120:123], v1, s[4:7], s61 offen offset:2048
    v_cvt_pk_bf16_f32 v39, v42, v43
    v_exp_f32 v44, v44
    v_exp_f32 v45, v45
    v_exp_f32 v46, v46
    v_exp_f32 v47, v47
    v_cvt_pk_bf16_f32 v44, v44, v45
    s_waitcnt lgkmcnt(2)
    v_mfma_f32_32x32x16_bf16 v[68:83], v[92:95], v[36:39], 0
    ds_read_b128 v[92:95], v102 offset:0
    v_exp_f32 v48, v48
    v_exp_f32 v49, v49
    v_exp_f32 v50, v50
    v_exp_f32 v51, v51
    v_cvt_pk_bf16_f32 v45, v46, v47
    v_cvt_pk_bf16_f32 v46, v48, v49
    v_cvt_pk_bf16_f32 v47, v50, v51
    s_cmp_eq_u32 s48, 6
    s_cbranch_scc0 Lw_72
    s_mov_b32 s50, 162840
    s_mov_b32 s51, 1
    s_call_b64 s[30:31], L_B_wait
Lw_72:
    v_exp_f32 v52, v52
    v_exp_f32 v53, v53
    s_waitcnt lgkmcnt(2)
    v_mfma_f32_32x32x16_bf16 v[68:83], v[96:99], v[44:47], v[68:83]
    ds_read_b128 v[96:99], v102 offset:608
    v_exp_f32 v54, v54
    v_exp_f32 v55, v55
    v_exp_f32 v56, v56
    v_cvt_pk_bf16_f32 v52, v52, v53
    s_waitcnt lgkmcnt(2)
    v_mfma_f32_32x32x16_bf16 v[36:51], v[84:87], v[24:27], 0
    ds_read_b128 v[84:87], v106 offset:0
    v_exp_f32 v57, v57
    v_exp_f32 v58, v58
    v_exp_f32 v59, v59
    v_cvt_pk_bf16_f32 v53, v54, v55
    v_cvt_pk_bf16_f32 v54, v56, v57
    v_mfma_f32_32x32x8_bf16 v[36:51], v[88:89], v[28:29], v[36:51]
    ds_read_b32 v88, v107 offset:1024
    s_add_u32 s61, s41, 0
    buffer_load_dwordx4 v[124:127], v1, s[4:7], s61 offen offset:3072
    s_add_u32 s61, s41, 4096
    buffer_load_dwordx4 v[128:131], v1, s[4:7], s61 offen offset:0
    buffer_load_dwordx4 v[132:135], v1, s[4:7], s61 offen offset:1024
    v_cvt_pk_bf16_f32 v55, v58, v59
    v_exp_f32 v60, v60
    v_exp_f32 v61, v61
    v_exp_f32 v62, v62
    v_exp_f32 v63, v63
    v_cvt_pk_bf16_f32 v60, v60, v61
    s_waitcnt lgkmcnt(2)
    v_mfma_f32_32x32x16_bf16 v[68:83], v[92:95], v[52:55], v[68:83]
    ds_read_b128 v[92:95], v105 offset:0
    v_exp_f32 v64, v64
    v_exp_f32 v65, v65
    v_exp_f32 v66, v66
    v_exp_f32 v67, v67
    v_cvt_pk_bf16_f32 v61, v62, v63
    v_cvt_pk_bf16_f32 v62, v64, v65
    v_cvt_pk_bf16_f32 v63, v66, v67
    s_cmp_eq_u32 s48, 7
    s_cbranch_scc0 Lw_73
    s_mov_b32 s50, 162840
    s_mov_b32 s51, 1
    s_call_b64 s[30:31], L_B_wait
Lw_73:
    v_exp_f32 v36, v36
    v_exp_f32 v37, v37
    s_waitcnt lgkmcnt(2)
    v_mfma_f32_32x32x16_bf16 v[68:83], v[96:99], v[60:63], v[68:83]
    ds_read_b128 v[96:99], v105 offset:608
    v_exp_f32 v38, v38
    v_exp_f32 v39, v39
    v_exp_f32 v40, v40
    v_cvt_pk_bf16_f32 v36, v36, v37
    s_waitcnt lgkmcnt(2)
    v_mfma_f32_32x32x16_bf16 v[52:67], v[84:87], v[24:27], 0
    ds_read_b128 v[84:87], v8 offset:0
    v_exp_f32 v41, v41
    v_exp_f32 v42, v42
    v_exp_f32 v43, v43
    v_cvt_pk_bf16_f32 v37, v38, v39
    v_cvt_pk_bf16_f32 v38, v40, v41
    v_mfma_f32_32x32x8_bf16 v[52:67], v[88:89], v[28:29], v[52:67]
    ds_read_b32 v88, v9 offset:1024
    s_add_u32 s61, s41, 4096
    buffer_load_dwordx4 v[136:139], v1, s[4:7], s61 offen offset:2048
    buffer_load_dwordx4 v[140:143], v1, s[4:7], s61 offen offset:3072
    s_add_u32 s61, s41, 8192
    buffer_load_dwordx4 v[144:147], v1, s[4:7], s61 offen offset:0
    v_cvt_pk_bf16_f32 v39, v42, v43
    v_exp_f32 v44, v44
    v_exp_f32 v45, v45
    v_exp_f32 v46, v46
    v_exp_f32 v47, v47
    v_cvt_pk_bf16_f32 v44, v44, v45
    s_waitcnt lgkmcnt(2)
    v_mfma_f32_32x32x16_bf16 v[68:83], v[92:95], v[36:39], v[68:83]
    ds_read_b128 v[92:95], v108 offset:0
    v_exp_f32 v48, v48
    v_exp_f32 v49, v49
    v_exp_f32 v50, v50
    v_exp_f32 v51, v51
    v_cvt_pk_bf16_f32 v45, v46, v47
    v_cvt_pk_bf16_f32 v46, v48, v49
    v_cvt_pk_bf16_f32 v47, v50, v51
    v_exp_f32 v52, v52
    v_exp_f32 v53, v53
    s_waitcnt lgkmcnt(2)
    v_mfma_f32_32x32x16_bf16 v[68:83], v[96:99], v[44:47], v[68:83]
    ds_read_b128 v[96:99], v108 offset:608
    v_cndmask_b32 v36, 0, v11, s[64:65]
    v_cndmask_b32 v37, 0, v11, s[66:67]
    v_cndmask_b32 v38, 0, v11, s[68:69]
    v_cndmask_b32 v39, 0, v11, s[70:71]
    v_cndmask_b32 v40, 0, v11, s[72:73]
    v_cndmask_b32 v41, 0, v11, s[74:75]
    v_cndmask_b32 v42, 0, v11, s[76:77]
    v_cndmask_b32 v43, 0, v11, s[78:79]
    v_cndmask_b32 v44, 0, v11, s[80:81]
    v_cndmask_b32 v45, 0, v11, s[82:83]
    v_cndmask_b32 v46, 0, v11, s[84:85]
    v_cndmask_b32 v47, 0, v11, s[86:87]
    v_cndmask_b32 v48, 0, v11, s[88:89]
    v_cndmask_b32 v49, 0, v11, s[90:91]
    v_cndmask_b32 v50, 0, v11, s[92:93]
    v_cndmask_b32 v51, 0, v11, s[94:95]
    v_exp_f32 v54, v54
    v_exp_f32 v55, v55
    v_exp_f32 v56, v56
    v_cvt_pk_bf16_f32 v52, v52, v53
    s_waitcnt lgkmcnt(2)
    v_mfma_f32_32x32x16_bf16 v[36:51], v[84:87], v[24:27], v[36:51]
    v_exp_f32 v57, v57
    v_exp_f32 v58, v58
    v_exp_f32 v59, v59
    v_cvt_pk_bf16_f32 v53, v54, v55
    v_cvt_pk_bf16_f32 v54, v56, v57
    v_mfma_f32_32x32x8_bf16 v[36:51], v[88:89], v[28:29], v[36:51]
    s_add_u32 s61, s41, 8192
    buffer_load_dwordx4 v[148:151], v1, s[4:7], s61 offen offset:1024
    buffer_load_dwordx4 v[152:155], v1, s[4:7], s61 offen offset:2048
    buffer_load_dwordx4 v[156:159], v1, s[4:7], s61 offen offset:3072
    v_cvt_pk_bf16_f32 v55, v58, v59
    v_exp_f32 v60, v60
    v_exp_f32 v61, v61
    v_exp_f32 v62, v62
    v_exp_f32 v63, v63
    v_cvt_pk_bf16_f32 v60, v60, v61
    s_waitcnt lgkmcnt(1)
    v_mfma_f32_32x32x16_bf16 v[68:83], v[92:95], v[52:55], v[68:83]
    ds_read_b128 v[92:95], v10 offset:0
    v_exp_f32 v64, v64
    v_exp_f32 v65, v65
    v_exp_f32 v66, v66
    v_exp_f32 v67, v67
    v_cvt_pk_bf16_f32 v61, v62, v63
    v_cvt_pk_bf16_f32 v62, v64, v65
    v_cvt_pk_bf16_f32 v63, v66, v67
    v_exp_f32 v36, v36
    v_exp_f32 v37, v37
    s_waitcnt lgkmcnt(1)
    v_mfma_f32_32x32x16_bf16 v[68:83], v[96:99], v[60:63], v[68:83]
    ds_read_b128 v[96:99], v10 offset:608
    v_exp_f32 v38, v38
    v_exp_f32 v39, v39
    v_exp_f32 v40, v40
    v_cvt_pk_bf16_f32 v36, v36, v37
    v_exp_f32 v41, v41
    v_exp_f32 v42, v42
    v_exp_f32 v43, v43
    v_cvt_pk_bf16_f32 v37, v38, v39
    v_cvt_pk_bf16_f32 v38, v40, v41
    s_add_u32 s61, s41, 12288
    buffer_load_dwordx4 v[160:163], v1, s[4:7], s61 offen offset:0
    buffer_load_dwordx4 v[164:167], v1, s[4:7], s61 offen offset:1024
    buffer_load_dwordx4 v[168:171], v1, s[4:7], s61 offen offset:2048
    v_cvt_pk_bf16_f32 v39, v42, v43
    v_exp_f32 v44, v44
    v_exp_f32 v45, v45
    v_exp_f32 v46, v46
    v_exp_f32 v47, v47
    v_cvt_pk_bf16_f32 v44, v44, v45
    s_waitcnt lgkmcnt(1)
    v_mfma_f32_32x32x16_bf16 v[68:83], v[92:95], v[36:39], v[68:83]
    v_exp_f32 v48, v48
    v_exp_f32 v49, v49
    v_exp_f32 v50, v50
    v_exp_f32 v51, v51
    v_cvt_pk_bf16_f32 v45, v46, v47
    v_cvt_pk_bf16_f32 v46, v48, v49
    v_cvt_pk_bf16_f32 v47, v50, v51
    s_waitcnt lgkmcnt(0)
    s_nop 0
    v_mfma_f32_32x32x16_bf16 v[68:83], v[96:99], v[44:47], v[68:83]
    s_sub_u32 s22, 8, s48
    s_mul_i32 s22, s22, 2368
    v_add_u32 v100, s22, v8
    v_add_u32 v101, s22, v9
    v_add_u32 v102, s22, v10
    v_mov_b32 v36, 0
    v_mov_b32 v37, 0
    v_mov_b32 v38, 0
    v_mov_b32 v39, 0
    v_mov_b32 v40, 0
    v_mov_b32 v41, 0
    v_mov_b32 v42, 0
    v_mov_b32 v43, 0
    v_mov_b32 v44, 0
    v_mov_b32 v45, 0
    v_mov_b32 v46, 0
    v_mov_b32 v47, 0
    v_mov_b32 v48, 0
    v_mov_b32 v49, 0
    v_mov_b32 v50, 0
    v_mov_b32 v51, 0
    s_mov_b32 s40, 4
    s_mov_b32 s50, 162836
    s_mov_b32 s51, 4
    s_call_b64 s[30:31], L_B_wait
L_B_run2:
    ds_read_b128 v[84:87], v100 offset:0
    ds_read_b32 v88, v101 offset:1024
    s_waitcnt lgkmcnt(0)
    v_mfma_f32_32x32x16_bf16 v[36:51], v[84:87], v[24:27], v[36:51]
    v_mfma_f32_32x32x8_bf16 v[36:51], v[88:89], v[28:29], v[36:51]
    ds_read_b128 v[84:87], v100 offset:2368
    ds_read_b32 v88, v101 offset:3392
    ds_read_b128 v[92:95], v102 offset:0
    s_nop 8
    v_exp_f32 v36, v36
    v_exp_f32 v37, v37
    ds_read_b128 v[96:99], v102 offset:608
    v_exp_f32 v38, v38
    v_exp_f32 v39, v39
    v_exp_f32 v40, v40
    v_cvt_pk_bf16_f32 v36, v36, v37
    s_waitcnt lgkmcnt(2)
    v_mfma_f32_32x32x16_bf16 v[52:67], v[84:87], v[24:27], 0
    ds_read_b128 v[84:87], v100 offset:4736
    v_exp_f32 v41, v41
    v_exp_f32 v42, v42
    v_exp_f32 v43, v43
    v_cvt_pk_bf16_f32 v37, v38, v39
    v_cvt_pk_bf16_f32 v38, v40, v41
    v_mfma_f32_32x32x8_bf16 v[52:67], v[88:89], v[28:29], v[52:67]
    ds_read_b32 v88, v101 offset:5760
    s_cmp_lt_u32 s3, 4
    s_cbranch_scc0 Lg_74
    s_add_u32 s61, s41, 12288
    buffer_load_dwordx4 v[172:175], v1, s[4:7], s61 offen offset:3072
    s_add_u32 s61, s41, 16384
    buffer_load_dwordx4 v[176:179], v1, s[4:7], s61 offen offset:0
    buffer_load_dwordx4 v[180:183], v1, s[4:7], s61 offen offset:1024
    Lg_74:
    v_cvt_pk_bf16_f32 v39, v42, v43
    v_exp_f32 v44, v44
    v_exp_f32 v45, v45
    v_exp_f32 v46, v46
    v_exp_f32 v47, v47
    v_cvt_pk_bf16_f32 v44, v44, v45
    s_waitcnt lgkmcnt(2)
    v_mfma_f32_32x32x16_bf16 v[68:83], v[92:95], v[36:39], v[68:83]
    ds_read_b128 v[92:95], v102 offset:2368
    v_exp_f32 v48, v48
    v_exp_f32 v49, v49
    v_exp_f32 v50, v50
    v_exp_f32 v51, v51
    v_cvt_pk_bf16_f32 v45, v46, v47
    v_cvt_pk_bf16_f32 v46, v48, v49
    v_cvt_pk_bf16_f32 v47, v50, v51
    s_cmp_eq_u32 s40, 1
    s_cbranch_scc1 L_B_t0
    v_exp_f32 v52, v52
    v_exp_f32 v53, v53
    s_waitcnt lgkmcnt(2)
    v_mfma_f32_32x32x16_bf16 v[68:83], v[96:99], v[44:47], v[68:83]
    ds_read_b128 v[96:99], v102 offset:2976
    v_exp_f32 v54, v54
    v_exp_f32 v55, v55
    v_exp_f32 v56, v56
    v_cvt_pk_bf16_f32 v52, v52, v53
    s_waitcnt lgkmcnt(2)
    v_mfma_f32_32x32x16_bf16 v[36:51], v[84:87], v[24:27], 0
    ds_read_b128 v[84:87], v100 offset:7104
    v_exp_f32 v57, v57
    v_exp_f32 v58, v58
    v_exp_f32 v59, v59
    v_cvt_pk_bf16_f32 v53, v54, v55
    v_cvt_pk_bf16_f32 v54, v56, v57
    v_mfma_f32_32x32x8_bf16 v[36:51], v[88:89], v[28:29], v[36:51]
    ds_read_b32 v88, v101 offset:8128
    s_cmp_lt_u32 s3, 4
    s_cbranch_scc0 Lg_75
    s_add_u32 s61, s41, 16384
    buffer_load_dwordx4 v[184:187], v1, s[4:7], s61 offen offset:2048
    buffer_load_dwordx4 v[188:191], v1, s[4:7], s61 offen offset:3072
    s_add_u32 s61, s41, 20480
    buffer_load_dwordx4 v[192:195], v1, s[4:7], s61 offen offset:0
    Lg_75:
    v_cvt_pk_bf16_f32 v55, v58, v59
    v_exp_f32 v60, v60
    v_exp_f32 v61, v61
    v_exp_f32 v62, v62
    v_exp_f32 v63, v63
    v_cvt_pk_bf16_f32 v60, v60, v61
    s_waitcnt lgkmcnt(2)
    v_mfma_f32_32x32x16_bf16 v[68:83], v[92:95], v[52:55], v[68:83]
    ds_read_b128 v[92:95], v102 offset:4736
    v_exp_f32 v64, v64
    v_exp_f32 v65, v65
    v_exp_f32 v66, v66
    v_exp_f32 v67, v67
    v_cvt_pk_bf16_f32 v61, v62, v63
    v_cvt_pk_bf16_f32 v62, v64, v65
    v_cvt_pk_bf16_f32 v63, v66, v67
    s_cmp_eq_u32 s40, 2
    s_cbranch_scc1 L_B_t1
    v_exp_f32 v36, v36
    v_exp_f32 v37, v37
    s_waitcnt lgkmcnt(2)
    v_mfma_f32_32x32x16_bf16 v[68:83], v[96:99], v[60:63], v[68:83]
    ds_read_b128 v[96:99], v102 offset:5344
    v_exp_f32 v38, v38
    v_exp_f32 v39, v39
    v_exp_f32 v40, v40
    v_cvt_pk_bf16_f32 v36, v36, v37
    s_waitcnt lgkmcnt(2)
    v_mfma_f32_32x32x16_bf16 v[52:67], v[84:87], v[24:27], 0
    v_exp_f32 v41, v41
    v_exp_f32 v42, v42
    v_exp_f32 v43, v43
    v_cvt_pk_bf16_f32 v37, v38, v39
    v_cvt_pk_bf16_f32 v38, v40, v41
    v_mfma_f32_32x32x8_bf16 v[52:67], v[88:89], v[28:29], v[52:67]
    s_cmp_lt_u32 s3, 4
    s_cbranch_scc0 Lg_76
    s_add_u32 s61, s41, 20480
    buffer_load_dwordx4 v[196:199], v1, s[4:7], s61 offen offset:1024
    buffer_load_dwordx4 v[200:203], v1, s[4:7], s61 offen offset:2048
    buffer_load_dwordx4 v[204:207], v1, s[4:7], s61 offen offset:3072
    Lg_76:
    v_cvt_pk_bf16_f32 v39, v42, v43
    v_exp_f32 v44, v44
    v_exp_f32 v45, v45
    v_exp_f32 v46, v46
    v_exp_f32 v47, v47
    v_cvt_pk_bf16_f32 v44, v44, v45
    s_waitcnt lgkmcnt(1)
    v_mfma_f32_32x32x16_bf16 v[68:83], v[92:95], v[36:39], v[68:83]
    ds_read_b128 v[92:95], v102 offset:7104
    v_exp_f32 v48, v48
    v_exp_f32 v49, v49
    v_exp_f32 v50, v50
    v_exp_f32 v51, v51
    v_cvt_pk_bf16_f32 v45, v46, v47
    v_cvt_pk_bf16_f32 v46, v48, v49
    v_cvt_pk_bf16_f32 v47, v50, v51
    s_cmp_eq_u32 s40, 3
    s_cbranch_scc1 L_B_t0
    v_exp_f32 v52, v52
    v_exp_f32 v53, v53
    s_waitcnt lgkmcnt(1)
    v_mfma_f32_32x32x16_bf16 v[68:83], v[96:99], v[44:47], v[68:83]
    ds_read_b128 v[96:99], v102 offset:7712
    v_exp_f32 v54, v54
    v_exp_f32 v55, v55
    v_exp_f32 v56, v56
    v_cvt_pk_bf16_f32 v52, v52, v53
    v_exp_f32 v57, v57
    v_exp_f32 v58, v58
    v_exp_f32 v59, v59
    v_cvt_pk_bf16_f32 v53, v54, v55
    v_cvt_pk_bf16_f32 v54, v56, v57
    v_cvt_pk_bf16_f32 v55, v58, v59
    v_exp_f32 v60, v60
    v_exp_f32 v61, v61
    v_exp_f32 v62, v62
    v_exp_f32 v63, v63
    v_cvt_pk_bf16_f32 v60, v60, v61
    s_waitcnt lgkmcnt(1)
    v_mfma_f32_32x32x16_bf16 v[68:83], v[92:95], v[52:55], v[68:83]
    v_exp_f32 v64, v64
    v_exp_f32 v65, v65
    v_exp_f32 v66, v66
    v_exp_f32 v67, v67
    v_cvt_pk_bf16_f32 v61, v62, v63
    v_cvt_pk_bf16_f32 v62, v64, v65
    v_cvt_pk_bf16_f32 v63, v66, v67
    s_branch L_B_t1
L_B_L0:
    s_cmp_lt_u32 s3, 4
    s_cbranch_scc1 L_B_L0b
    s_cmp_lt_u32 s3, s44
    s_cbranch_scc0 L_B_L0b
    s_add_u32 s61, s41, 0
    buffer_load_dwordx4 v[112:115], v1, s[4:7], s61 offen offset:0
    buffer_load_dwordx4 v[116:119], v1, s[4:7], s61 offen offset:1024
    buffer_load_dwordx4 v[120:123], v1, s[4:7], s61 offen offset:2048
    buffer_load_dwordx4 v[124:127], v1, s[4:7], s61 offen offset:3072
    s_add_u32 s61, s41, 4096
    buffer_load_dwordx4 v[128:131], v1, s[4:7], s61 offen offset:0
    buffer_load_dwordx4 v[132:135], v1, s[4:7], s61 offen offset:1024
    buffer_load_dwordx4 v[136:139], v1, s[4:7], s61 offen offset:2048
    buffer_load_dwordx4 v[140:143], v1, s[4:7], s61 offen offset:3072
    s_add_u32 s61, s41, 8192
    buffer_load_dwordx4 v[144:147], v1, s[4:7], s61 offen offset:0
    buffer_load_dwordx4 v[148:151], v1, s[4:7], s61 offen offset:1024
    buffer_load_dwordx4 v[152:155], v1, s[4:7], s61 offen offset:2048
    buffer_load_dwordx4 v[156:159], v1, s[4:7], s61 offen offset:3072
    s_add_u32 s61, s41, 12288
    buffer_load_dwordx4 v[160:163], v1, s[4:7], s61 offen offset:0
    buffer_load_dwordx4 v[164:167], v1, s[4:7], s61 offen offset:1024
    buffer_load_dwordx4 v[168:171], v1, s[4:7], s61 offen offset:2048
    buffer_load_dwordx4 v[172:175], v1, s[4:7], s61 offen offset:3072
    s_add_u32 s61, s41, 16384
    buffer_load_dwordx4 v[176:179], v1, s[4:7], s61 offen offset:0
    buffer_load_dwordx4 v[180:183], v1, s[4:7], s61 offen offset:1024
    buffer_load_dwordx4 v[184:187], v1, s[4:7], s61 offen offset:2048
    buffer_load_dwordx4 v[188:191], v1, s[4:7], s61 offen offset:3072
    s_add_u32 s61, s41, 20480
    buffer_load_dwordx4 v[192:195], v1, s[4:7], s61 offen offset:0
    buffer_load_dwordx4 v[196:199], v1, s[4:7], s61 offen offset:1024
    buffer_load_dwordx4 v[200:203], v1, s[4:7], s61 offen offset:2048
    buffer_load_dwordx4 v[204:207], v1, s[4:7], s61 offen offset:3072
L_B_L0b:
    s_mov_b32 s50, 162832
    s_mov_b32 s51, 4
    s_call_b64 s[30:31], L_B_wait
    s_mov_b32 s40, s47
    s_mov_b32 s48, 99
    s_branch L_B_L1
L_B_L:
    s_add_u32 s40, s48, 5
    v_mov_b32 v5, 162832
    ds_read_b128 v[100:103], v5
    s_waitcnt lgkmcnt(0)
    v_cmp_gt_u32 vcc, 4, v101
    v_cmp_gt_u32 s[62:63], 1, v102
    s_or_b64 vcc, vcc, s[62:63]
    s_mov_b32 s50, 1
    s_cbranch_vccz L_B_L4
    s_waitcnt vmcnt(0)
    s_mov_b64 exec, 1
    buffer_store_dword v14, off, s[16:19], s49 sc1
    s_mov_b64 exec, -1
    s_call_b64 s[30:31], L_B_try
    s_mov_b32 s50, 162840
    s_mov_b32 s51, 1
    s_call_b64 s[30:31], L_B_wait
L_B_L1:
    s_mov_b32 s50, 162836
    s_mov_b32 s51, 4
    s_call_b64 s[30:31], L_B_wait
    s_mov_b32 s50, 0
L_B_L4:
    s_cmp_eq_u32 s12, 0
    s_cselect_b32 s51, 4, s44
    s_cmp_lt_u32 s3, s51
    s_cselect_b32 s51, 77, 0
    ds_read_b128 v[84:87], v8 offset:16576
    ds_read_b32 v88, v9 offset:17600
    ds_read_b128 v[92:95], v10 offset:18944
    v_exp_f32 v36, v36
    v_exp_f32 v37, v37
    ds_read_b128 v[96:99], v10 offset:19552
    v_exp_f32 v38, v38
    v_exp_f32 v39, v39
    v_exp_f32 v40, v40
    v_cvt_pk_bf16_f32 v36, v36, v37
    s_waitcnt lgkmcnt(2)
    v_mfma_f32_32x32x16_bf16 v[52:67], v[84:87], v[24:27], 0
    ds_read_b128 v[84:87], v8 offset:14208
    v_exp_f32 v41, v41
    v_exp_f32 v42, v42
    v_exp_f32 v43, v43
    v_cvt_pk_bf16_f32 v37, v38, v39
    v_cvt_pk_bf16_f32 v38, v40, v41
    v_mfma_f32_32x32x8_bf16 v[52:67], v[88:89], v[28:29], v[52:67]
    ds_read_b32 v88, v9 offset:15232
    v_cvt_pk_bf16_f32 v39, v42, v43
    v_exp_f32 v44, v44
    v_exp_f32 v45, v45
    v_exp_f32 v46, v46
    v_exp_f32 v47, v47
    v_cvt_pk_bf16_f32 v44, v44, v45
    s_waitcnt lgkmcnt(2)
    v_mfma_f32_32x32x16_bf16 v[68:83], v[92:95], v[36:39], 0
    ds_read_b128 v[92:95], v10 offset:16576
    v_exp_f32 v48, v48
    v_exp_f32 v49, v49
    v_exp_f32 v50, v50
    v_exp_f32 v51, v51
    v_cvt_pk_bf16_f32 v45, v46, v47
    v_cvt_pk_bf16_f32 v46, v48, v49
    v_cvt_pk_bf16_f32 v47, v50, v51
    s_cmp_eq_u32 s40, 1
    s_cbranch_scc1 L_B_u0
    s_cmp_eq_u32 s50, 1
    s_cbranch_scc0 Lf_77
    s_waitcnt vmcnt(0)
    s_mov_b64 exec, 1
    buffer_store_dword v14, off, s[16:19], s49 sc1
    s_mov_b64 exec, -1
    s_call_b64 s[30:31], L_B_try
Lf_77:
    v_exp_f32 v52, v52
    v_exp_f32 v53, v53
    s_waitcnt lgkmcnt(2)
    v_mfma_f32_32x32x16_bf16 v[68:83], v[96:99], v[44:47], v[68:83]
    ds_read_b128 v[96:99], v10 offset:17184
    v_exp_f32 v54, v54
    v_exp_f32 v55, v55
    v_exp_f32 v56, v56
    v_cvt_pk_bf16_f32 v52, v52, v53
    s_waitcnt lgkmcnt(2)
    v_mfma_f32_32x32x16_bf16 v[36:51], v[84:87], v[24:27], 0
    ds_read_b128 v[84:87], v8 offset:11840
    v_exp_f32 v57, v57
    v_exp_f32 v58, v58
    v_exp_f32 v59, v59
    v_cvt_pk_bf16_f32 v53, v54, v55
    v_cvt_pk_bf16_f32 v54, v56, v57
    v_mfma_f32_32x32x8_bf16 v[36:51], v[88:89], v[28:29], v[36:51]
    ds_read_b32 v88, v9 offset:12864
    s_cmp_eq_u32 s51, 77
    s_cbranch_scc0 Lg_78
    s_add_u32 s61, s41, 0
    buffer_load_dwordx4 v[112:115], v1, s[4:7], s61 offen offset:0
    buffer_load_dwordx4 v[116:119], v1, s[4:7], s61 offen offset:1024
    buffer_load_dwordx4 v[120:123], v1, s[4:7], s61 offen offset:2048
    buffer_load_dwordx4 v[124:127], v1, s[4:7], s61 offen offset:3072
    s_add_u32 s61, s41, 4096
    buffer_load_dwordx4 v[128:131], v1, s[4:7], s61 offen offset:0
    buffer_load_dwordx4 v[132:135], v1, s[4:7], s61 offen offset:1024
    Lg_78:
    v_cvt_pk_bf16_f32 v55, v58, v59
    v_exp_f32 v60, v60
    v_exp_f32 v61, v61
    v_exp_f32 v62, v62
    v_exp_f32 v63, v63
    v_cvt_pk_bf16_f32 v60, v60, v61
    s_waitcnt lgkmcnt(2)
    v_mfma_f32_32x32x16_bf16 v[68:83], v[92:95], v[52:55], v[68:83]
    ds_read_b128 v[92:95], v10 offset:14208
    v_exp_f32 v64, v64
    v_exp_f32 v65, v65
    v_exp_f32 v66, v66
    v_exp_f32 v67, v67
    v_cvt_pk_bf16_f32 v61, v62, v63
    v_cvt_pk_bf16_f32 v62, v64, v65
    v_cvt_pk_bf16_f32 v63, v66, v67
    s_cmp_eq_u32 s40, 2
    s_cbranch_scc1 L_B_u1
    s_cmp_eq_u32 s48, 0
    s_cbranch_scc0 Lf_79
    s_mov_b32 s50, 3
    s_call_b64 s[30:31], L_B_fetch
Lf_79:
    v_exp_f32 v36, v36
    v_exp_f32 v37, v37
    s_waitcnt lgkmcnt(2)
    v_mfma_f32_32x32x16_bf16 v[68:83], v[96:99], v[60:63], v[68:83]
    ds_read_b128 v[96:99], v10 offset:14816
    v_exp_f32 v38, v38
    v_exp_f32 v39, v39
    v_exp_f32 v40, v40
    v_cvt_pk_bf16_f32 v36, v36, v37
    s_waitcnt lgkmcnt(2)
    v_mfma_f32_32x32x16_bf16 v[52:67], v[84:87], v[24:27], 0
    ds_read_b128 v[84:87], v8 offset:9472
    v_exp_f32 v41, v41
    v_exp_f32 v42, v42
    v_exp_f32 v43, v43
    v_cvt_pk_bf16_f32 v37, v38, v39
    v_cvt_pk_bf16_f32 v38, v40, v41
    v_mfma_f32_32x32x8_bf16 v[52:67], v[88:89], v[28:29], v[52:67]
    ds_read_b32 v88, v9 offset:10496
    s_cmp_eq_u32 s51, 77
    s_cbranch_scc0 Lg_80
    s_add_u32 s61, s41, 4096
    buffer_load_dwordx4 v[136:139], v1, s[4:7], s61 offen offset:2048
    buffer_load_dwordx4 v[140:143], v1, s[4:7], s61 offen offset:3072
    s_add_u32 s61, s41, 8192
    buffer_load_dwordx4 v[144:147], v1, s[4:7], s61 offen offset:0
    buffer_load_dwordx4 v[148:151], v1, s[4:7], s61 offen offset:1024
    buffer_load_dwordx4 v[152:155], v1, s[4:7], s61 offen offset:2048
    buffer_load_dwordx4 v[156:159], v1, s[4:7], s61 offen offset:3072
    Lg_80:
    v_cvt_pk_bf16_f32 v39, v42, v43
    v_exp_f32 v44, v44
    v_exp_f32 v45, v45
    v_exp_f32 v46, v46
    v_exp_f32 v47, v47
    v_cvt_pk_bf16_f32 v44, v44, v45
    s_waitcnt lgkmcnt(2)
    v_mfma_f32_32x32x16_bf16 v[68:83], v[92:95], v[36:39], v[68:83]
    ds_read_b128 v[92:95], v10 offset:11840
    v_exp_f32 v48, v48
    v_exp_f32 v49, v49
    v_exp_f32 v50, v50
    v_exp_f32 v51, v51
    v_cvt_pk_bf16_f32 v45, v46, v47
    v_cvt_pk_bf16_f32 v46, v48, v49
    v_cvt_pk_bf16_f32 v47, v50, v51
    s_cmp_eq_u32 s40, 3
    s_cbranch_scc1 L_B_u0
    v_exp_f32 v52, v52
    v_exp_f32 v53, v53
    s_waitcnt lgkmcnt(2)
    v_mfma_f32_32x32x16_bf16 v[68:83], v[96:99], v[44:47], v[68:83]
    ds_read_b128 v[96:99], v10 offset:12448
    v_exp_f32 v54, v54
    v_exp_f32 v55, v55
    v_exp_f32 v56, v56
    v_cvt_pk_bf16_f32 v52, v52, v53
    s_waitcnt lgkmcnt(2)
    v_mfma_f32_32x32x16_bf16 v[36:51], v[84:87], v[24:27], 0
    ds_read_b128 v[84:87], v8 offset:7104
    v_exp_f32 v57, v57
    v_exp_f32 v58, v58
    v_exp_f32 v59, v59
    v_cvt_pk_bf16_f32 v53, v54, v55
    v_cvt_pk_bf16_f32 v54, v56, v57
    v_mfma_f32_32x32x8_bf16 v[36:51], v[88:89], v[28:29], v[36:51]
    ds_read_b32 v88, v9 offset:8128
    s_cmp_eq_u32 s51, 77
    s_cbranch_scc0 Lg_81
    s_add_u32 s61, s41, 12288
    buffer_load_dwordx4 v[160:163], v1, s[4:7], s61 offen offset:0
    buffer_load_dwordx4 v[164:167], v1, s[4:7], s61 offen offset:1024
    buffer_load_dwordx4 v[168:171], v1, s[4:7], s61 offen offset:2048
    buffer_load_dwordx4 v[172:175], v1, s[4:7], s61 offen offset:3072
    s_add_u32 s61, s41, 16384
    buffer_load_dwordx4 v[176:179], v1, s[4:7], s61 offen offset:0
    buffer_load_dwordx4 v[180:183], v1, s[4:7], s61 offen offset:1024
    Lg_81:
    v_cvt_pk_bf16_f32 v55, v58, v59
    v_exp_f32 v60, v60
    v_exp_f32 v61, v61
    v_exp_f32 v62, v62
    v_exp_f32 v63, v63
    v_cvt_pk_bf16_f32 v60, v60, v61
    s_waitcnt lgkmcnt(2)
    v_mfma_f32_32x32x16_bf16 v[68:83], v[92:95], v[52:55], v[68:83]
    ds_read_b128 v[92:95], v10 offset:9472
    v_exp_f32 v64, v64
    v_exp_f32 v65, v65
    v_exp_f32 v66, v66
    v_exp_f32 v67, v67
    v_cvt_pk_bf16_f32 v61, v62, v63
    v_cvt_pk_bf16_f32 v62, v64, v65
    v_cvt_pk_bf16_f32 v63, v66, v67
    s_cmp_eq_u32 s40, 4
    s_cbranch_scc1 L_B_u1
    v_exp_f32 v36, v36
    v_exp_f32 v37, v37
    s_waitcnt lgkmcnt(2)
    v_mfma_f32_32x32x16_bf16 v[68:83], v[96:99], v[60:63], v[68:83]
    ds_read_b128 v[96:99], v10 offset:10080
    v_exp_f32 v38, v38
    v_exp_f32 v39, v39
    v_exp_f32 v40, v40
    v_cvt_pk_bf16_f32 v36, v36, v37
    s_waitcnt lgkmcnt(2)
    v_mfma_f32_32x32x16_bf16 v[52:67], v[84:87], v[24:27], 0
    ds_read_b128 v[84:87], v8 offset:4736
    v_exp_f32 v41, v41
    v_exp_f32 v42, v42
    v_exp_f32 v43, v43
    v_cvt_pk_bf16_f32 v37, v38, v39
    v_cvt_pk_bf16_f32 v38, v40, v41
    v_mfma_f32_32x32x8_bf16 v[52:67], v[88:89], v[28:29], v[52:67]
    ds_read_b32 v88, v9 offset:5760
    s_cmp_eq_u32 s51, 77
    s_cbranch_scc0 Lg_82
    s_add_u32 s61, s41, 16384
    buffer_load_dwordx4 v[184:187], v1, s[4:7], s61 offen offset:2048
    buffer_load_dwordx4 v[188:191], v1, s[4:7], s61 offen offset:3072
    s_add_u32 s61, s41, 20480
    buffer_load_dwordx4 v[192:195], v1, s[4:7], s61 offen offset:0
    buffer_load_dwordx4 v[196:199], v1, s[4:7], s61 offen offset:1024
    buffer_load_dwordx4 v[200:203], v1, s[4:7], s61 offen offset:2048
    buffer_load_dwordx4 v[204:207], v1, s[4:7], s61 offen offset:3072
    Lg_82:
    v_cvt_pk_bf16_f32 v39, v42, v43
    v_exp_f32 v44, v44
    v_exp_f32 v45, v45
    v_exp_f32 v46, v46
    v_exp_f32 v47, v47
    v_cvt_pk_bf16_f32 v44, v44, v45
    s_waitcnt lgkmcnt(2)
    v_mfma_f32_32x32x16_bf16 v[68:83], v[92:95], v[36:39], v[68:83]
    ds_read_b128 v[92:95], v10 offset:7104
    v_exp_f32 v48, v48
    v_exp_f32 v49, v49
    v_exp_f32 v50, v50
    v_exp_f32 v51, v51
    v_cvt_pk_bf16_f32 v45, v46, v47
    v_cvt_pk_bf16_f32 v46, v48, v49
    v_cvt_pk_bf16_f32 v47, v50, v51
    s_cmp_eq_u32 s40, 5
    s_cbranch_scc1 L_B_u0
    v_exp_f32 v52, v52
    v_exp_f32 v53, v53
    s_waitcnt lgkmcnt(2)
    v_mfma_f32_32x32x16_bf16 v[68:83], v[96:99], v[44:47], v[68:83]
    ds_read_b128 v[96:99], v10 offset:7712
    v_exp_f32 v54, v54
    v_exp_f32 v55, v55
    v_exp_f32 v56, v56
    v_cvt_pk_bf16_f32 v52, v52, v53
    s_waitcnt lgkmcnt(2)
    v_mfma_f32_32x32x16_bf16 v[36:51], v[84:87], v[24:27], 0
    ds_read_b128 v[84:87], v8 offset:2368
    v_exp_f32 v57, v57
    v_exp_f32 v58, v58
    v_exp_f32 v59, v59
    v_cvt_pk_bf16_f32 v53, v54, v55
    v_cvt_pk_bf16_f32 v54, v56, v57
    v_mfma_f32_32x32x8_bf16 v[36:51], v[88:89], v[28:29], v[36:51]
    ds_read_b32 v88, v9 offset:3392
    v_cvt_pk_bf16_f32 v55, v58, v59
    v_exp_f32 v60, v60
    v_exp_f32 v61, v61
    v_exp_f32 v62, v62
    v_exp_f32 v63, v63
    v_cvt_pk_bf16_f32 v60, v60, v61
    s_waitcnt lgkmcnt(2)
    v_mfma_f32_32x32x16_bf16 v[68:83], v[92:95], v[52:55], v[68:83]
    ds_read_b128 v[92:95], v10 offset:4736
    v_exp_f32 v64, v64
    v_exp_f32 v65, v65
    v_exp_f32 v66, v66
    v_exp_f32 v67, v67
    v_cvt_pk_bf16_f32 v61, v62, v63
    v_cvt_pk_bf16_f32 v62, v64, v65
    v_cvt_pk_bf16_f32 v63, v66, v67
    s_cmp_eq_u32 s40, 6
    s_cbranch_scc1 L_B_u1
    v_exp_f32 v36, v36
    v_exp_f32 v37, v37
    s_waitcnt lgkmcnt(2)
    v_mfma_f32_32x32x16_bf16 v[68:83], v[96:99], v[60:63], v[68:83]
    ds_read_b128 v[96:99], v10 offset:5344
    v_exp_f32 v38, v38
    v_exp_f32 v39, v39
    v_exp_f32 v40, v40
    v_cvt_pk_bf16_f32 v36, v36, v37
    s_waitcnt lgkmcnt(2)
    v_mfma_f32_32x32x16_bf16 v[52:67], v[84:87], v[24:27], 0
    v_exp_f32 v41, v41
    v_exp_f32 v42, v42
    v_exp_f32 v43, v43
    v_cvt_pk_bf16_f32 v37, v38, v39
    v_cvt_pk_bf16_f32 v38, v40, v41
    v_mfma_f32_32x32x8_bf16 v[52:67], v[88:89], v[28:29], v[52:67]
    v_cvt_pk_bf16_f32 v39, v42, v43
    v_exp_f32 v44, v44
    v_exp_f32 v45, v45
    v_exp_f32 v46, v46
    v_exp_f32 v47, v47
    v_cvt_pk_bf16_f32 v44, v44, v45
    s_waitcnt lgkmcnt(1)
    v_mfma_f32_32x32x16_bf16 v[68:83], v[92:95], v[36:39], v[68:83]
    ds_read_b128 v[92:95], v10 offset:2368
    v_exp_f32 v48, v48
    v_exp_f32 v49, v49
    v_exp_f32 v50, v50
    v_exp_f32 v51, v51
    v_cvt_pk_bf16_f32 v45, v46, v47
    v_cvt_pk_bf16_f32 v46, v48, v49
    v_cvt_pk_bf16_f32 v47, v50, v51
    s_cmp_eq_u32 s40, 7
    s_cbranch_scc1 L_B_u0
    v_exp_f32 v52, v52
    v_exp_f32 v53, v53
    s_waitcnt lgkmcnt(1)
    v_mfma_f32_32x32x16_bf16 v[68:83], v[96:99], v[44:47], v[68:83]
    ds_read_b128 v[96:99], v10 offset:2976
    v_exp_f32 v54, v54
    v_exp_f32 v55, v55
    v_exp_f32 v56, v56
    v_cvt_pk_bf16_f32 v52, v52, v53
    v_exp_f32 v57, v57
    v_exp_f32 v58, v58
    v_exp_f32 v59, v59
    v_cvt_pk_bf16_f32 v53, v54, v55
    v_cvt_pk_bf16_f32 v54, v56, v57
    v_cvt_pk_bf16_f32 v55, v58, v59
    v_exp_f32 v60, v60
    v_exp_f32 v61, v61
    v_exp_f32 v62, v62
    v_exp_f32 v63, v63
    v_cvt_pk_bf16_f32 v60, v60, v61
    s_waitcnt lgkmcnt(1)
    v_mfma_f32_32x32x16_bf16 v[68:83], v[92:95], v[52:55], v[68:83]
    v_exp_f32 v64, v64
    v_exp_f32 v65, v65
    v_exp_f32 v66, v66
    v_exp_f32 v67, v67
    v_cvt_pk_bf16_f32 v61, v62, v63
    v_cvt_pk_bf16_f32 v62, v64, v65
    v_cvt_pk_bf16_f32 v63, v66, v67
L_B_u1:
    s_waitcnt lgkmcnt(0)
    s_nop 0
    v_mfma_f32_32x32x16_bf16 v[68:83], v[96:99], v[60:63], v[68:83]
L_B_L2:
    s_cmp_eq_u32 s12, 0
    s_cbranch_scc1 L_B_done
    v_mov_b32 v100, v8
    v_mov_b32 v101, v9
    v_mov_b32 v102, v10
    s_sub_u32 s40, 4, s48
    s_cmp_eq_u32 s48, 0
    s_cbranch_scc0 L_B_L3
    s_call_b64 s[30:31], L_B_fetched
L_B_L3:
    s_nop 7
    v_cndmask_b32 v36, 0, v11, s[64:65]
    v_cndmask_b32 v37, 0, v11, s[66:67]
    v_cndmask_b32 v38, 0, v11, s[68:69]
    v_cndmask_b32 v39, 0, v11, s[70:71]
    v_cndmask_b32 v40, 0, v11, s[72:73]
    v_cndmask_b32 v41, 0, v11, s[74:75]
    v_cndmask_b32 v42, 0, v11, s[76:77]
    v_cndmask_b32 v43, 0, v11, s[78:79]
    v_cndmask_b32 v44, 0, v11, s[80:81]
    v_cndmask_b32 v45, 0, v11, s[82:83]
    v_cndmask_b32 v46, 0, v11, s[84:85]
    v_cndmask_b32 v47, 0, v11, s[86:87]
    v_cndmask_b32 v48, 0, v11, s[88:89]
    v_cndmask_b32 v49, 0, v11, s[90:91]
    v_cndmask_b32 v50, 0, v11, s[92:93]
    v_cndmask_b32 v51, 0, v11, s[94:95]
    s_mov_b32 s50, 162844
    s_mov_b32 s51, 1
    s_call_b64 s[30:31], L_B_wait
    s_branch L_B_run2
L_B_t0:
    s_waitcnt lgkmcnt(0)
    s_nop 0
    v_mfma_f32_32x32x16_bf16 v[68:83], v[96:99], v[44:47], v[68:83]
L_B_done:
    s_mul_i32 s24, s45, 36864
    s_add_u32 s24, s24, 0x840000
    s_lshl_b32 s27, s46, 10
    s_add_u32 s27, s27, s24
    s_lshr_b32 s25, s46, 2
    s_lshl_b32 s25, s25, 9
    s_and_b32 s26, s46, 3
    s_lshl_b32 s26, s26, 2
    s_add_u32 s25, s25, s26
    s_add_u32 s25, s25, s24
    s_add_u32 s25, s25, 32768
    v_cmp_eq_u32 vcc, 0, v3
    v_lshlrev_b32 v12, 30, v3
    v_lshl_add_u32 v12, v2, 4, v12
    v_mov_b32 v5, 0x5d800000
    v_cndmask_b32 v4, v80, v78, vcc
    v_cmp_le_f32 vcc, 0x21800000, v4
    v_cmp_le_f32 s[62:63], v4, v5
    s_and_b64 vcc, vcc, s[62:63]
    s_cmp_eq_u64 vcc, -1
    s_cbranch_scc0 L_B_slow
L_B_fin:
    v_rcp_f32 v4, v4
    s_nop 0
    v_mul_f32 v68, v4, v68
    v_mul_f32 v69, v4, v69
    v_mul_f32 v70, v4, v70
    v_mul_f32 v71, v4, v71
    v_mul_f32 v72, v4, v72
    v_mul_f32 v73, v4, v73
    v_mul_f32 v74, v4, v74
    v_mul_f32 v75, v4, v75
    v_mul_f32 v76, v4, v76
    v_mul_f32 v77, v4, v77
    v_cvt_pk_bf16_f32 v68, v68, v69
    v_cvt_pk_bf16_f32 v69, v70, v71
    v_cvt_pk_bf16_f32 v70, v72, v73
    v_cvt_pk_bf16_f32 v71, v74, v75
    v_cvt_pk_bf16_f32 v72, v76, v77
    s_cmp_eq_u32 s99, 1
    s_cbranch_scc1 Ls_83
    buffer_store_dwordx4 v[68:71], v1, s[4:7], s27 offen sc1
    buffer_store_dword v72, v12, s[4:7], s25 offen sc1
    s_branch Lse_84
Ls_83:
    buffer_store_dwordx4 v[68:71], v1, s[4:7], s27 offen
    buffer_store_dword v72, v12, s[4:7], s25 offen
Lse_84:
    s_cmp_lt_u32 s3, s44
    s_cbranch_scc0 L_B_nl
    s_add_u32 s61, s41, 24576
    buffer_load_dwordx4 v[208:211], v1, s[4:7], s61 offen offset:0
    buffer_load_dwordx4 v[212:215], v1, s[4:7], s61 offen offset:1024
    buffer_load_dwordx4 v[216:219], v1, s[4:7], s61 offen offset:2048
    buffer_load_dwordx4 v[220:223], v1, s[4:7], s61 offen offset:3072
    s_add_u32 s61, s41, 28672
    buffer_load_dwordx4 v[224:227], v1, s[4:7], s61 offen offset:0
    buffer_load_dwordx4 v[228:231], v1, s[4:7], s61 offen offset:1024
    buffer_load_dwordx4 v[232:235], v1, s[4:7], s61 offen offset:2048
    buffer_load_dwordx4 v[236:239], v1, s[4:7], s61 offen offset:3072
    s_add_u32 s61, s41, 32768
    buffer_load_dwordx4 v[240:243], v1, s[4:7], s61 offen offset:0
    buffer_load_dwordx4 v[244:247], v1, s[4:7], s61 offen offset:1024
    buffer_load_dwordx4 v[248:251], v1, s[4:7], s61 offen offset:2048
    buffer_load_dwordx4 v[252:255], v1, s[4:7], s61 offen offset:3072
    s_waitcnt vmcnt(12)
    s_branch L_B_nl2
L_B_nl:
    s_waitcnt vmcnt(0)
L_B_nl2:
    s_barrier
    s_cmp_lg_u32 s3, 0
    s_cbranch_scc1 L_B_end
    s_lshl_b32 s22, s12, 12
    s_lshl_b32 s23, s46, 7
    s_add_u32 s22, s22, s23
    s_add_u32 s22, s22, 0x51000c
    s_mov_b64 exec, 1
    s_cmp_eq_u32 s99, 1
    s_cbranch_scc1 Ls_85
    buffer_store_dword v14, off, s[16:19], s22 sc1
    s_branch Lse_86
Ls_85:
    buffer_store_dword v14, off, s[16:19], s22
Lse_86:
    s_mov_b64 exec, -1
L_B_end:
    s_setprio 0
    s_cmp_lt_u32 s3, s44
    s_cbranch_scc1 L_OB_c
    s_cmp_eq_u32 s3, 7
    s_cbranch_scc1 L_OB_ld
    s_cmp_eq_u32 s15, 0
    s_cbranch_scc0 L_OB_idle
    s_cmp_lt_u32 s3, 4
    s_cbranch_scc1 L_OB_idle
    s_lshr_b32 s23, s13, 2
    s_mul_i32 s22, s23, 3
    s_add_u32 s22, s22, s3
    s_sub_u32 s22, s22, 5
    s_cmp_lg_u32 s3, 4
    s_cbranch_scc1 Lwa_87
    s_and_b32 s24, s23, 2
    s_cmp_eq_u32 s24, 0
    s_cbranch_scc1 L_OB_idle
    s_lshr_b32 s22, s23, 2
    s_add_u32 s22, s22, 24
Lwa_87:
    s_mul_i32 s22, s22, 36864
    s_add_u32 s22, s22, 0xb00000
    s_add_u32 s61, s22, 0
    buffer_load_dwordx4 v[112:115], v1, s[4:7], s61 offen offset:0
    buffer_load_dwordx4 v[116:119], v1, s[4:7], s61 offen offset:1024
    buffer_load_dwordx4 v[120:123], v1, s[4:7], s61 offen offset:2048
    buffer_load_dwordx4 v[124:127], v1, s[4:7], s61 offen offset:3072
    s_add_u32 s61, s22, 4096
    buffer_load_dwordx4 v[128:131], v1, s[4:7], s61 offen offset:0
    buffer_load_dwordx4 v[132:135], v1, s[4:7], s61 offen offset:1024
    buffer_load_dwordx4 v[136:139], v1, s[4:7], s61 offen offset:2048
    buffer_load_dwordx4 v[140:143], v1, s[4:7], s61 offen offset:3072
    s_add_u32 s61, s22, 8192
    buffer_load_dwordx4 v[144:147], v1, s[4:7], s61 offen offset:0
    buffer_load_dwordx4 v[148:151], v1, s[4:7], s61 offen offset:1024
    buffer_load_dwordx4 v[152:155], v1, s[4:7], s61 offen offset:2048
    buffer_load_dwordx4 v[156:159], v1, s[4:7], s61 offen offset:3072
    s_add_u32 s61, s22, 12288
    buffer_load_dwordx4 v[160:163], v1, s[4:7], s61 offen offset:0
    buffer_load_dwordx4 v[164:167], v1, s[4:7], s61 offen offset:1024
    buffer_load_dwordx4 v[168:171], v1, s[4:7], s61 offen offset:2048
    buffer_load_dwordx4 v[172:175], v1, s[4:7], s61 offen offset:3072
    s_add_u32 s61, s22, 16384
    buffer_load_dwordx4 v[176:179], v1, s[4:7], s61 offen offset:0
    buffer_load_dwordx4 v[180:183], v1, s[4:7], s61 offen offset:1024
    buffer_load_dwordx4 v[184:187], v1, s[4:7], s61 offen offset:2048
    buffer_load_dwordx4 v[188:191], v1, s[4:7], s61 offen offset:3072
    s_add_u32 s61, s22, 20480
    buffer_load_dwordx4 v[192:195], v1, s[4:7], s61 offen offset:0
    buffer_load_dwordx4 v[196:199], v1, s[4:7], s61 offen offset:1024
    buffer_load_dwordx4 v[200:203], v1, s[4:7], s61 offen offset:2048
    buffer_load_dwordx4 v[204:207], v1, s[4:7], s61 offen offset:3072
    s_add_u32 s61, s22, 24576
    buffer_load_dwordx4 v[208:211], v1, s[4:7], s61 offen offset:0
    buffer_load_dwordx4 v[212:215], v1, s[4:7], s61 offen offset:1024
    buffer_load_dwordx4 v[216:219], v1, s[4:7], s61 offen offset:2048
    buffer_load_dwordx4 v[220:223], v1, s[4:7], s61 offen offset:3072
    s_add_u32 s61, s22, 28672
    buffer_load_dwordx4 v[224:227], v1, s[4:7], s61 offen offset:0
    buffer_load_dwordx4 v[228:231], v1, s[4:7], s61 offen offset:1024
    buffer_load_dwordx4 v[232:235], v1, s[4:7], s61 offen offset:2048
    buffer_load_dwordx4 v[236:239], v1, s[4:7], s61 offen offset:3072
    s_add_u32 s61, s22, 32768
    buffer_load_dwordx4 v[240:243], v1, s[4:7], s61 offen offset:0
    buffer_load_dwordx4 v[244:247], v1, s[4:7], s61 offen offset:1024
    buffer_load_dwordx4 v[248:251], v1, s[4:7], s61 offen offset:2048
    buffer_load_dwordx4 v[252:255], v1, s[4:7], s61 offen offset:3072
    s_barrier
    s_barrier
    s_barrier
    s_branch L_OB_e
L_OB_idle:
    s_barrier
    s_barrier
    s_barrier
    s_branch L_OB_e
L_OB_ld:
    s_lshl_b32 s23, s12, 12
    s_add_u32 s23, s23, 0x51000c
    v_lshlrev_b32 v5, 3, v1
    s_mov_b32 exec_lo, -1
    s_mov_b32 exec_hi, 0x0
    s_mov_b32 s21, 0
Lp_88:
    buffer_load_dword v4, v5, s[16:19], s23 offen sc1
    s_add_u32 s21, s21, 1
    s_cmp_gt_u32 s21, s20
    s_cselect_b32 s20, 0, s20
    s_waitcnt vmcnt(0)
    s_cbranch_scc1 Lpd_89
    v_cmp_ne_u32 vcc, s14, v4
    s_cbranch_vccnz Lp_88
Lpd_89:
    s_mov_b64 exec, -1
    s_mul_i32 s22, s42, 36864
    s_add_u32 s22, s22, 0x840000
    s_mov_b32 m0, 0
    s_nop 0
    buffer_load_dwordx4 v1, s[4:7], s22 offen sc1 lds
    s_add_u32 m0, m0, 1024
    s_add_u32 s22, s22, 1024
    s_nop 0
    buffer_load_dwordx4 v1, s[4:7], s22 offen sc1 lds
    s_add_u32 m0, m0, 1024
    s_add_u32 s22, s22, 1024
    s_nop 0
    buffer_load_dwordx4 v1, s[4:7], s22 offen sc1 lds
    s_add_u32 m0, m0, 1024
    s_add_u32 s22, s22, 1024
    s_nop 0
    buffer_load_dwordx4 v1, s[4:7], s22 offen sc1 lds
    s_add_u32 m0, m0, 1024
    s_add_u32 s22, s22, 1024
    s_nop 0
    buffer_load_dwordx4 v1, s[4:7], s22 offen sc1 lds
    s_add_u32 m0, m0, 1024
    s_add_u32 s22, s22, 1024
    s_nop 0
    buffer_load_dwordx4 v1, s[4:7], s22 offen sc1 lds
    s_add_u32 m0, m0, 1024
    s_add_u32 s22, s22, 1024
    s_nop 0
    buffer_load_dwordx4 v1, s[4:7], s22 offen sc1 lds
    s_add_u32 m0, m0, 1024
    s_add_u32 s22, s22, 1024
    s_nop 0
    buffer_load_dwordx4 v1, s[4:7], s22 offen sc1 lds
    s_add_u32 m0, m0, 1024
    s_add_u32 s22, s22, 1024
    s_nop 0
    buffer_load_dwordx4 v1, s[4:7], s22 offen sc1 lds
    s_add_u32 m0, m0, 1024
    s_add_u32 s22, s22, 1024
    s_nop 0
    buffer_load_dwordx4 v1, s[4:7], s22 offen sc1 lds
    s_add_u32 m0, m0, 1024
    s_add_u32 s22, s22, 1024
    s_nop 0
    buffer_load_dwordx4 v1, s[4:7], s22 offen sc1 lds
    s_add_u32 m0, m0, 1024
    s_add_u32 s22, s22, 1024
    s_nop 0
    buffer_load_dwordx4 v1, s[4:7], s22 offen sc1 lds
    s_add_u32 m0, m0, 1024
    s_add_u32 s22, s22, 1024
    s_nop 0
    buffer_load_dwordx4 v1, s[4:7], s22 offen sc1 lds
    s_add_u32 m0, m0, 1024
    s_add_u32 s22, s22, 1024
    s_nop 0
    buffer_load_dwordx4 v1, s[4:7], s22 offen sc1 lds
    s_add_u32 m0, m0, 1024
    s_add_u32 s22, s22, 1024
    s_nop 0
    buffer_load_dwordx4 v1, s[4:7], s22 offen sc1 lds
    s_add_u32 m0, m0, 1024
    s_add_u32 s22, s22, 1024
    s_nop 0
    buffer_load_dwordx4 v1, s[4:7], s22 offen sc1 lds
    s_add_u32 m0, m0, 1024
    s_add_u32 s22, s22, 1024
    s_nop 0
    buffer_load_dwordx4 v1, s[4:7], s22 offen sc1 lds
    s_add_u32 m0, m0, 1024
    s_add_u32 s22, s22, 1024
    s_nop 0
    buffer_load_dwordx4 v1, s[4:7], s22 offen sc1 lds
    s_add_u32 m0, m0, 1024
    s_add_u32 s22, s22, 1024
    s_nop 0
    buffer_load_dwordx4 v1, s[4:7], s22 offen sc1 lds
    s_add_u32 m0, m0, 1024
    s_add_u32 s22, s22, 1024
    s_nop 0
    buffer_load_dwordx4 v1, s[4:7], s22 offen sc1 lds
    s_add_u32 m0, m0, 1024
    s_add_u32 s22, s22, 1024
    s_nop 0
    buffer_load_dwordx4 v1, s[4:7], s22 offen sc1 lds
    s_add_u32 m0, m0, 1024
    s_add_u32 s22, s22, 1024
    s_nop 0
    buffer_load_dwordx4 v1, s[4:7], s22 offen sc1 lds
    s_add_u32 m0, m0, 1024
    s_add_u32 s22, s22, 1024
    s_nop 0
    buffer_load_dwordx4 v1, s[4:7], s22 offen sc1 lds
    s_add_u32 m0, m0, 1024
    s_add_u32 s22, s22, 1024
    s_nop 0
    buffer_load_dwordx4 v1, s[4:7], s22 offen sc1 lds
    s_add_u32 m0, m0, 1024
    s_add_u32 s22, s22, 1024
    s_nop 0
    buffer_load_dwordx4 v1, s[4:7], s22 offen sc1 lds
    s_add_u32 m0, m0, 1024
    s_add_u32 s22, s22, 1024
    s_nop 0
    buffer_load_dwordx4 v1, s[4:7], s22 offen sc1 lds
    s_add_u32 m0, m0, 1024
    s_add_u32 s22, s22, 1024
    s_nop 0
    buffer_load_dwordx4 v1, s[4:7], s22 offen sc1 lds
    s_add_u32 m0, m0, 1024
    s_add_u32 s22, s22, 1024
    s_nop 0
    buffer_load_dwordx4 v1, s[4:7], s22 offen sc1 lds
    s_add_u32 m0, m0, 1024
    s_add_u32 s22, s22, 1024
    s_nop 0
    buffer_load_dwordx4 v1, s[4:7], s22 offen sc1 lds
    s_add_u32 m0, m0, 1024
    s_add_u32 s22, s22, 1024
    s_nop 0
    buffer_load_dwordx4 v1, s[4:7], s22 offen sc1 lds
    s_add_u32 m0, m0, 1024
    s_add_u32 s22, s22, 1024
    s_nop 0
    buffer_load_dwordx4 v1, s[4:7], s22 offen sc1 lds
    s_add_u32 m0, m0, 1024
    s_add_u32 s22, s22, 1024
    s_nop 0
    buffer_load_dwordx4 v1, s[4:7], s22 offen sc1 lds
    s_add_u32 m0, m0, 1024
    s_add_u32 s22, s22, 1024
    s_nop 0
    buffer_load_dwordx4 v1, s[4:7], s22 offen sc1 lds
    s_add_u32 m0, m0, 1024
    s_add_u32 s22, s22, 1024
    s_nop 0
    buffer_load_dwordx4 v1, s[4:7], s22 offen sc1 lds
    s_add_u32 m0, m0, 1024
    s_add_u32 s22, s22, 1024
    s_nop 0
    buffer_load_dwordx4 v1, s[4:7], s22 offen sc1 lds
    s_add_u32 m0, m0, 1024
    s_add_u32 s22, s22, 1024
    s_nop 0
    buffer_load_dwordx4 v1, s[4:7], s22 offen sc1 lds
    s_waitcnt vmcnt(24)
    s_barrier
    s_waitcnt vmcnt(12)
    s_barrier
    s_waitcnt vmcnt(0)
    s_barrier
    s_cmp_eq_u32 s15, 0
    s_cbranch_scc0 L_OB_e
    s_cmp_lt_u32 s3, 4
    s_cbranch_scc1 L_OB_e
    s_lshr_b32 s23, s13, 2
    s_mul_i32 s22, s23, 3
    s_add_u32 s22, s22, s3
    s_sub_u32 s22, s22, 5
    s_cmp_lg_u32 s3, 4
    s_cbranch_scc1 Lwa_90
    s_and_b32 s24, s23, 2
    s_cmp_eq_u32 s24, 0
    s_cbranch_scc1 L_OB_e
    s_lshr_b32 s22, s23, 2
    s_add_u32 s22, s22, 24
Lwa_90:
    s_mul_i32 s22, s22, 36864
    s_add_u32 s22, s22, 0xb00000
    s_add_u32 s61, s22, 0
    buffer_load_dwordx4 v[112:115], v1, s[4:7], s61 offen offset:0
    buffer_load_dwordx4 v[116:119], v1, s[4:7], s61 offen offset:1024
    buffer_load_dwordx4 v[120:123], v1, s[4:7], s61 offen offset:2048
    buffer_load_dwordx4 v[124:127], v1, s[4:7], s61 offen offset:3072
    s_add_u32 s61, s22, 4096
    buffer_load_dwordx4 v[128:131], v1, s[4:7], s61 offen offset:0
    buffer_load_dwordx4 v[132:135], v1, s[4:7], s61 offen offset:1024
    buffer_load_dwordx4 v[136:139], v1, s[4:7], s61 offen offset:2048
    buffer_load_dwordx4 v[140:143], v1, s[4:7], s61 offen offset:3072
    s_add_u32 s61, s22, 8192
    buffer_load_dwordx4 v[144:147], v1, s[4:7], s61 offen offset:0
    buffer_load_dwordx4 v[148:151], v1, s[4:7], s61 offen offset:1024
    buffer_load_dwordx4 v[152:155], v1, s[4:7], s61 offen offset:2048
    buffer_load_dwordx4 v[156:159], v1, s[4:7], s61 offen offset:3072
    s_add_u32 s61, s22, 12288
    buffer_load_dwordx4 v[160:163], v1, s[4:7], s61 offen offset:0
    buffer_load_dwordx4 v[164:167], v1, s[4:7], s61 offen offset:1024
    buffer_load_dwordx4 v[168:171], v1, s[4:7], s61 offen offset:2048
    buffer_load_dwordx4 v[172:175], v1, s[4:7], s61 offen offset:3072
    s_add_u32 s61, s22, 16384
    buffer_load_dwordx4 v[176:179], v1, s[4:7], s61 offen offset:0
    buffer_load_dwordx4 v[180:183], v1, s[4:7], s61 offen offset:1024
    buffer_load_dwordx4 v[184:187], v1, s[4:7], s61 offen offset:2048
    buffer_load_dwordx4 v[188:191], v1, s[4:7], s61 offen offset:3072
    s_add_u32 s61, s22, 20480
    buffer_load_dwordx4 v[192:195], v1, s[4:7], s61 offen offset:0
    buffer_load_dwordx4 v[196:199], v1, s[4:7], s61 offen offset:1024
    buffer_load_dwordx4 v[200:203], v1, s[4:7], s61 offen offset:2048
    buffer_load_dwordx4 v[204:207], v1, s[4:7], s61 offen offset:3072
    s_add_u32 s61, s22, 24576
    buffer_load_dwordx4 v[208:211], v1, s[4:7], s61 offen offset:0
    buffer_load_dwordx4 v[212:215], v1, s[4:7], s61 offen offset:1024
    buffer_load_dwordx4 v[216:219], v1, s[4:7], s61 offen offset:2048
    buffer_load_dwordx4 v[220:223], v1, s[4:7], s61 offen offset:3072
    s_add_u32 s61, s22, 28672
    buffer_load_dwordx4 v[224:227], v1, s[4:7], s61 offen offset:0
    buffer_load_dwordx4 v[228:231], v1, s[4:7], s61 offen offset:1024
    buffer_load_dwordx4 v[232:235], v1, s[4:7], s61 offen offset:2048
    buffer_load_dwordx4 v[236:239], v1, s[4:7], s61 offen offset:3072
    s_add_u32 s61, s22, 32768
    buffer_load_dwordx4 v[240:243], v1, s[4:7], s61 offen offset:0
    buffer_load_dwordx4 v[244:247], v1, s[4:7], s61 offen offset:1024
    buffer_load_dwordx4 v[248:251], v1, s[4:7], s61 offen offset:2048
    buffer_load_dwordx4 v[252:255], v1, s[4:7], s61 offen offset:3072
    s_branch L_OB_e
L_OB_c:
    v_lshlrev_b32 v24, 16, v16
    v_and_b32 v25, 0xffff0000, v16
    v_lshlrev_b32 v26, 16, v17
    v_and_b32 v27, 0xffff0000, v17
    v_lshlrev_b32 v28, 16, v18
    v_and_b32 v29, 0xffff0000, v18
    v_lshlrev_b32 v30, 16, v19
    v_and_b32 v31, 0xffff0000, v19
    v_lshlrev_b32 v32, 16, v20
    v_and_b32 v33, 0xffff0000, v20
    v_lshlrev_b32 v34, 16, v21
    v_and_b32 v35, 0xffff0000, v21
    v_lshlrev_b32 v36, 16, v22
    v_and_b32 v37, 0xffff0000, v22
    v_lshlrev_b32 v38, 16, v23
    v_and_b32 v39, 0xffff0000, v23
    s_barrier
    ds_read_b128 v[56:59], v1 offset:0
    ds_read_b128 v[60:63], v1 offset:1024
    ds_read_b128 v[64:67], v1 offset:2048
    ds_read_b128 v[68:71], v1 offset:3072
    ds_read_b128 v[72:75], v1 offset:4096
    ds_read_b128 v[76:79], v1 offset:5120
    ds_read_b128 v[80:83], v1 offset:6144
    ds_read_b128 v[84:87], v1 offset:7168
    s_waitcnt lgkmcnt(7)
    v_mfma_f32_32x32x16_bf16 v[24:39], v[112:115], v[56:59], v[24:39]
    ds_read_b128 v[56:59], v1 offset:8192
    s_waitcnt lgkmcnt(7)
    v_mfma_f32_32x32x16_bf16 v[24:39], v[116:119], v[60:63], v[24:39]
    ds_read_b128 v[60:63], v1 offset:9216
    s_waitcnt lgkmcnt(7)
    v_mfma_f32_32x32x16_bf16 v[24:39], v[120:123], v[64:67], v[24:39]
    ds_read_b128 v[64:67], v1 offset:10240
    s_waitcnt lgkmcnt(7)
    v_mfma_f32_32x32x16_bf16 v[24:39], v[124:127], v[68:71], v[24:39]
    ds_read_b128 v[68:71], v1 offset:11264
    s_waitcnt lgkmcnt(7)
    v_mfma_f32_32x32x16_bf16 v[24:39], v[128:131], v[72:75], v[24:39]
    s_barrier
    ds_read_b128 v[72:75], v1 offset:12288
    s_waitcnt lgkmcnt(7)
    v_mfma_f32_32x32x16_bf16 v[24:39], v[132:135], v[76:79], v[24:39]
    ds_read_b128 v[76:79], v1 offset:13312
    s_waitcnt lgkmcnt(7)
    v_mfma_f32_32x32x16_bf16 v[24:39], v[136:139], v[80:83], v[24:39]
    ds_read_b128 v[80:83], v1 offset:14336
    s_waitcnt lgkmcnt(7)
    v_mfma_f32_32x32x16_bf16 v[24:39], v[140:143], v[84:87], v[24:39]
    ds_read_b128 v[84:87], v1 offset:15360
    s_waitcnt lgkmcnt(7)
    v_mfma_f32_32x32x16_bf16 v[24:39], v[144:147], v[56:59], v[24:39]
    ds_read_b128 v[56:59], v1 offset:16384
    s_waitcnt lgkmcnt(7)
    v_mfma_f32_32x32x16_bf16 v[24:39], v[148:151], v[60:63], v[24:39]
    ds_read_b128 v[60:63], v1 offset:17408
    s_waitcnt lgkmcnt(7)
    v_mfma_f32_32x32x16_bf16 v[24:39], v[152:155], v[64:67], v[24:39]
    ds_read_b128 v[64:67], v1 offset:18432
    s_waitcnt lgkmcnt(7)
    v_mfma_f32_32x32x16_bf16 v[24:39], v[156:159], v[68:71], v[24:39]
    ds_read_b128 v[68:71], v1 offset:19456
    s_waitcnt lgkmcnt(7)
    v_mfma_f32_32x32x16_bf16 v[24:39], v[160:163], v[72:75], v[24:39]
    ds_read_b128 v[72:75], v1 offset:20480
    s_waitcnt lgkmcnt(7)
    v_mfma_f32_32x32x16_bf16 v[24:39], v[164:167], v[76:79], v[24:39]
    ds_read_b128 v[76:79], v1 offset:21504
    s_waitcnt lgkmcnt(7)
    v_mfma_f32_32x32x16_bf16 v[24:39], v[168:171], v[80:83], v[24:39]
    ds_read_b128 v[80:83], v1 offset:22528
    s_waitcnt lgkmcnt(7)
    v_mfma_f32_32x32x16_bf16 v[24:39], v[172:175], v[84:87], v[24:39]
    ds_read_b128 v[84:87], v1 offset:23552
    s_waitcnt lgkmcnt(7)
    v_mfma_f32_32x32x16_bf16 v[24:39], v[176:179], v[56:59], v[24:39]
    s_barrier
    ds_read_b128 v[56:59], v1 offset:24576
    s_waitcnt lgkmcnt(7)
    v_mfma_f32_32x32x16_bf16 v[24:39], v[180:183], v[60:63], v[24:39]
    ds_read_b128 v[60:63], v1 offset:25600
    s_waitcnt lgkmcnt(7)
    v_mfma_f32_32x32x16_bf16 v[24:39], v[184:187], v[64:67], v[24:39]
    ds_read_b128 v[64:67], v1 offset:26624
    s_waitcnt lgkmcnt(7)
    v_mfma_f32_32x32x16_bf16 v[24:39], v[188:191], v[68:71], v[24:39]
    ds_read_b128 v[68:71], v1 offset:27648
    s_waitcnt lgkmcnt(7)
    v_mfma_f32_32x32x16_bf16 v[24:39], v[192:195], v[72:75], v[24:39]
    ds_read_b128 v[72:75], v1 offset:28672
    s_waitcnt lgkmcnt(7)
    v_mfma_f32_32x32x16_bf16 v[24:39], v[196:199], v[76:79], v[24:39]
    ds_read_b128 v[76:79], v1 offset:29696
    s_waitcnt lgkmcnt(7)
    v_mfma_f32_32x32x16_bf16 v[24:39], v[200:203], v[80:83], v[24:39]
    s_waitcnt vmcnt(0)
    ds_read_b128 v[80:83], v1 offset:30720
    s_waitcnt lgkmcnt(7)
    v_mfma_f32_32x32x16_bf16 v[24:39], v[204:207], v[84:87], v[24:39]
    ds_read_b128 v[84:87], v1 offset:31744
    s_waitcnt lgkmcnt(7)
    v_mfma_f32_32x32x16_bf16 v[24:39], v[208:211], v[56:59], v[24:39]
    ds_read_b128 v[56:59], v1 offset:32768
    s_waitcnt lgkmcnt(7)
    v_mfma_f32_32x32x16_bf16 v[24:39], v[212:215], v[60:63], v[24:39]
    ds_read_b128 v[60:63], v1 offset:33792
    s_waitcnt lgkmcnt(7)
    v_mfma_f32_32x32x16_bf16 v[24:39], v[216:219], v[64:67], v[24:39]
    ds_read_b128 v[64:67], v1 offset:34816
    s_waitcnt lgkmcnt(7)
    v_mfma_f32_32x32x16_bf16 v[24:39], v[220:223], v[68:71], v[24:39]
    ds_read_b128 v[68:71], v1 offset:35840
    s_waitcnt lgkmcnt(7)
    v_mfma_f32_32x32x16_bf16 v[24:39], v[224:227], v[72:75], v[24:39]
    s_waitcnt lgkmcnt(6)
    v_mfma_f32_32x32x16_bf16 v[24:39], v[228:231], v[76:79], v[24:39]
    s_waitcnt lgkmcnt(5)
    v_mfma_f32_32x32x16_bf16 v[24:39], v[232:235], v[80:83], v[24:39]
    s_waitcnt lgkmcnt(4)
    v_mfma_f32_32x32x16_bf16 v[24:39], v[236:239], v[84:87], v[24:39]
    s_waitcnt lgkmcnt(3)
    v_mfma_f32_32x32x16_bf16 v[24:39], v[240:243], v[56:59], v[24:39]
    s_waitcnt lgkmcnt(2)
    v_mfma_f32_32x32x16_bf16 v[24:39], v[244:247], v[60:63], v[24:39]
    s_waitcnt lgkmcnt(1)
    v_mfma_f32_32x32x16_bf16 v[24:39], v[248:251], v[64:67], v[24:39]
    s_waitcnt lgkmcnt(0)
    v_mfma_f32_32x32x16_bf16 v[24:39], v[252:255], v[68:71], v[24:39]
    s_mul_i32 s26, s42, 36864
    s_lshl_b32 s27, s43, 11
    s_add_u32 s26, s26, s27
    s_add_u32 s26, s26, 0x600000
    s_mul_i32 s27, s42, 4608
    s_lshl_b32 s28, s43, 8
    s_add_u32 s27, s27, s28
    s_add_u32 s27, s27, 0xa80000
    v_lshrrev_b32 v8, 2, v1
    s_nop 3
    v_cvt_pk_bf16_f32 v16, v24, v25
    v_cvt_pk_bf16_f32 v17, v26, v27
    v_cvt_pk_bf16_f32 v18, v28, v29
    v_cvt_pk_bf16_f32 v19, v30, v31
    v_cvt_pk_bf16_f32 v20, v32, v33
    v_cvt_pk_bf16_f32 v21, v34, v35
    v_cvt_pk_bf16_f32 v22, v36, v37
    v_cvt_pk_bf16_f32 v23, v38, v39
    s_cmp_eq_u32 s15, 1
    s_cbranch_scc1 L_final
    s_cmp_eq_u32 s99, 1
    s_cbranch_scc1 Ls_91
    buffer_store_dwordx4 v[16:19], v1, s[4:7], s26 offen sc1
    buffer_store_dwordx4 v[20:23], v1, s[4:7], s26 offen offset:1024 sc1
    s_branch Lse_92
Ls_91:
    buffer_store_dwordx4 v[16:19], v1, s[4:7], s26 offen
    buffer_store_dwordx4 v[20:23], v1, s[4:7], s26 offen offset:1024
Lse_92:
    v_dot2_f32_bf16 v4, v16, s60, 0
    v_dot2_f32_bf16 v5, v16, v16, 0
    v_dot2_f32_bf16 v6, v17, s60, 0
    v_dot2_f32_bf16 v7, v17, v17, 0
    v_dot2_f32_bf16 v4, v18, s60, v4
    v_dot2_f32_bf16 v5, v18, v18, v5
    v_dot2_f32_bf16 v6, v19, s60, v6
    v_dot2_f32_bf16 v7, v19, v19, v7
    v_dot2_f32_bf16 v4, v20, s60, v4
    v_dot2_f32_bf16 v5, v20, v20, v5
    v_dot2_f32_bf16 v6, v21, s60, v6
    v_dot2_f32_bf16 v7, v21, v21, v7
    v_dot2_f32_bf16 v4, v22, s60, v4
    v_dot2_f32_bf16 v5, v22, v22, v5
    v_dot2_f32_bf16 v6, v23, s60, v6
    v_dot2_f32_bf16 v7, v23, v23, v7
    s_nop 2
    v_add_f32 v4, v4, v6
    v_add_f32 v5, v5, v7
    s_nop 1
    v_permlane32_swap_b32 v4, v5
    s_nop 1
    v_add_f32 v4, v4, v5
    s_cmp_eq_u32 s99, 1
    s_cbranch_scc1 Ls_93
    buffer_store_dword v4, v8, s[4:7], s27 offen sc1
    s_branch Lse_94
Ls_93:
    buffer_store_dword v4, v8, s[4:7], s27 offen
Lse_94:
    s_waitcnt vmcnt(0)
L_OB_e:
    s_cmp_eq_u32 s15, 1
    s_cbranch_scc1 L_fin2
    s_barrier
    s_cmp_lg_u32 s3, 0
    s_cbranch_scc1 L_OB_nf
    s_lshl_b32 s22, s42, 9
    s_lshr_b32 s23, s13, 3
    s_lshl_b32 s23, s23, 7
    s_add_u32 s22, s22, s23
    s_add_u32 s22, s22, 0x510030
    s_mov_b64 exec, 1
    s_cmp_eq_u32 s99, 1
    s_cbranch_scc1 Ls_95
    buffer_store_dword v14, off, s[16:19], s22 sc1
    s_branch Lse_96
Ls_95:
    buffer_store_dword v14, off, s[16:19], s22
Lse_96:
    s_mov_b64 exec, -1
L_OB_nf:
    s_mov_b32 s15, 1
    s_mov_b32 s33, 0x27fe0
    s_add_u32 s16, s16, 0x20
    s_addc_u32 s17, s17, 0
    s_branch L_it
L_final:
    v_mul_u32_u24 v4, 1152, v2
    v_lshl_add_u32 v4, v3, 4, v4
    s_mul_i32 s24, s42, 36864
    s_lshl_b32 s25, s43, 6
    s_add_u32 s24, s24, s25
    buffer_store_dwordx4 v[16:19], v4, s[8:11], s24 offen offset:0
    buffer_store_dwordx4 v[20:23], v4, s[8:11], s24 offen offset:32
L_fin2:
L_end:
    s_endpgm
L_defer:
    s_cmp_eq_u32 s15, 0
    s_cbranch_scc0 L_ret
    buffer_store_dwordx4 v[16:19], v1, s[4:7], s100 offen sc1
    s_add_u32 s100, s100, s101
    buffer_store_dwordx4 v[20:23], v1, s[4:7], s100 offen sc1
    s_cmp_lt_u32 s2, 180
    s_cbranch_scc1 L_ret
    s_cmp_ge_u32 s3, 2
    s_cbranch_scc1 L_ret
    s_add_u32 s100, s100, s101
    buffer_store_dwordx4 v[112:115], v1, s[4:7], s100 offen sc1
L_ret:
    s_setpc_b64 s[30:31]
L_A_warm:
    s_mul_i32 s24, s13, 20736
    s_add_u32 s24, s24, 0x1000000
    buffer_load_dword v100, v11, s[4:7], s24 offen
    s_add_u32 s24, s24, 8192
    buffer_load_dword v101, v11, s[4:7], s24 offen
    s_add_u32 s24, s24, 8192
    buffer_load_dword v102, v11, s[4:7], s24 offen
    s_add_u32 s24, s24, 8192
    s_cmp_eq_u32 s15, 0
    s_cbranch_scc0 L_ret
    s_mul_i32 s24, s13, 29952
    s_add_u32 s24, s24, 0xb00000
    buffer_load_dword v104, v11, s[4:7], s24 offen
    s_add_u32 s24, s24, 8192
    buffer_load_dword v105, v11, s[4:7], s24 offen
    s_add_u32 s24, s24, 8192
    buffer_load_dword v106, v11, s[4:7], s24 offen
    s_add_u32 s24, s24, 8192
    buffer_load_dword v107, v11, s[4:7], s24 offen
    s_add_u32 s24, s24, 8192
    s_setpc_b64 s[30:31]
L_A_cs:
    v_lshlrev_b32 v45, 7, v2
    s_lshl_b32 s22, s12, 12
    s_add_u32 s22, s22, 0x510014
    buffer_load_dword v44, v45, s[4:7], s22 offen sc1
    v_dot2_f32_bf16 v106, v112, s60, 0
    v_dot2_f32_bf16 v107, v113, s60, 0
    v_dot2_f32_bf16 v108, v114, s60, 0
    v_dot2_f32_bf16 v109, v115, s60, 0
    v_dot2_f32_bf16 v106, v116, s60, v106
    v_dot2_f32_bf16 v107, v117, s60, v107
    v_dot2_f32_bf16 v108, v118, s60, v108
    v_dot2_f32_bf16 v109, v119, s60, v109
    v_dot2_f32_bf16 v106, v120, s60, v106
    v_dot2_f32_bf16 v107, v121, s60, v107
    v_dot2_f32_bf16 v108, v122, s60, v108
    v_dot2_f32_bf16 v109, v123, s60, v109
    v_dot2_f32_bf16 v106, v124, s60, v106
    v_dot2_f32_bf16 v107, v125, s60, v107
    v_dot2_f32_bf16 v108, v126, s60, v108
    v_dot2_f32_bf16 v109, v127, s60, v109
    v_dot2_f32_bf16 v106, v128, s60, v106
    v_dot2_f32_bf16 v107, v129, s60, v107
    v_dot2_f32_bf16 v108, v130, s60, v108
    v_dot2_f32_bf16 v109, v131, s60, v109
    v_dot2_f32_bf16 v106, v132, s60, v106
    v_dot2_f32_bf16 v107, v133, s60, v107
    v_dot2_f32_bf16 v108, v134, s60, v108
    v_dot2_f32_bf16 v109, v135, s60, v109
    v_dot2_f32_bf16 v106, v136, s60, v106
    v_dot2_f32_bf16 v107, v137, s60, v107
    v_dot2_f32_bf16 v108, v138, s60, v108
    v_dot2_f32_bf16 v109, v139, s60, v109
    v_dot2_f32_bf16 v106, v140, s60, v106
    v_dot2_f32_bf16 v107, v141, s60, v107
    v_dot2_f32_bf16 v108, v142, s60, v108
    v_dot2_f32_bf16 v109, v143, s60, v109
    v_dot2_f32_bf16 v106, v144, s60, v106
    v_dot2_f32_bf16 v107, v145, s60, v107
    v_dot2_f32_bf16 v108, v146, s60, v108
    v_dot2_f32_bf16 v109, v147, s60, v109
    v_dot2_f32_bf16 v106, v148, s60, v106
    v_dot2_f32_bf16 v107, v149, s60, v107
    v_dot2_f32_bf16 v108, v150, s60, v108
    v_dot2_f32_bf16 v109, v151, s60, v109
    v_dot2_f32_bf16 v106, v152, s60, v106
    v_dot2_f32_bf16 v107, v153, s60, v107
    v_dot2_f32_bf16 v108, v154, s60, v108
    v_dot2_f32_bf16 v109, v155, s60, v109
    v_dot2_f32_bf16 v106, v156, s60, v106
    v_dot2_f32_bf16 v107, v157, s60, v107
    v_dot2_f32_bf16 v108, v158, s60, v108
    v_dot2_f32_bf16 v109, v159, s60, v109
    v_dot2_f32_bf16 v106, v160, s60, v106
    v_dot2_f32_bf16 v107, v161, s60, v107
    v_dot2_f32_bf16 v108, v162, s60, v108
    v_dot2_f32_bf16 v109, v163, s60, v109
    v_dot2_f32_bf16 v106, v164, s60, v106
    v_dot2_f32_bf16 v107, v165, s60, v107
    v_dot2_f32_bf16 v108, v166, s60, v108
    v_dot2_f32_bf16 v109, v167, s60, v109
    v_dot2_f32_bf16 v106, v168, s60, v106
    v_dot2_f32_bf16 v107, v169, s60, v107
    v_dot2_f32_bf16 v108, v170, s60, v108
    v_dot2_f32_bf16 v109, v171, s60, v109
    v_dot2_f32_bf16 v106, v172, s60, v106
    v_dot2_f32_bf16 v107, v173, s60, v107
    v_dot2_f32_bf16 v108, v174, s60, v108
    v_dot2_f32_bf16 v109, v175, s60, v109
    v_dot2_f32_bf16 v106, v176, s60, v106
    v_dot2_f32_bf16 v107, v177, s60, v107
    v_dot2_f32_bf16 v108, v178, s60, v108
    v_dot2_f32_bf16 v109, v179, s60, v109
    v_dot2_f32_bf16 v106, v180, s60, v106
    v_dot2_f32_bf16 v107, v181, s60, v107
    v_dot2_f32_bf16 v108, v182, s60, v108
    v_dot2_f32_bf16 v109, v183, s60, v109
    v_dot2_f32_bf16 v106, v184, s60, v106
    v_dot2_f32_bf16 v107, v185, s60, v107
    v_dot2_f32_bf16 v108, v186, s60, v108
    v_dot2_f32_bf16 v109, v187, s60, v109
    v_dot2_f32_bf16 v106, v188, s60, v106
    v_dot2_f32_bf16 v107, v189, s60, v107
    v_dot2_f32_bf16 v108, v190, s60, v108
    v_dot2_f32_bf16 v109, v191, s60, v109
    v_dot2_f32_bf16 v106, v192, s60, v106
    v_dot2_f32_bf16 v107, v193, s60, v107
    v_dot2_f32_bf16 v108, v194, s60, v108
    v_dot2_f32_bf16 v109, v195, s60, v109
    v_dot2_f32_bf16 v106, v196, s60, v106
    v_dot2_f32_bf16 v107, v197, s60, v107
    v_dot2_f32_bf16 v108, v198, s60, v108
    v_dot2_f32_bf16 v109, v199, s60, v109
    v_dot2_f32_bf16 v106, v200, s60, v106
    v_dot2_f32_bf16 v107, v201, s60, v107
    v_dot2_f32_bf16 v108, v202, s60, v108
    v_dot2_f32_bf16 v109, v203, s60, v109
    v_dot2_f32_bf16 v106, v204, s60, v106
    v_dot2_f32_bf16 v107, v205, s60, v107
    v_dot2_f32_bf16 v108, v206, s60, v108
    v_dot2_f32_bf16 v109, v207, s60, v109
    v_dot2_f32_bf16 v106, v208, s60, v106
    v_dot2_f32_bf16 v107, v209, s60, v107
    v_dot2_f32_bf16 v108, v210, s60, v108
    v_dot2_f32_bf16 v109, v211, s60, v109
    v_dot2_f32_bf16 v106, v212, s60, v106
    v_dot2_f32_bf16 v107, v213, s60, v107
    v_dot2_f32_bf16 v108, v214, s60, v108
    v_dot2_f32_bf16 v109, v215, s60, v109
    v_dot2_f32_bf16 v106, v216, s60, v106
    v_dot2_f32_bf16 v107, v217, s60, v107
    v_dot2_f32_bf16 v108, v218, s60, v108
    v_dot2_f32_bf16 v109, v219, s60, v109
    v_dot2_f32_bf16 v106, v220, s60, v106
    v_dot2_f32_bf16 v107, v221, s60, v107
    v_dot2_f32_bf16 v108, v222, s60, v108
    v_dot2_f32_bf16 v109, v223, s60, v109
    v_dot2_f32_bf16 v106, v224, s60, v106
    v_dot2_f32_bf16 v107, v225, s60, v107
    v_dot2_f32_bf16 v108, v226, s60, v108
    v_dot2_f32_bf16 v109, v227, s60, v109
    v_dot2_f32_bf16 v106, v228, s60, v106
    v_dot2_f32_bf16 v107, v229, s60, v107
    v_dot2_f32_bf16 v108, v230, s60, v108
    v_dot2_f32_bf16 v109, v231, s60, v109
    v_dot2_f32_bf16 v106, v232, s60, v106
    v_dot2_f32_bf16 v107, v233, s60, v107
    v_dot2_f32_bf16 v108, v234, s60, v108
    v_dot2_f32_bf16 v109, v235, s60, v109
    v_dot2_f32_bf16 v106, v236, s60, v106
    v_dot2_f32_bf16 v107, v237, s60, v107
    v_dot2_f32_bf16 v108, v238, s60, v108
    v_dot2_f32_bf16 v109, v239, s60, v109
    v_dot2_f32_bf16 v106, v240, s60, v106
    v_dot2_f32_bf16 v107, v241, s60, v107
    v_dot2_f32_bf16 v108, v242, s60, v108
    v_dot2_f32_bf16 v109, v243, s60, v109
    v_dot2_f32_bf16 v106, v244, s60, v106
    v_dot2_f32_bf16 v107, v245, s60, v107
    v_dot2_f32_bf16 v108, v246, s60, v108
    v_dot2_f32_bf16 v109, v247, s60, v109
    v_dot2_f32_bf16 v106, v248, s60, v106
    v_dot2_f32_bf16 v107, v249, s60, v107
    v_dot2_f32_bf16 v108, v250, s60, v108
    v_dot2_f32_bf16 v109, v251, s60, v109
    v_dot2_f32_bf16 v106, v252, s60, v106
    v_dot2_f32_bf16 v107, v253, s60, v107
    v_dot2_f32_bf16 v108, v254, s60, v108
    v_dot2_f32_bf16 v109, v255, s60, v109
    s_nop 2
    v_add_f32 v106, v106, v107
    v_add_f32 v108, v108, v109
    v_add_f32 v106, v106, v108
    v_cvt_pk_bf16_f32 v110, v106, v106
    v_lshlrev_b32 v110, 16, v110
    v_sub_f32 v106, v106, v110
    v_cvt_pk_bf16_f32 v110, v110, v106
    s_setpc_b64 s[30:31]
L_A_pflag:
    s_cmp_eq_u32 s15, 0
    s_cbranch_scc0 L_ret
    s_cmp_lt_u32 s2, 36
    s_cbranch_scc1 L_ret
    s_lshl_b32 s22, s2, 7
    s_add_u32 s22, s22, 0x10c0000
    s_mov_b64 exec, 1
    buffer_store_dword v14, off, s[4:7], s22 sc1
    s_mov_b64 exec, -1
    s_setpc_b64 s[30:31]
L_A_fetch:
    s_waitcnt vmcnt(0)
    v_cmp_ne_u32 vcc, s14, v12
    s_cbranch_vccz L_A_fetch2
    s_lshl_b32 s23, s47, 11
    s_add_u32 s23, s23, 0x518000
    s_mov_b32 exec_lo, 0xffff
    s_mov_b32 exec_hi, 0x0
    s_mov_b32 s21, 0
Lp_100001:
    buffer_load_dword v4, v11, s[16:19], s23 offen sc1
    s_add_u32 s21, s21, 1
    s_cmp_gt_u32 s21, s20
    s_cselect_b32 s20, 0, s20
    s_waitcnt vmcnt(0)
    s_cbranch_scc1 Lpd_100002
    v_cmp_ne_u32 vcc, s14, v4
    s_cbranch_vccnz Lp_100001
Lpd_100002:
    s_mov_b64 exec, -1
L_A_fetch2:
    s_mul_i32 s22, s47, 18944
    s_add_u32 s22, s22, s33
    s_mul_i32 m0, s3, 18944
    s_nop 0
    buffer_load_dwordx4 v1, s[16:19], s22 offen sc1 lds
    s_add_u32 m0, m0, 1024
    s_add_u32 s22, s22, 1024
    s_nop 0
    buffer_load_dwordx4 v1, s[16:19], s22 offen sc1 lds
    s_add_u32 m0, m0, 1024
    s_add_u32 s22, s22, 1024
    s_nop 0
    buffer_load_dwordx4 v1, s[16:19], s22 offen sc1 lds
    s_add_u32 m0, m0, 1024
    s_add_u32 s22, s22, 1024
    s_nop 0
    buffer_load_dwordx4 v1, s[16:19], s22 offen sc1 lds
    s_add_u32 m0, m0, 1024
    s_add_u32 s22, s22, 1024
    s_nop 0
    buffer_load_dwordx4 v1, s[16:19], s22 offen sc1 lds
    s_add_u32 m0, m0, 1024
    s_add_u32 s22, s22, 1024
    s_nop 0
    buffer_load_dwordx4 v1, s[16:19], s22 offen sc1 lds
    s_add_u32 m0, m0, 1024
    s_add_u32 s22, s22, 1024
    s_nop 0
    buffer_load_dwordx4 v1, s[16:19], s22 offen sc1 lds
    s_add_u32 m0, m0, 1024
    s_add_u32 s22, s22, 1024
    s_nop 0
    buffer_load_dwordx4 v1, s[16:19], s22 offen sc1 lds
    s_add_u32 m0, m0, 1024
    s_add_u32 s22, s22, 1024
    s_nop 0
    buffer_load_dwordx4 v1, s[16:19], s22 offen sc1 lds
    s_add_u32 m0, m0, 1024
    s_add_u32 s22, s22, 1024
    s_nop 0
    buffer_load_dwordx4 v1, s[16:19], s22 offen sc1 lds
    s_add_u32 m0, m0, 1024
    s_add_u32 s22, s22, 1024
    s_nop 0
    buffer_load_dwordx4 v1, s[16:19], s22 offen sc1 lds
    s_add_u32 m0, m0, 1024
    s_add_u32 s22, s22, 1024
    s_nop 0
    buffer_load_dwordx4 v1, s[16:19], s22 offen sc1 lds
    s_add_u32 m0, m0, 1024
    s_add_u32 s22, s22, 1024
    s_nop 0
    buffer_load_dwordx4 v1, s[16:19], s22 offen sc1 lds
    s_add_u32 m0, m0, 1024
    s_add_u32 s22, s22, 1024
    s_nop 0
    buffer_load_dwordx4 v1, s[16:19], s22 offen sc1 lds
    s_add_u32 m0, m0, 1024
    s_add_u32 s22, s22, 1024
    s_nop 0
    buffer_load_dwordx4 v1, s[16:19], s22 offen sc1 lds
    s_add_u32 m0, m0, 1024
    s_add_u32 s22, s22, 1024
    s_nop 0
    buffer_load_dwordx4 v1, s[16:19], s22 offen sc1 lds
    s_add_u32 m0, m0, 1024
    s_add_u32 s22, s22, 1024
    s_nop 0
    buffer_load_dwordx4 v1, s[16:19], s22 offen sc1 lds
    s_add_u32 m0, m0, 1024
    s_add_u32 s22, s22, 1024
    s_nop 0
    buffer_load_dwordx4 v1, s[16:19], s22 offen sc1 lds
    s_add_u32 m0, m0, 1024
    s_add_u32 s22, s22, 1024
    s_mov_b32 exec_hi, 0
    buffer_load_dwordx4 v1, s[16:19], s22 offen sc1 lds
    s_mov_b64 exec, -1
    s_cmp_ge_u32 s3, 3
    s_cbranch_scc1 L_defer
    s_setpc_b64 s[30:31]
L_A_check0:
    s_cmp_eq_u32 s15, 0
    s_cbranch_scc0 L_ret
    s_mov_b32 s22, 0x10c0000
    buffer_load_dword v104, v11, s[4:7], s22 offen sc1
    s_add_u32 s61, s22, 8192
    buffer_load_dword v105, v11, s[4:7], s61 offen sc1
    s_add_u32 s61, s22, 16384
    buffer_load_dword v106, v11, s[4:7], s61 offen sc1
    s_add_u32 s61, s22, 24576
    buffer_load_dword v107, v11, s[4:7], s61 offen sc1
    v_lshlrev_b32 v109, 7, v2
    s_lshl_b32 s22, s12, 12
    s_add_u32 s22, s22, 0x510014
    buffer_load_dword v108, v109, s[4:7], s22 offen sc1
    s_setpc_b64 s[30:31]
L_A_check:
    s_cmp_eq_u32 s15, 0
    s_cbranch_scc0 L_ret
    s_waitcnt vmcnt(0)
    v_cmp_ne_u32 vcc, s14, v104
    v_cmp_ne_u32 s[62:63], s14, v105
    s_or_b64 vcc, vcc, s[62:63]
    v_cmp_ne_u32 s[62:63], s14, v106
    s_or_b64 vcc, vcc, s[62:63]
    v_cmp_ne_u32 s[62:63], s14, v107
    s_or_b64 vcc, vcc, s[62:63]
    s_cbranch_vccz L_A_check2
    s_mov_b32 s22, 0x10c0000
    s_mov_b32 s21, 0
Lp_100003:
    buffer_load_dword v4, v11, s[4:7], s22 offen sc1
    s_add_u32 s61, s22, 8192
    buffer_load_dword v5, v11, s[4:7], s61 offen sc1
    s_add_u32 s61, s22, 16384
    buffer_load_dword v6, v11, s[4:7], s61 offen sc1
    s_add_u32 s61, s22, 24576
    buffer_load_dword v7, v11, s[4:7], s61 offen sc1
    s_add_u32 s21, s21, 1
    s_cmp_gt_u32 s21, s20
    s_cselect_b32 s20, 0, s20
    s_waitcnt vmcnt(0)
    s_cbranch_scc1 Lpd_100004
    v_cmp_ne_u32 vcc, s14, v4
    v_cmp_ne_u32 s[62:63], s14, v5
    s_or_b64 vcc, vcc, s[62:63]
    v_cmp_ne_u32 s[62:63], s14, v6
    s_or_b64 vcc, vcc, s[62:63]
    v_cmp_ne_u32 s[62:63], s14, v7
    s_or_b64 vcc, vcc, s[62:63]
    s_cbranch_vccnz Lp_100003
Lpd_100004:
L_A_check2:
    v_cmp_ne_u32 vcc, s34, v108
    s_cmp_eq_u64 vcc, 0
    s_cselect_b32 s22, 1, 2
    v_mov_b32 v4, s22
    v_mov_b32 v5, 162816
    ds_write_b32 v5, v4 offset:4
    s_waitcnt lgkmcnt(0)
    s_setpc_b64 s[30:31]
L_A_touch0:
    s_cmp_eq_u32 s15, 0
    s_cbranch_scc0 L_ret
    s_mov_b32 s22, 0x10c0000
    buffer_load_dword v100, v11, s[4:7], s22 offen sc1
    s_add_u32 s61, s22, 8192
    buffer_load_dword v101, v11, s[4:7], s61 offen sc1
    s_add_u32 s61, s22, 16384
    buffer_load_dword v102, v11, s[4:7], s61 offen sc1
    s_add_u32 s61, s22, 24576
    buffer_load_dword v103, v11, s[4:7], s61 offen sc1
    s_setpc_b64 s[30:31]
L_A_touch:
    s_cmp_eq_u32 s15, 0
    s_cbranch_scc0 L_ret
    s_lshl_b32 s22, s13, 6
    s_lshl_b32 s23, s12, 3
    s_add_u32 s22, s22, s23
    s_add_u32 s22, s22, s3
    s_lshl_b32 s23, s22, 7
    s_add_u32 s23, s23, 0x520000
    s_mul_i32 s22, s22, 2368
    s_add_u32 s22, s22, 0x60000
    s_mov_b32 exec_lo, 0xfffff
    s_mov_b32 exec_hi, 0x0
    buffer_load_dword v100, v11, s[16:19], s22 offen sc1
    s_mov_b64 exec, 1
    buffer_load_dword v100, off, s[16:19], s23 sc1
    s_mov_b64 exec, -1
    s_mul_i32 s22, s45, 36864
    s_add_u32 s22, s22, 0x840000
    s_lshl_b32 s23, s46, 10
    s_add_u32 s23, s23, s22
    buffer_load_dwordx4 v[100:103], v1, s[4:7], s23 offen sc1
    s_lshr_b32 s23, s46, 3
    s_lshl_b32 s23, s23, 10
    s_add_u32 s23, s23, s22
    s_add_u32 s23, s23, 32768
    buffer_load_dwordx4 v[100:103], v1, s[4:7], s23 offen sc1
    s_cmp_ge_u32 s3, s44
    s_cbranch_scc1 L_ret
    s_mul_i32 s22, s42, 36864
    s_lshl_b32 s23, s43, 6
    s_add_u32 s22, s22, s23
    v_mul_u32_u24 v5, 1152, v2
    v_lshl_add_u32 v5, v3, 4, v5
    buffer_load_dwordx4 v[16:19], v5, s[52:55], s22 offen
    buffer_load_dwordx4 v[20:23], v5, s[52:55], s22 offen offset:32
    s_mul_i32 s22, s42, 36864
    s_lshl_b32 s23, s43, 11
    s_add_u32 s22, s22, s23
    s_add_u32 s22, s22, 0x600000
    buffer_load_dwordx4 v[100:103], v1, s[4:7], s22 offen sc1
    buffer_load_dwordx4 v[100:103], v1, s[4:7], s22 offen offset:1024 sc1
    s_mul_i32 s22, s42, 4608
    s_lshl_b32 s23, s43, 8
    s_add_u32 s22, s22, s23
    s_add_u32 s22, s22, 0xa80000
    v_lshrrev_b32 v4, 2, v1
    buffer_load_dword v100, v4, s[4:7], s22 offen sc1
    s_setpc_b64 s[30:31]
L_A_slow:
    v_mov_b32 v8, v1
    v_lshlrev_b32 v9, 8, v3
    v_lshl_add_u32 v9, v2, 3, v9
    v_mov_b32 v7, 0xff800000
    s_mov_b32 s41, 0
L_A_slow0:
    ds_read_b64 v[88:89], v9 offset:4096
    ds_read_b128 v[84:87], v8 offset:0
    s_waitcnt lgkmcnt(0)
    s_nop 1
    v_mfma_f32_32x32x16_bf16 v[36:51], v[84:87], v[24:27], 0
    v_mfma_f32_32x32x8_bf16 v[36:51], v[88:89], v[28:29], v[36:51]
    s_nop 12
    v_max3_f32 v7, v36, v37, v7
    v_max3_f32 v7, v38, v39, v7
    v_max3_f32 v7, v40, v41, v7
    v_max3_f32 v7, v42, v43, v7
    v_max3_f32 v7, v44, v45, v7
    v_max3_f32 v7, v46, v47, v7
    v_max3_f32 v7, v48, v49, v7
    v_max3_f32 v7, v50, v51, v7
    ds_read_b128 v[84:87], v8 offset:1024
    s_waitcnt lgkmcnt(0)
    s_nop 1
    v_mfma_f32_32x32x16_bf16 v[36:51], v[84:87], v[24:27], 0
    v_mfma_f32_32x32x8_bf16 v[36:51], v[88:89], v[30:31], v[36:51]
    s_nop 12
    v_max3_f32 v7, v36, v37, v7
    v_max3_f32 v7, v38, v39, v7
    v_max3_f32 v7, v40, v41, v7
    v_max3_f32 v7, v42, v43, v7
    v_max3_f32 v7, v44, v45, v7
    v_max3_f32 v7, v46, v47, v7
    v_max3_f32 v7, v48, v49, v7
    v_max3_f32 v7, v50, v51, v7
    ds_read_b128 v[84:87], v8 offset:2048
    s_waitcnt lgkmcnt(0)
    s_nop 1
    v_mfma_f32_32x32x16_bf16 v[36:51], v[84:87], v[24:27], 0
    v_mfma_f32_32x32x8_bf16 v[36:51], v[88:89], v[32:33], v[36:51]
    s_nop 12
    v_max3_f32 v7, v36, v37, v7
    v_max3_f32 v7, v38, v39, v7
    v_max3_f32 v7, v40, v41, v7
    v_max3_f32 v7, v42, v43, v7
    v_max3_f32 v7, v44, v45, v7
    v_max3_f32 v7, v46, v47, v7
    v_max3_f32 v7, v48, v49, v7
    v_max3_f32 v7, v50, v51, v7
    ds_read_b128 v[84:87], v8 offset:3072
    s_waitcnt lgkmcnt(0)
    s_nop 1
    v_mfma_f32_32x32x16_bf16 v[36:51], v[84:87], v[24:27], 0
    v_mfma_f32_32x32x8_bf16 v[36:51], v[88:89], v[34:35], v[36:51]
    s_nop 12
    v_max3_f32 v7, v36, v37, v7
    v_max3_f32 v7, v38, v39, v7
    v_max3_f32 v7, v40, v41, v7
    v_max3_f32 v7, v42, v43, v7
    v_max3_f32 v7, v44, v45, v7
    v_max3_f32 v7, v46, v47, v7
    v_max3_f32 v7, v48, v49, v7
    v_max3_f32 v7, v50, v51, v7
    v_add_u32 v8, 9472, v8
    v_add_u32 v9, 9472, v9
    v_add_u32 v10, 9472, v10
    s_add_u32 s41, s41, 1
    s_cmp_lt_u32 s41, 16
    s_cbranch_scc1 L_A_slow0
    v_mov_b32 v6, v7
    s_nop 1
    v_permlane32_swap_b32 v6, v7
    s_nop 1
    v_max_f32 v7, v6, v7
    v_mov_b32 v68, 0
    v_mov_b32 v69, 0
    v_mov_b32 v70, 0
    v_mov_b32 v71, 0
    v_mov_b32 v72, 0
    v_mov_b32 v73, 0
    v_mov_b32 v74, 0
    v_mov_b32 v75, 0
    v_mov_b32 v76, 0
    v_mov_b32 v77, 0
    v_mov_b32 v78, 0
    v_mov_b32 v79, 0
    v_mov_b32 v80, 0
    v_mov_b32 v81, 0
    v_mov_b32 v82, 0
    v_mov_b32 v83, 0
    v_mov_b32 v8, v1
    v_lshlrev_b32 v9, 8, v3
    v_lshl_add_u32 v9, v2, 3, v9
    v_mul_u32_u24 v10, 304, v3
    v_min_u32 v4, 18, v2
    v_lshl_add_u32 v10, v4, 4, v10
    v_add_u32 v10, 4608, v10
    v_cmp_ge_u32 vcc, 18, v2
    v_cmp_eq_u32 s[62:63], 28, v2
    s_or_b64 vcc, vcc, s[62:63]
    v_mov_b32 v4, 0x40000
    s_nop 0
    v_cndmask_b32 v10, v4, v10, vcc
    s_mov_b32 s41, 0
L_A_slow1:
    ds_read_b64 v[88:89], v9 offset:4096
    ds_read_b128 v[84:87], v8 offset:0
    ds_read_b128 v[92:95], v10 offset:0
    ds_read_b128 v[96:99], v10 offset:608
    s_waitcnt lgkmcnt(0)
    s_nop 1
    v_mfma_f32_32x32x16_bf16 v[36:51], v[84:87], v[24:27], 0
    v_mfma_f32_32x32x8_bf16 v[36:51], v[88:89], v[28:29], v[36:51]
    s_nop 12
    v_sub_f32 v36, v36, v7
    v_sub_f32 v37, v37, v7
    v_sub_f32 v38, v38, v7
    v_sub_f32 v39, v39, v7
    v_sub_f32 v40, v40, v7
    v_sub_f32 v41, v41, v7
    v_sub_f32 v42, v42, v7
    v_sub_f32 v43, v43, v7
    v_sub_f32 v44, v44, v7
    v_sub_f32 v45, v45, v7
    v_sub_f32 v46, v46, v7
    v_sub_f32 v47, v47, v7
    v_sub_f32 v48, v48, v7
    v_sub_f32 v49, v49, v7
    v_sub_f32 v50, v50, v7
    v_sub_f32 v51, v51, v7
    v_exp_f32 v36, v36
    v_exp_f32 v37, v37
    v_exp_f32 v38, v38
    v_exp_f32 v39, v39
    v_exp_f32 v40, v40
    v_exp_f32 v41, v41
    v_exp_f32 v42, v42
    v_exp_f32 v43, v43
    v_exp_f32 v44, v44
    v_exp_f32 v45, v45
    v_exp_f32 v46, v46
    v_exp_f32 v47, v47
    v_exp_f32 v48, v48
    v_exp_f32 v49, v49
    v_exp_f32 v50, v50
    v_exp_f32 v51, v51
    s_nop 0
    v_cvt_pk_bf16_f32 v36, v36, v37
    v_cvt_pk_bf16_f32 v37, v38, v39
    v_cvt_pk_bf16_f32 v38, v40, v41
    v_cvt_pk_bf16_f32 v39, v42, v43
    v_cvt_pk_bf16_f32 v40, v44, v45
    v_cvt_pk_bf16_f32 v41, v46, v47
    v_cvt_pk_bf16_f32 v42, v48, v49
    v_cvt_pk_bf16_f32 v43, v50, v51
    s_nop 1
    v_mfma_f32_32x32x16_bf16 v[68:83], v[92:95], v[36:39], v[68:83]
    v_mfma_f32_32x32x16_bf16 v[68:83], v[96:99], v[40:43], v[68:83]
    s_nop 7
    ds_read_b128 v[84:87], v8 offset:1024
    ds_read_b128 v[92:95], v10 offset:1216
    ds_read_b128 v[96:99], v10 offset:1824
    s_waitcnt lgkmcnt(0)
    s_nop 1
    v_mfma_f32_32x32x16_bf16 v[36:51], v[84:87], v[24:27], 0
    v_mfma_f32_32x32x8_bf16 v[36:51], v[88:89], v[30:31], v[36:51]
    s_nop 12
    v_sub_f32 v36, v36, v7
    v_sub_f32 v37, v37, v7
    v_sub_f32 v38, v38, v7
    v_sub_f32 v39, v39, v7
    v_sub_f32 v40, v40, v7
    v_sub_f32 v41, v41, v7
    v_sub_f32 v42, v42, v7
    v_sub_f32 v43, v43, v7
    v_sub_f32 v44, v44, v7
    v_sub_f32 v45, v45, v7
    v_sub_f32 v46, v46, v7
    v_sub_f32 v47, v47, v7
    v_sub_f32 v48, v48, v7
    v_sub_f32 v49, v49, v7
    v_sub_f32 v50, v50, v7
    v_sub_f32 v51, v51, v7
    v_exp_f32 v36, v36
    v_exp_f32 v37, v37
    v_exp_f32 v38, v38
    v_exp_f32 v39, v39
    v_exp_f32 v40, v40
    v_exp_f32 v41, v41
    v_exp_f32 v42, v42
    v_exp_f32 v43, v43
    v_exp_f32 v44, v44
    v_exp_f32 v45, v45
    v_exp_f32 v46, v46
    v_exp_f32 v47, v47
    v_exp_f32 v48, v48
    v_exp_f32 v49, v49
    v_exp_f32 v50, v50
    v_exp_f32 v51, v51
    s_nop 0
    v_cvt_pk_bf16_f32 v36, v36, v37
    v_cvt_pk_bf16_f32 v37, v38, v39
    v_cvt_pk_bf16_f32 v38, v40, v41
    v_cvt_pk_bf16_f32 v39, v42, v43
    v_cvt_pk_bf16_f32 v40, v44, v45
    v_cvt_pk_bf16_f32 v41, v46, v47
    v_cvt_pk_bf16_f32 v42, v48, v49
    v_cvt_pk_bf16_f32 v43, v50, v51
    s_nop 1
    v_mfma_f32_32x32x16_bf16 v[68:83], v[92:95], v[36:39], v[68:83]
    v_mfma_f32_32x32x16_bf16 v[68:83], v[96:99], v[40:43], v[68:83]
    s_nop 7
    ds_read_b128 v[84:87], v8 offset:2048
    ds_read_b128 v[92:95], v10 offset:2432
    ds_read_b128 v[96:99], v10 offset:3040
    s_waitcnt lgkmcnt(0)
    s_nop 1
    v_mfma_f32_32x32x16_bf16 v[36:51], v[84:87], v[24:27], 0
    v_mfma_f32_32x32x8_bf16 v[36:51], v[88:89], v[32:33], v[36:51]
    s_nop 12
    v_sub_f32 v36, v36, v7
    v_sub_f32 v37, v37, v7
    v_sub_f32 v38, v38, v7
    v_sub_f32 v39, v39, v7
    v_sub_f32 v40, v40, v7
    v_sub_f32 v41, v41, v7
    v_sub_f32 v42, v42, v7
    v_sub_f32 v43, v43, v7
    v_sub_f32 v44, v44, v7
    v_sub_f32 v45, v45, v7
    v_sub_f32 v46, v46, v7
    v_sub_f32 v47, v47, v7
    v_sub_f32 v48, v48, v7
    v_sub_f32 v49, v49, v7
    v_sub_f32 v50, v50, v7
    v_sub_f32 v51, v51, v7
    v_exp_f32 v36, v36
    v_exp_f32 v37, v37
    v_exp_f32 v38, v38
    v_exp_f32 v39, v39
    v_exp_f32 v40, v40
    v_exp_f32 v41, v41
    v_exp_f32 v42, v42
    v_exp_f32 v43, v43
    v_exp_f32 v44, v44
    v_exp_f32 v45, v45
    v_exp_f32 v46, v46
    v_exp_f32 v47, v47
    v_exp_f32 v48, v48
    v_exp_f32 v49, v49
    v_exp_f32 v50, v50
    v_exp_f32 v51, v51
    s_nop 0
    v_cvt_pk_bf16_f32 v36, v36, v37
    v_cvt_pk_bf16_f32 v37, v38, v39
    v_cvt_pk_bf16_f32 v38, v40, v41
    v_cvt_pk_bf16_f32 v39, v42, v43
    v_cvt_pk_bf16_f32 v40, v44, v45
    v_cvt_pk_bf16_f32 v41, v46, v47
    v_cvt_pk_bf16_f32 v42, v48, v49
    v_cvt_pk_bf16_f32 v43, v50, v51
    s_nop 1
    v_mfma_f32_32x32x16_bf16 v[68:83], v[92:95], v[36:39], v[68:83]
    v_mfma_f32_32x32x16_bf16 v[68:83], v[96:99], v[40:43], v[68:83]
    s_nop 7
    ds_read_b128 v[84:87], v8 offset:3072
    ds_read_b128 v[92:95], v10 offset:3648
    ds_read_b128 v[96:99], v10 offset:4256
    s_waitcnt lgkmcnt(0)
    s_nop 1
    v_mfma_f32_32x32x16_bf16 v[36:51], v[84:87], v[24:27], 0
    v_mfma_f32_32x32x8_bf16 v[36:51], v[88:89], v[34:35], v[36:51]
    s_nop 12
    v_sub_f32 v36, v36, v7
    v_sub_f32 v37, v37, v7
    v_sub_f32 v38, v38, v7
    v_sub_f32 v39, v39, v7
    v_sub_f32 v40, v40, v7
    v_sub_f32 v41, v41, v7
    v_sub_f32 v42, v42, v7
    v_sub_f32 v43, v43, v7
    v_sub_f32 v44, v44, v7
    v_sub_f32 v45, v45, v7
    v_sub_f32 v46, v46, v7
    v_sub_f32 v47, v47, v7
    v_sub_f32 v48, v48, v7
    v_sub_f32 v49, v49, v7
    v_sub_f32 v50, v50, v7
    v_sub_f32 v51, v51, v7
    v_exp_f32 v36, v36
    v_exp_f32 v37, v37
    v_exp_f32 v38, v38
    v_exp_f32 v39, v39
    v_exp_f32 v40, v40
    v_exp_f32 v41, v41
    v_exp_f32 v42, v42
    v_exp_f32 v43, v43
    v_exp_f32 v44, v44
    v_exp_f32 v45, v45
    v_exp_f32 v46, v46
    v_exp_f32 v47, v47
    v_exp_f32 v48, v48
    v_exp_f32 v49, v49
    v_exp_f32 v50, v50
    v_exp_f32 v51, v51
    s_nop 0
    v_cvt_pk_bf16_f32 v36, v36, v37
    v_cvt_pk_bf16_f32 v37, v38, v39
    v_cvt_pk_bf16_f32 v38, v40, v41
    v_cvt_pk_bf16_f32 v39, v42, v43
    v_cvt_pk_bf16_f32 v40, v44, v45
    v_cvt_pk_bf16_f32 v41, v46, v47
    v_cvt_pk_bf16_f32 v42, v48, v49
    v_cvt_pk_bf16_f32 v43, v50, v51
    s_nop 1
    v_mfma_f32_32x32x16_bf16 v[68:83], v[92:95], v[36:39], v[68:83]
    v_mfma_f32_32x32x16_bf16 v[68:83], v[96:99], v[40:43], v[68:83]
    s_nop 7
    v_add_u32 v8, 9472, v8
    v_add_u32 v9, 9472, v9
    v_add_u32 v10, 9472, v10
    s_add_u32 s41, s41, 1
    s_cmp_lt_u32 s41, 16
    s_cbranch_scc1 L_A_slow1
    s_nop 12
    v_cmp_eq_u32 vcc, 0, v3
    s_nop 1
    v_cndmask_b32 v4, v80, v78, vcc
    s_branch L_A_fin
L_B_t1:
    s_waitcnt lgkmcnt(0)
    s_nop 0
    v_mfma_f32_32x32x16_bf16 v[68:83], v[96:99], v[60:63], v[68:83]
    s_branch L_B_done
L_B_u0:
    s_waitcnt lgkmcnt(0)
    s_nop 0
    v_mfma_f32_32x32x16_bf16 v[68:83], v[96:99], v[44:47], v[68:83]
    s_branch L_B_L2
L_B_wait:
    v_mov_b32 v5, s50
    s_mov_b32 s21, 0
L_B_spin:
    ds_read_b32 v6, v5
    s_add_u32 s21, s21, 1
    s_cmp_gt_u32 s21, 0x400000
    s_waitcnt lgkmcnt(0)
    s_cbranch_scc1 L_B_spun
    v_cmp_gt_u32 vcc, s51, v6
    s_cbranch_vccz L_B_spun
    s_sleep 1
    s_branch L_B_spin
L_B_spun:
    s_setpc_b64 s[30:31]
L_B_try:
    s_cmp_eq_u32 s48, 0
    s_cbranch_scc0 L_ret
    v_cmp_ne_u32 vcc, s14, v109
    s_cbranch_vccnz L_ret
    s_branch L_B_fetch2
L_B_fetch:
    s_cmp_eq_u32 s36, 1
    s_cbranch_scc1 L_ret
    v_cmp_ne_u32 vcc, s14, v109
    s_cbranch_vccz L_B_fetch2
    s_sub_u32 s22, s49, 1024
    v_lshlrev_b32 v5, 3, v1
    s_mov_b64 exec, 15
    s_mov_b32 s21, 0
Lp_100005:
    buffer_load_dword v4, v5, s[16:19], s22 offen sc1
    s_add_u32 s21, s21, 1
    s_cmp_gt_u32 s21, s20
    s_cselect_b32 s20, 0, s20
    s_waitcnt vmcnt(0)
    s_cbranch_scc1 Lpd_100006
    v_cmp_ne_u32 vcc, s14, v4
    s_cbranch_vccnz Lp_100005
Lpd_100006:
    s_mov_b64 exec, -1
L_B_fetch2:
    s_mov_b32 s36, 1
    s_sub_u32 s22, s29, 18944
    s_mul_i32 s23, s48, 2368
    s_add_u32 m0, s23, 118784
    s_nop 0
    buffer_load_dwordx4 v1, s[16:19], s22 offen sc1 lds
    s_add_u32 m0, m0, 1024
    s_add_u32 s22, s22, 1024
    s_nop 0
    buffer_load_dwordx4 v1, s[16:19], s22 offen sc1 lds
    s_add_u32 m0, m0, 1024
    s_add_u32 s22, s22, 1024
    s_nop 0
    buffer_load_dwordx4 v1, s[16:19], s22 offen sc1 lds
    s_add_u32 m0, m0, 1024
    s_add_u32 s22, s22, 1024
    s_nop 0
    buffer_load_dwordx4 v1, s[16:19], s22 offen sc1 lds
    s_add_u32 m0, m0, 1024
    s_add_u32 s22, s22, 1024
    s_nop 0
    buffer_load_dwordx4 v1, s[16:19], s22 offen sc1 lds
    s_add_u32 m0, m0, 1024
    s_add_u32 s22, s22, 1024
    s_nop 0
    buffer_load_dwordx4 v1, s[16:19], s22 offen sc1 lds
    s_add_u32 m0, m0, 1024
    s_add_u32 s22, s22, 1024
    s_nop 0
    buffer_load_dwordx4 v1, s[16:19], s22 offen sc1 lds
    s_add_u32 m0, m0, 1024
    s_add_u32 s22, s22, 1024
    s_nop 0
    buffer_load_dwordx4 v1, s[16:19], s22 offen sc1 lds
    s_add_u32 m0, m0, 1024
    s_add_u32 s22, s22, 1024
    s_nop 0
    buffer_load_dwordx4 v1, s[16:19], s22 offen sc1 lds
    s_add_u32 m0, m0, 1024
    s_add_u32 s22, s22, 1024
    s_mov_b32 exec_lo, 0xffff
    s_mov_b32 exec_hi, 0x0
    buffer_load_dwordx4 v1, s[16:19], s22 offen sc1 lds
    s_mov_b64 exec, -1
    s_setpc_b64 s[30:31]
L_B_fetched:
    s_lshl_b32 s50, s50, 2
    s_add_u32 s50, s50, 162832
    v_mov_b32 v5, s50
    v_mov_b32 v6, 1
    s_waitcnt vmcnt(0)
    ds_write_b32 v5, v6
    s_waitcnt lgkmcnt(0)
    s_setpc_b64 s[30:31]
L_B_slow:
    v_mov_b32 v7, 0xff800000
    ds_read_b128 v[84:87], v8 offset:18944
    ds_read_b32 v88, v9 offset:19968
    v_cndmask_b32 v36, v11, 0, s[64:65]
    v_cndmask_b32 v37, v11, 0, s[66:67]
    v_cndmask_b32 v38, v11, 0, s[68:69]
    v_cndmask_b32 v39, v11, 0, s[70:71]
    v_cndmask_b32 v40, v11, 0, s[72:73]
    v_cndmask_b32 v41, v11, 0, s[74:75]
    v_cndmask_b32 v42, v11, 0, s[76:77]
    v_cndmask_b32 v43, v11, 0, s[78:79]
    v_cndmask_b32 v44, v11, 0, s[80:81]
    v_cndmask_b32 v45, v11, 0, s[82:83]
    v_cndmask_b32 v46, v11, 0, s[84:85]
    v_cndmask_b32 v47, v11, 0, s[86:87]
    v_cndmask_b32 v48, v11, 0, s[88:89]
    v_cndmask_b32 v49, v11, 0, s[90:91]
    v_cndmask_b32 v50, v11, 0, s[92:93]
    v_cndmask_b32 v51, v11, 0, s[94:95]
    s_waitcnt lgkmcnt(0)
    s_nop 1
    v_mfma_f32_32x32x16_bf16 v[36:51], v[84:87], v[24:27], v[36:51]
    v_mfma_f32_32x32x8_bf16 v[36:51], v[88:89], v[28:29], v[36:51]
    s_nop 12
    v_max3_f32 v7, v36, v37, v7
    v_max3_f32 v7, v38, v39, v7
    v_max3_f32 v7, v40, v41, v7
    v_max3_f32 v7, v42, v43, v7
    v_max3_f32 v7, v44, v45, v7
    v_max3_f32 v7, v46, v47, v7
    v_max3_f32 v7, v48, v49, v7
    v_max3_f32 v7, v50, v51, v7
    s_cmp_eq_u32 s47, 1
    s_cbranch_scc1 L_B_slowd0
    ds_read_b128 v[84:87], v8 offset:16576
    ds_read_b32 v88, v9 offset:17600
    s_waitcnt lgkmcnt(0)
    s_nop 1
    v_mfma_f32_32x32x16_bf16 v[36:51], v[84:87], v[24:27], 0
    v_mfma_f32_32x32x8_bf16 v[36:51], v[88:89], v[28:29], v[36:51]
    s_nop 12
    v_max3_f32 v7, v36, v37, v7
    v_max3_f32 v7, v38, v39, v7
    v_max3_f32 v7, v40, v41, v7
    v_max3_f32 v7, v42, v43, v7
    v_max3_f32 v7, v44, v45, v7
    v_max3_f32 v7, v46, v47, v7
    v_max3_f32 v7, v48, v49, v7
    v_max3_f32 v7, v50, v51, v7
    s_cmp_eq_u32 s47, 2
    s_cbranch_scc1 L_B_slowd0
    ds_read_b128 v[84:87], v8 offset:14208
    ds_read_b32 v88, v9 offset:15232
    s_waitcnt lgkmcnt(0)
    s_nop 1
    v_mfma_f32_32x32x16_bf16 v[36:51], v[84:87], v[24:27], 0
    v_mfma_f32_32x32x8_bf16 v[36:51], v[88:89], v[28:29], v[36:51]
    s_nop 12
    v_max3_f32 v7, v36, v37, v7
    v_max3_f32 v7, v38, v39, v7
    v_max3_f32 v7, v40, v41, v7
    v_max3_f32 v7, v42, v43, v7
    v_max3_f32 v7, v44, v45, v7
    v_max3_f32 v7, v46, v47, v7
    v_max3_f32 v7, v48, v49, v7
    v_max3_f32 v7, v50, v51, v7
    s_cmp_eq_u32 s47, 3
    s_cbranch_scc1 L_B_slowd0
    ds_read_b128 v[84:87], v8 offset:11840
    ds_read_b32 v88, v9 offset:12864
    s_waitcnt lgkmcnt(0)
    s_nop 1
    v_mfma_f32_32x32x16_bf16 v[36:51], v[84:87], v[24:27], 0
    v_mfma_f32_32x32x8_bf16 v[36:51], v[88:89], v[28:29], v[36:51]
    s_nop 12
    v_max3_f32 v7, v36, v37, v7
    v_max3_f32 v7, v38, v39, v7
    v_max3_f32 v7, v40, v41, v7
    v_max3_f32 v7, v42, v43, v7
    v_max3_f32 v7, v44, v45, v7
    v_max3_f32 v7, v46, v47, v7
    v_max3_f32 v7, v48, v49, v7
    v_max3_f32 v7, v50, v51, v7
    s_cmp_eq_u32 s47, 4
    s_cbranch_scc1 L_B_slowd0
    ds_read_b128 v[84:87], v8 offset:9472
    ds_read_b32 v88, v9 offset:10496
    s_waitcnt lgkmcnt(0)
    s_nop 1
    v_mfma_f32_32x32x16_bf16 v[36:51], v[84:87], v[24:27], 0
    v_mfma_f32_32x32x8_bf16 v[36:51], v[88:89], v[28:29], v[36:51]
    s_nop 12
    v_max3_f32 v7, v36, v37, v7
    v_max3_f32 v7, v38, v39, v7
    v_max3_f32 v7, v40, v41, v7
    v_max3_f32 v7, v42, v43, v7
    v_max3_f32 v7, v44, v45, v7
    v_max3_f32 v7, v46, v47, v7
    v_max3_f32 v7, v48, v49, v7
    v_max3_f32 v7, v50, v51, v7
    s_cmp_eq_u32 s47, 5
    s_cbranch_scc1 L_B_slowd0
    ds_read_b128 v[84:87], v8 offset:7104
    ds_read_b32 v88, v9 offset:8128
    s_waitcnt lgkmcnt(0)
    s_nop 1
    v_mfma_f32_32x32x16_bf16 v[36:51], v[84:87], v[24:27], 0
    v_mfma_f32_32x32x8_bf16 v[36:51], v[88:89], v[28:29], v[36:51]
    s_nop 12
    v_max3_f32 v7, v36, v37, v7
    v_max3_f32 v7, v38, v39, v7
    v_max3_f32 v7, v40, v41, v7
    v_max3_f32 v7, v42, v43, v7
    v_max3_f32 v7, v44, v45, v7
    v_max3_f32 v7, v46, v47, v7
    v_max3_f32 v7, v48, v49, v7
    v_max3_f32 v7, v50, v51, v7
    s_cmp_eq_u32 s47, 6
    s_cbranch_scc1 L_B_slowd0
    ds_read_b128 v[84:87], v8 offset:4736
    ds_read_b32 v88, v9 offset:5760
    s_waitcnt lgkmcnt(0)
    s_nop 1
    v_mfma_f32_32x32x16_bf16 v[36:51], v[84:87], v[24:27], 0
    v_mfma_f32_32x32x8_bf16 v[36:51], v[88:89], v[28:29], v[36:51]
    s_nop 12
    v_max3_f32 v7, v36, v37, v7
    v_max3_f32 v7, v38, v39, v7
    v_max3_f32 v7, v40, v41, v7
    v_max3_f32 v7, v42, v43, v7
    v_max3_f32 v7, v44, v45, v7
    v_max3_f32 v7, v46, v47, v7
    v_max3_f32 v7, v48, v49, v7
    v_max3_f32 v7, v50, v51, v7
    s_cmp_eq_u32 s47, 7
    s_cbranch_scc1 L_B_slowd0
    ds_read_b128 v[84:87], v8 offset:2368
    ds_read_b32 v88, v9 offset:3392
    s_waitcnt lgkmcnt(0)
    s_nop 1
    v_mfma_f32_32x32x16_bf16 v[36:51], v[84:87], v[24:27], 0
    v_mfma_f32_32x32x8_bf16 v[36:51], v[88:89], v[28:29], v[36:51]
    s_nop 12
    v_max3_f32 v7, v36, v37, v7
    v_max3_f32 v7, v38, v39, v7
    v_max3_f32 v7, v40, v41, v7
    v_max3_f32 v7, v42, v43, v7
    v_max3_f32 v7, v44, v45, v7
    v_max3_f32 v7, v46, v47, v7
    v_max3_f32 v7, v48, v49, v7
    v_max3_f32 v7, v50, v51, v7
    s_cmp_eq_u32 s47, 8
    s_cbranch_scc1 L_B_slowd0
    ds_read_b128 v[84:87], v8 offset:0
    ds_read_b32 v88, v9 offset:1024
    v_cndmask_b32 v36, 0, v11, s[64:65]
    v_cndmask_b32 v37, 0, v11, s[66:67]
    v_cndmask_b32 v38, 0, v11, s[68:69]
    v_cndmask_b32 v39, 0, v11, s[70:71]
    v_cndmask_b32 v40, 0, v11, s[72:73]
    v_cndmask_b32 v41, 0, v11, s[74:75]
    v_cndmask_b32 v42, 0, v11, s[76:77]
    v_cndmask_b32 v43, 0, v11, s[78:79]
    v_cndmask_b32 v44, 0, v11, s[80:81]
    v_cndmask_b32 v45, 0, v11, s[82:83]
    v_cndmask_b32 v46, 0, v11, s[84:85]
    v_cndmask_b32 v47, 0, v11, s[86:87]
    v_cndmask_b32 v48, 0, v11, s[88:89]
    v_cndmask_b32 v49, 0, v11, s[90:91]
    v_cndmask_b32 v50, 0, v11, s[92:93]
    v_cndmask_b32 v51, 0, v11, s[94:95]
    s_waitcnt lgkmcnt(0)
    s_nop 1
    v_mfma_f32_32x32x16_bf16 v[36:51], v[84:87], v[24:27], v[36:51]
    v_mfma_f32_32x32x8_bf16 v[36:51], v[88:89], v[28:29], v[36:51]
    s_nop 12
    v_max3_f32 v7, v36, v37, v7
    v_max3_f32 v7, v38, v39, v7
    v_max3_f32 v7, v40, v41, v7
    v_max3_f32 v7, v42, v43, v7
    v_max3_f32 v7, v44, v45, v7
    v_max3_f32 v7, v46, v47, v7
    v_max3_f32 v7, v48, v49, v7
    v_max3_f32 v7, v50, v51, v7
L_B_slowd0:
    v_mov_b32 v6, v7
    s_nop 1
    v_permlane32_swap_b32 v6, v7
    s_nop 1
    v_max_f32 v7, v6, v7
    v_mov_b32 v68, 0
    v_mov_b32 v69, 0
    v_mov_b32 v70, 0
    v_mov_b32 v71, 0
    v_mov_b32 v72, 0
    v_mov_b32 v73, 0
    v_mov_b32 v74, 0
    v_mov_b32 v75, 0
    v_mov_b32 v76, 0
    v_mov_b32 v77, 0
    v_mov_b32 v78, 0
    v_mov_b32 v79, 0
    v_mov_b32 v80, 0
    v_mov_b32 v81, 0
    v_mov_b32 v82, 0
    v_mov_b32 v83, 0
    ds_read_b128 v[84:87], v8 offset:18944
    ds_read_b32 v88, v9 offset:19968
    ds_read_b128 v[92:95], v10 offset:18944
    ds_read_b128 v[96:99], v10 offset:19552
    v_cndmask_b32 v36, v11, 0, s[64:65]
    v_cndmask_b32 v37, v11, 0, s[66:67]
    v_cndmask_b32 v38, v11, 0, s[68:69]
    v_cndmask_b32 v39, v11, 0, s[70:71]
    v_cndmask_b32 v40, v11, 0, s[72:73]
    v_cndmask_b32 v41, v11, 0, s[74:75]
    v_cndmask_b32 v42, v11, 0, s[76:77]
    v_cndmask_b32 v43, v11, 0, s[78:79]
    v_cndmask_b32 v44, v11, 0, s[80:81]
    v_cndmask_b32 v45, v11, 0, s[82:83]
    v_cndmask_b32 v46, v11, 0, s[84:85]
    v_cndmask_b32 v47, v11, 0, s[86:87]
    v_cndmask_b32 v48, v11, 0, s[88:89]
    v_cndmask_b32 v49, v11, 0, s[90:91]
    v_cndmask_b32 v50, v11, 0, s[92:93]
    v_cndmask_b32 v51, v11, 0, s[94:95]
    s_waitcnt lgkmcnt(0)
    s_nop 1
    v_mfma_f32_32x32x16_bf16 v[36:51], v[84:87], v[24:27], v[36:51]
    v_mfma_f32_32x32x8_bf16 v[36:51], v[88:89], v[28:29], v[36:51]
    s_nop 12
    v_sub_f32 v36, v36, v7
    v_sub_f32 v37, v37, v7
    v_sub_f32 v38, v38, v7
    v_sub_f32 v39, v39, v7
    v_sub_f32 v40, v40, v7
    v_sub_f32 v41, v41, v7
    v_sub_f32 v42, v42, v7
    v_sub_f32 v43, v43, v7
    v_sub_f32 v44, v44, v7
    v_sub_f32 v45, v45, v7
    v_sub_f32 v46, v46, v7
    v_sub_f32 v47, v47, v7
    v_sub_f32 v48, v48, v7
    v_sub_f32 v49, v49, v7
    v_sub_f32 v50, v50, v7
    v_sub_f32 v51, v51, v7
    v_exp_f32 v36, v36
    v_exp_f32 v37, v37
    v_exp_f32 v38, v38
    v_exp_f32 v39, v39
    v_exp_f32 v40, v40
    v_exp_f32 v41, v41
    v_exp_f32 v42, v42
    v_exp_f32 v43, v43
    v_exp_f32 v44, v44
    v_exp_f32 v45, v45
    v_exp_f32 v46, v46
    v_exp_f32 v47, v47
    v_exp_f32 v48, v48
    v_exp_f32 v49, v49
    v_exp_f32 v50, v50
    v_exp_f32 v51, v51
    s_nop 0
    v_cvt_pk_bf16_f32 v36, v36, v37
    v_cvt_pk_bf16_f32 v37, v38, v39
    v_cvt_pk_bf16_f32 v38, v40, v41
    v_cvt_pk_bf16_f32 v39, v42, v43
    v_cvt_pk_bf16_f32 v40, v44, v45
    v_cvt_pk_bf16_f32 v41, v46, v47
    v_cvt_pk_bf16_f32 v42, v48, v49
    v_cvt_pk_bf16_f32 v43, v50, v51
    s_nop 1
    v_mfma_f32_32x32x16_bf16 v[68:83], v[92:95], v[36:39], v[68:83]
    v_mfma_f32_32x32x16_bf16 v[68:83], v[96:99], v[40:43], v[68:83]
    s_nop 7
    s_cmp_eq_u32 s47, 1
    s_cbranch_scc1 L_B_slowd1
    ds_read_b128 v[84:87], v8 offset:16576
    ds_read_b32 v88, v9 offset:17600
    ds_read_b128 v[92:95], v10 offset:16576
    ds_read_b128 v[96:99], v10 offset:17184
    s_waitcnt lgkmcnt(0)
    s_nop 1
    v_mfma_f32_32x32x16_bf16 v[36:51], v[84:87], v[24:27], 0
    v_mfma_f32_32x32x8_bf16 v[36:51], v[88:89], v[28:29], v[36:51]
    s_nop 12
    v_sub_f32 v36, v36, v7
    v_sub_f32 v37, v37, v7
    v_sub_f32 v38, v38, v7
    v_sub_f32 v39, v39, v7
    v_sub_f32 v40, v40, v7
    v_sub_f32 v41, v41, v7
    v_sub_f32 v42, v42, v7
    v_sub_f32 v43, v43, v7
    v_sub_f32 v44, v44, v7
    v_sub_f32 v45, v45, v7
    v_sub_f32 v46, v46, v7
    v_sub_f32 v47, v47, v7
    v_sub_f32 v48, v48, v7
    v_sub_f32 v49, v49, v7
    v_sub_f32 v50, v50, v7
    v_sub_f32 v51, v51, v7
    v_exp_f32 v36, v36
    v_exp_f32 v37, v37
    v_exp_f32 v38, v38
    v_exp_f32 v39, v39
    v_exp_f32 v40, v40
    v_exp_f32 v41, v41
    v_exp_f32 v42, v42
    v_exp_f32 v43, v43
    v_exp_f32 v44, v44
    v_exp_f32 v45, v45
    v_exp_f32 v46, v46
    v_exp_f32 v47, v47
    v_exp_f32 v48, v48
    v_exp_f32 v49, v49
    v_exp_f32 v50, v50
    v_exp_f32 v51, v51
    s_nop 0
    v_cvt_pk_bf16_f32 v36, v36, v37
    v_cvt_pk_bf16_f32 v37, v38, v39
    v_cvt_pk_bf16_f32 v38, v40, v41
    v_cvt_pk_bf16_f32 v39, v42, v43
    v_cvt_pk_bf16_f32 v40, v44, v45
    v_cvt_pk_bf16_f32 v41, v46, v47
    v_cvt_pk_bf16_f32 v42, v48, v49
    v_cvt_pk_bf16_f32 v43, v50, v51
    s_nop 1
    v_mfma_f32_32x32x16_bf16 v[68:83], v[92:95], v[36:39], v[68:83]
    v_mfma_f32_32x32x16_bf16 v[68:83], v[96:99], v[40:43], v[68:83]
    s_nop 7
    s_cmp_eq_u32 s47, 2
    s_cbranch_scc1 L_B_slowd1
    ds_read_b128 v[84:87], v8 offset:14208
    ds_read_b32 v88, v9 offset:15232
    ds_read_b128 v[92:95], v10 offset:14208
    ds_read_b128 v[96:99], v10 offset:14816
    s_waitcnt lgkmcnt(0)
    s_nop 1
    v_mfma_f32_32x32x16_bf16 v[36:51], v[84:87], v[24:27], 0
    v_mfma_f32_32x32x8_bf16 v[36:51], v[88:89], v[28:29], v[36:51]
    s_nop 12
    v_sub_f32 v36, v36, v7
    v_sub_f32 v37, v37, v7
    v_sub_f32 v38, v38, v7
    v_sub_f32 v39, v39, v7
    v_sub_f32 v40, v40, v7
    v_sub_f32 v41, v41, v7
    v_sub_f32 v42, v42, v7
    v_sub_f32 v43, v43, v7
    v_sub_f32 v44, v44, v7
    v_sub_f32 v45, v45, v7
    v_sub_f32 v46, v46, v7
    v_sub_f32 v47, v47, v7
    v_sub_f32 v48, v48, v7
    v_sub_f32 v49, v49, v7
    v_sub_f32 v50, v50, v7
    v_sub_f32 v51, v51, v7
    v_exp_f32 v36, v36
    v_exp_f32 v37, v37
    v_exp_f32 v38, v38
    v_exp_f32 v39, v39
    v_exp_f32 v40, v40
    v_exp_f32 v41, v41
    v_exp_f32 v42, v42
    v_exp_f32 v43, v43
    v_exp_f32 v44, v44
    v_exp_f32 v45, v45
    v_exp_f32 v46, v46
    v_exp_f32 v47, v47
    v_exp_f32 v48, v48
    v_exp_f32 v49, v49
    v_exp_f32 v50, v50
    v_exp_f32 v51, v51
    s_nop 0
    v_cvt_pk_bf16_f32 v36, v36, v37
    v_cvt_pk_bf16_f32 v37, v38, v39
    v_cvt_pk_bf16_f32 v38, v40, v41
    v_cvt_pk_bf16_f32 v39, v42, v43
    v_cvt_pk_bf16_f32 v40, v44, v45
    v_cvt_pk_bf16_f32 v41, v46, v47
    v_cvt_pk_bf16_f32 v42, v48, v49
    v_cvt_pk_bf16_f32 v43, v50, v51
    s_nop 1
    v_mfma_f32_32x32x16_bf16 v[68:83], v[92:95], v[36:39], v[68:83]
    v_mfma_f32_32x32x16_bf16 v[68:83], v[96:99], v[40:43], v[68:83]
    s_nop 7
    s_cmp_eq_u32 s47, 3
    s_cbranch_scc1 L_B_slowd1
    ds_read_b128 v[84:87], v8 offset:11840
    ds_read_b32 v88, v9 offset:12864
    ds_read_b128 v[92:95], v10 offset:11840
    ds_read_b128 v[96:99], v10 offset:12448
    s_waitcnt lgkmcnt(0)
    s_nop 1
    v_mfma_f32_32x32x16_bf16 v[36:51], v[84:87], v[24:27], 0
    v_mfma_f32_32x32x8_bf16 v[36:51], v[88:89], v[28:29], v[36:51]
    s_nop 12
    v_sub_f32 v36, v36, v7
    v_sub_f32 v37, v37, v7
    v_sub_f32 v38, v38, v7
    v_sub_f32 v39, v39, v7
    v_sub_f32 v40, v40, v7
    v_sub_f32 v41, v41, v7
    v_sub_f32 v42, v42, v7
    v_sub_f32 v43, v43, v7
    v_sub_f32 v44, v44, v7
    v_sub_f32 v45, v45, v7
    v_sub_f32 v46, v46, v7
    v_sub_f32 v47, v47, v7
    v_sub_f32 v48, v48, v7
    v_sub_f32 v49, v49, v7
    v_sub_f32 v50, v50, v7
    v_sub_f32 v51, v51, v7
    v_exp_f32 v36, v36
    v_exp_f32 v37, v37
    v_exp_f32 v38, v38
    v_exp_f32 v39, v39
    v_exp_f32 v40, v40
    v_exp_f32 v41, v41
    v_exp_f32 v42, v42
    v_exp_f32 v43, v43
    v_exp_f32 v44, v44
    v_exp_f32 v45, v45
    v_exp_f32 v46, v46
    v_exp_f32 v47, v47
    v_exp_f32 v48, v48
    v_exp_f32 v49, v49
    v_exp_f32 v50, v50
    v_exp_f32 v51, v51
    s_nop 0
    v_cvt_pk_bf16_f32 v36, v36, v37
    v_cvt_pk_bf16_f32 v37, v38, v39
    v_cvt_pk_bf16_f32 v38, v40, v41
    v_cvt_pk_bf16_f32 v39, v42, v43
    v_cvt_pk_bf16_f32 v40, v44, v45
    v_cvt_pk_bf16_f32 v41, v46, v47
    v_cvt_pk_bf16_f32 v42, v48, v49
    v_cvt_pk_bf16_f32 v43, v50, v51
    s_nop 1
    v_mfma_f32_32x32x16_bf16 v[68:83], v[92:95], v[36:39], v[68:83]
    v_mfma_f32_32x32x16_bf16 v[68:83], v[96:99], v[40:43], v[68:83]
    s_nop 7
    s_cmp_eq_u32 s47, 4
    s_cbranch_scc1 L_B_slowd1
    ds_read_b128 v[84:87], v8 offset:9472
    ds_read_b32 v88, v9 offset:10496
    ds_read_b128 v[92:95], v10 offset:9472
    ds_read_b128 v[96:99], v10 offset:10080
    s_waitcnt lgkmcnt(0)
    s_nop 1
    v_mfma_f32_32x32x16_bf16 v[36:51], v[84:87], v[24:27], 0
    v_mfma_f32_32x32x8_bf16 v[36:51], v[88:89], v[28:29], v[36:51]
    s_nop 12
    v_sub_f32 v36, v36, v7
    v_sub_f32 v37, v37, v7
    v_sub_f32 v38, v38, v7
    v_sub_f32 v39, v39, v7
    v_sub_f32 v40, v40, v7
    v_sub_f32 v41, v41, v7
    v_sub_f32 v42, v42, v7
    v_sub_f32 v43, v43, v7
    v_sub_f32 v44, v44, v7
    v_sub_f32 v45, v45, v7
    v_sub_f32 v46, v46, v7
    v_sub_f32 v47, v47, v7
    v_sub_f32 v48, v48, v7
    v_sub_f32 v49, v49, v7
    v_sub_f32 v50, v50, v7
    v_sub_f32 v51, v51, v7
    v_exp_f32 v36, v36
    v_exp_f32 v37, v37
    v_exp_f32 v38, v38
    v_exp_f32 v39, v39
    v_exp_f32 v40, v40
    v_exp_f32 v41, v41
    v_exp_f32 v42, v42
    v_exp_f32 v43, v43
    v_exp_f32 v44, v44
    v_exp_f32 v45, v45
    v_exp_f32 v46, v46
    v_exp_f32 v47, v47
    v_exp_f32 v48, v48
    v_exp_f32 v49, v49
    v_exp_f32 v50, v50
    v_exp_f32 v51, v51
    s_nop 0
    v_cvt_pk_bf16_f32 v36, v36, v37
    v_cvt_pk_bf16_f32 v37, v38, v39
    v_cvt_pk_bf16_f32 v38, v40, v41
    v_cvt_pk_bf16_f32 v39, v42, v43
    v_cvt_pk_bf16_f32 v40, v44, v45
    v_cvt_pk_bf16_f32 v41, v46, v47
    v_cvt_pk_bf16_f32 v42, v48, v49
    v_cvt_pk_bf16_f32 v43, v50, v51
    s_nop 1
    v_mfma_f32_32x32x16_bf16 v[68:83], v[92:95], v[36:39], v[68:83]
    v_mfma_f32_32x32x16_bf16 v[68:83], v[96:99], v[40:43], v[68:83]
    s_nop 7
    s_cmp_eq_u32 s47, 5
    s_cbranch_scc1 L_B_slowd1
    ds_read_b128 v[84:87], v8 offset:7104
    ds_read_b32 v88, v9 offset:8128
    ds_read_b128 v[92:95], v10 offset:7104
    ds_read_b128 v[96:99], v10 offset:7712
    s_waitcnt lgkmcnt(0)
    s_nop 1
    v_mfma_f32_32x32x16_bf16 v[36:51], v[84:87], v[24:27], 0
    v_mfma_f32_32x32x8_bf16 v[36:51], v[88:89], v[28:29], v[36:51]
    s_nop 12
    v_sub_f32 v36, v36, v7
    v_sub_f32 v37, v37, v7
    v_sub_f32 v38, v38, v7
    v_sub_f32 v39, v39, v7
    v_sub_f32 v40, v40, v7
    v_sub_f32 v41, v41, v7
    v_sub_f32 v42, v42, v7
    v_sub_f32 v43, v43, v7
    v_sub_f32 v44, v44, v7
    v_sub_f32 v45, v45, v7
    v_sub_f32 v46, v46, v7
    v_sub_f32 v47, v47, v7
    v_sub_f32 v48, v48, v7
    v_sub_f32 v49, v49, v7
    v_sub_f32 v50, v50, v7
    v_sub_f32 v51, v51, v7
    v_exp_f32 v36, v36
    v_exp_f32 v37, v37
    v_exp_f32 v38, v38
    v_exp_f32 v39, v39
    v_exp_f32 v40, v40
    v_exp_f32 v41, v41
    v_exp_f32 v42, v42
    v_exp_f32 v43, v43
    v_exp_f32 v44, v44
    v_exp_f32 v45, v45
    v_exp_f32 v46, v46
    v_exp_f32 v47, v47
    v_exp_f32 v48, v48
    v_exp_f32 v49, v49
    v_exp_f32 v50, v50
    v_exp_f32 v51, v51
    s_nop 0
    v_cvt_pk_bf16_f32 v36, v36, v37
    v_cvt_pk_bf16_f32 v37, v38, v39
    v_cvt_pk_bf16_f32 v38, v40, v41
    v_cvt_pk_bf16_f32 v39, v42, v43
    v_cvt_pk_bf16_f32 v40, v44, v45
    v_cvt_pk_bf16_f32 v41, v46, v47
    v_cvt_pk_bf16_f32 v42, v48, v49
    v_cvt_pk_bf16_f32 v43, v50, v51
    s_nop 1
    v_mfma_f32_32x32x16_bf16 v[68:83], v[92:95], v[36:39], v[68:83]
    v_mfma_f32_32x32x16_bf16 v[68:83], v[96:99], v[40:43], v[68:83]
    s_nop 7
    s_cmp_eq_u32 s47, 6
    s_cbranch_scc1 L_B_slowd1
    ds_read_b128 v[84:87], v8 offset:4736
    ds_read_b32 v88, v9 offset:5760
    ds_read_b128 v[92:95], v10 offset:4736
    ds_read_b128 v[96:99], v10 offset:5344
    s_waitcnt lgkmcnt(0)
    s_nop 1
    v_mfma_f32_32x32x16_bf16 v[36:51], v[84:87], v[24:27], 0
    v_mfma_f32_32x32x8_bf16 v[36:51], v[88:89], v[28:29], v[36:51]
    s_nop 12
    v_sub_f32 v36, v36, v7
    v_sub_f32 v37, v37, v7
    v_sub_f32 v38, v38, v7
    v_sub_f32 v39, v39, v7
    v_sub_f32 v40, v40, v7
    v_sub_f32 v41, v41, v7
    v_sub_f32 v42, v42, v7
    v_sub_f32 v43, v43, v7
    v_sub_f32 v44, v44, v7
    v_sub_f32 v45, v45, v7
    v_sub_f32 v46, v46, v7
    v_sub_f32 v47, v47, v7
    v_sub_f32 v48, v48, v7
    v_sub_f32 v49, v49, v7
    v_sub_f32 v50, v50, v7
    v_sub_f32 v51, v51, v7
    v_exp_f32 v36, v36
    v_exp_f32 v37, v37
    v_exp_f32 v38, v38
    v_exp_f32 v39, v39
    v_exp_f32 v40, v40
    v_exp_f32 v41, v41
    v_exp_f32 v42, v42
    v_exp_f32 v43, v43
    v_exp_f32 v44, v44
    v_exp_f32 v45, v45
    v_exp_f32 v46, v46
    v_exp_f32 v47, v47
    v_exp_f32 v48, v48
    v_exp_f32 v49, v49
    v_exp_f32 v50, v50
    v_exp_f32 v51, v51
    s_nop 0
    v_cvt_pk_bf16_f32 v36, v36, v37
    v_cvt_pk_bf16_f32 v37, v38, v39
    v_cvt_pk_bf16_f32 v38, v40, v41
    v_cvt_pk_bf16_f32 v39, v42, v43
    v_cvt_pk_bf16_f32 v40, v44, v45
    v_cvt_pk_bf16_f32 v41, v46, v47
    v_cvt_pk_bf16_f32 v42, v48, v49
    v_cvt_pk_bf16_f32 v43, v50, v51
    s_nop 1
    v_mfma_f32_32x32x16_bf16 v[68:83], v[92:95], v[36:39], v[68:83]
    v_mfma_f32_32x32x16_bf16 v[68:83], v[96:99], v[40:43], v[68:83]
    s_nop 7
    s_cmp_eq_u32 s47, 7
    s_cbranch_scc1 L_B_slowd1
    ds_read_b128 v[84:87], v8 offset:2368
    ds_read_b32 v88, v9 offset:3392
    ds_read_b128 v[92:95], v10 offset:2368
    ds_read_b128 v[96:99], v10 offset:2976
    s_waitcnt lgkmcnt(0)
    s_nop 1
    v_mfma_f32_32x32x16_bf16 v[36:51], v[84:87], v[24:27], 0
    v_mfma_f32_32x32x8_bf16 v[36:51], v[88:89], v[28:29], v[36:51]
    s_nop 12
    v_sub_f32 v36, v36, v7
    v_sub_f32 v37, v37, v7
    v_sub_f32 v38, v38, v7
    v_sub_f32 v39, v39, v7
    v_sub_f32 v40, v40, v7
    v_sub_f32 v41, v41, v7
    v_sub_f32 v42, v42, v7
    v_sub_f32 v43, v43, v7
    v_sub_f32 v44, v44, v7
    v_sub_f32 v45, v45, v7
    v_sub_f32 v46, v46, v7
    v_sub_f32 v47, v47, v7
    v_sub_f32 v48, v48, v7
    v_sub_f32 v49, v49, v7
    v_sub_f32 v50, v50, v7
    v_sub_f32 v51, v51, v7
    v_exp_f32 v36, v36
    v_exp_f32 v37, v37
    v_exp_f32 v38, v38
    v_exp_f32 v39, v39
    v_exp_f32 v40, v40
    v_exp_f32 v41, v41
    v_exp_f32 v42, v42
    v_exp_f32 v43, v43
    v_exp_f32 v44, v44
    v_exp_f32 v45, v45
    v_exp_f32 v46, v46
    v_exp_f32 v47, v47
    v_exp_f32 v48, v48
    v_exp_f32 v49, v49
    v_exp_f32 v50, v50
    v_exp_f32 v51, v51
    s_nop 0
    v_cvt_pk_bf16_f32 v36, v36, v37
    v_cvt_pk_bf16_f32 v37, v38, v39
    v_cvt_pk_bf16_f32 v38, v40, v41
    v_cvt_pk_bf16_f32 v39, v42, v43
    v_cvt_pk_bf16_f32 v40, v44, v45
    v_cvt_pk_bf16_f32 v41, v46, v47
    v_cvt_pk_bf16_f32 v42, v48, v49
    v_cvt_pk_bf16_f32 v43, v50, v51
    s_nop 1
    v_mfma_f32_32x32x16_bf16 v[68:83], v[92:95], v[36:39], v[68:83]
    v_mfma_f32_32x32x16_bf16 v[68:83], v[96:99], v[40:43], v[68:83]
    s_nop 7
    s_cmp_eq_u32 s47, 8
    s_cbranch_scc1 L_B_slowd1
    ds_read_b128 v[84:87], v8 offset:0
    ds_read_b32 v88, v9 offset:1024
    ds_read_b128 v[92:95], v10 offset:0
    ds_read_b128 v[96:99], v10 offset:608
    v_cndmask_b32 v36, 0, v11, s[64:65]
    v_cndmask_b32 v37, 0, v11, s[66:67]
    v_cndmask_b32 v38, 0, v11, s[68:69]
    v_cndmask_b32 v39, 0, v11, s[70:71]
    v_cndmask_b32 v40, 0, v11, s[72:73]
    v_cndmask_b32 v41, 0, v11, s[74:75]
    v_cndmask_b32 v42, 0, v11, s[76:77]
    v_cndmask_b32 v43, 0, v11, s[78:79]
    v_cndmask_b32 v44, 0, v11, s[80:81]
    v_cndmask_b32 v45, 0, v11, s[82:83]
    v_cndmask_b32 v46, 0, v11, s[84:85]
    v_cndmask_b32 v47, 0, v11, s[86:87]
    v_cndmask_b32 v48, 0, v11, s[88:89]
    v_cndmask_b32 v49, 0, v11, s[90:91]
    v_cndmask_b32 v50, 0, v11, s[92:93]
    v_cndmask_b32 v51, 0, v11, s[94:95]
    s_waitcnt lgkmcnt(0)
    s_nop 1
    v_mfma_f32_32x32x16_bf16 v[36:51], v[84:87], v[24:27], v[36:51]
    v_mfma_f32_32x32x8_bf16 v[36:51], v[88:89], v[28:29], v[36:51]
    s_nop 12
    v_sub_f32 v36, v36, v7
    v_sub_f32 v37, v37, v7
    v_sub_f32 v38, v38, v7
    v_sub_f32 v39, v39, v7
    v_sub_f32 v40, v40, v7
    v_sub_f32 v41, v41, v7
    v_sub_f32 v42, v42, v7
    v_sub_f32 v43, v43, v7
    v_sub_f32 v44, v44, v7
    v_sub_f32 v45, v45, v7
    v_sub_f32 v46, v46, v7
    v_sub_f32 v47, v47, v7
    v_sub_f32 v48, v48, v7
    v_sub_f32 v49, v49, v7
    v_sub_f32 v50, v50, v7
    v_sub_f32 v51, v51, v7
    v_exp_f32 v36, v36
    v_exp_f32 v37, v37
    v_exp_f32 v38, v38
    v_exp_f32 v39, v39
    v_exp_f32 v40, v40
    v_exp_f32 v41, v41
    v_exp_f32 v42, v42
    v_exp_f32 v43, v43
    v_exp_f32 v44, v44
    v_exp_f32 v45, v45
    v_exp_f32 v46, v46
    v_exp_f32 v47, v47
    v_exp_f32 v48, v48
    v_exp_f32 v49, v49
    v_exp_f32 v50, v50
    v_exp_f32 v51, v51
    s_nop 0
    v_cvt_pk_bf16_f32 v36, v36, v37
    v_cvt_pk_bf16_f32 v37, v38, v39
    v_cvt_pk_bf16_f32 v38, v40, v41
    v_cvt_pk_bf16_f32 v39, v42, v43
    v_cvt_pk_bf16_f32 v40, v44, v45
    v_cvt_pk_bf16_f32 v41, v46, v47
    v_cvt_pk_bf16_f32 v42, v48, v49
    v_cvt_pk_bf16_f32 v43, v50, v51
    s_nop 1
    v_mfma_f32_32x32x16_bf16 v[68:83], v[92:95], v[36:39], v[68:83]
    v_mfma_f32_32x32x16_bf16 v[68:83], v[96:99], v[40:43], v[68:83]
    s_nop 7
L_B_slowd1:
    s_nop 12
    v_cmp_eq_u32 vcc, 0, v3
    s_nop 1
    v_cndmask_b32 v4, v80, v78, vcc
    s_branch L_B_fin
CODE_END:
.section .rodata,"a"
.p2align 6
.amdhsa_kernel interleave_layers__grouped_kv_mqa__sliding_block__prompt_kernel
  .amdhsa_next_free_vgpr 256
  .amdhsa_next_free_sgpr 102
  .amdhsa_accum_offset 256
  .amdhsa_group_segment_fixed_size 0
  .amdhsa_kernarg_size 88
  .amdhsa_user_sgpr_count 2
  .amdhsa_user_sgpr_kernarg_segment_ptr 1
  .amdhsa_system_sgpr_workgroup_id_x 1
  .amdhsa_float_denorm_mode_32 3
.end_amdhsa_kernel
```
